```python
import torch

def _softmax(x, axis=-1):
    return torch.softmax(x, dim=axis)
def _gelu(x):
    return torch.nn.functional.gelu(x, approximate="tanh")
def _silu(x):
    return torch.nn.functional.silu(x)
def _sigmoid(x):
    return torch.sigmoid(x)
def _layernorm(x, axis=-1, eps=1e-5):
    m = x.mean(dim=axis, keepdim=True)
    v = x.var(dim=axis, keepdim=True, unbiased=False)
    return (x - m) / torch.sqrt(v + eps)
def _scatter_add(tgt, idx, src, axis=0):
    return tgt.clone().index_add_(axis, idx, src)
def _segment_sum(src, seg, n):
    out = torch.zeros((n,) + src.shape[1:], dtype=src.dtype)
    return out.index_add_(0, seg, src)
def _pad(x, pw):
    flat = tuple(v for pair in reversed(pw) for v in pair)
    return torch.nn.functional.pad(x, flat)

kernel_name = 'interleave_layers__sliding_block__glu_gated_glu__prompt'

def setup_inputs():

    _w = (lambda a: (lambda t: t.to(torch.bfloat16) if t.is_floating_point() else t)(torch.as_tensor(a)))
    def _A_setup():
        B, S, D = 1, 2048, 512
        return {
            "x": _w((lambda *s: torch.randn(*s, dtype=torch.bfloat16) * 0.05)(B, S, D)),
            "wqkv": _w((lambda *s: torch.randn(*s, dtype=torch.bfloat16) * 0.05)(D, 3 * D)),
            "wo": _w((lambda *s: torch.randn(*s, dtype=torch.bfloat16) * 0.05)(D, D)),
        }
    _A_in = _A_setup()

    def _B_setup():
        B, S, D, F = 1, 2048, 512, 1792
        return {
            "x": _w((lambda *s: torch.randn(*s, dtype=torch.bfloat16) * 0.05)(B, S, D)),
            "w_gate": _w((lambda *s: torch.randn(*s, dtype=torch.bfloat16) * 0.05)(D, F)),
            "w_up": _w((lambda *s: torch.randn(*s, dtype=torch.bfloat16) * 0.05)(D, F)),
            "w_down": _w((lambda *s: torch.randn(*s, dtype=torch.bfloat16) * 0.05)(F, D)),
        }
    _B_in = _B_setup()

    return {
        "A_x": _A_in["x"],
        "A_wqkv": _A_in["wqkv"],
        "A_wo": _A_in["wo"],
        "B_x": _B_in["x"],
        "B_w_gate": _B_in["w_gate"],
        "B_w_up": _B_in["w_up"],
        "B_w_down": _B_in["w_down"],
    }

def reference(A_x, A_wqkv, A_wo, B_x, B_w_gate, B_w_up, B_w_down):
    def _A_ref(x, wqkv, wo):
        B, S, D = x.shape
        H = 32; Dh = D // H; W = 256
        qkv = (lambda x, *d: x.permute(*d))((x @ wqkv).reshape(B, S, 3, H, Dh), 2, 0, 3, 1, 4)
        q, k, v = qkv[0], qkv[1], qkv[2]
        scores = torch.einsum("bhqd,bhkd->bhqk", q, k) * (Dh ** -0.5)
        idx = torch.arange(S)
        mask = (idx[:, None] - idx[None, :] >= 0) & (idx[:, None] - idx[None, :] < W)
        scores = torch.where(mask[None, None], scores, -1e9)
        p = _softmax(scores, axis=-1)
        o = torch.einsum("bhqk,bhkd->bhqd", p, v)
        return (lambda x, *d: x.permute(*d))(o, 0, 2, 1, 3).reshape(B, S, D) @ wo

    def _B_ref(x, w_gate, w_up, w_down):
        g = torch.einsum("bsd,df->bsf", x, w_gate)
        u = torch.einsum("bsd,df->bsf", x, w_up)
        h = _sigmoid(g) * u
        return torch.einsum("bsf,fd->bsd", h, w_down)

    x = A_x
    x = x + _A_ref(_layernorm(x, axis=-1), A_wqkv, A_wo)
    x = x + _B_ref(_layernorm(x, axis=-1), B_w_gate, B_w_up, B_w_down)
    x = x + _A_ref(_layernorm(x, axis=-1), A_wqkv, A_wo)
    x = x + _B_ref(_layernorm(x, axis=-1), B_w_gate, B_w_up, B_w_down)
    return x
```

```asm
; @launch grid=(256,1,1) block=(512,1,1) lds=163840
.amdgcn_target "amdgcn-amd-amdhsa--gfx950"
.text
.globl interleave_layers__sliding_block__glu_gated_glu__prompt_kernel
.p2align 8
.type interleave_layers__sliding_block__glu_gated_glu__prompt_kernel,@function
interleave_layers__sliding_block__glu_gated_glu__prompt_kernel:
    s_cmp_ge_u32 s2, 256
    s_cbranch_scc1 mega_end
    s_load_dwordx2 s[44:45], s[0:1], 0
    s_load_dwordx2 s[48:49], s[0:1], 8
    s_load_dwordx2 s[8:9], s[0:1], 72
    s_load_dwordx2 s[12:13], s[0:1], 56
    s_load_dwordx2 s[88:89], s[0:1], 16
    s_load_dwordx2 s[92:93], s[0:1], 48
    v_lshrrev_b32 v1, 6, v0
    v_and_b32 v0, 63, v0
    v_readfirstlane_b32 s3, v1
    v_lshlrev_b32 v1, 4, v0
    s_and_b32 s6, s2, 7
    s_lshr_b32 s7, s2, 3
    s_lshr_b32 s56, s6, 1
    s_mul_i32 s16, s56, 4
    s_lshr_b32 s56, s7, 3
    s_add_u32 s16, s16, s56
    s_and_b32 s56, s6, 1
    s_mul_i32 s17, s56, 8
    s_and_b32 s56, s7, 7
    s_add_u32 s17, s17, s56
    s_mov_b32 s46, 0x200000
    s_mov_b32 s47, 0x00020000
    s_mov_b32 s50, 0x180000
    s_mov_b32 s51, 0x00020000
    s_mov_b32 s10, 0x10000000
    s_mov_b32 s11, 0x00020000
    s_mov_b32 s14, 0x200000
    s_mov_b32 s15, 0x00020000
    s_mov_b32 s90, 0x80000
    s_mov_b32 s91, 0x00020000
    s_mov_b32 s94, 0x1c0000
    s_mov_b32 s95, 0x00020000
    v_mov_b32 v26, 0
    v_mov_b32 v27, 0
    v_mov_b32 v28, 0
    s_cmp_lg_u32 s3, 0
    s_cbranch_scc1 e_1
    s_lshr_b32 s6, s17, 2
    s_lshl2_add_u32 s6, s16, s6
    s_and_b32 s7, s17, 3
    v_and_b32 v28, 31, v0
    v_lshlrev_b32 v29, 10, v28
    v_lshrrev_b32 v30, 5, v0
    v_lshl_add_u32 v29, v30, 4, v29
    s_lshl_b32 s60, s6, 15
    s_lshl_b32 s61, s7, 8
    s_add_u32 s61, s61, s60
    s_waitcnt lgkmcnt(0)
    buffer_load_dwordx4 v[128:131], v29, s[44:47], s61 offen offset:0
    buffer_load_dwordx4 v[132:135], v29, s[44:47], s61 offen offset:32
    buffer_load_dwordx4 v[136:139], v29, s[44:47], s61 offen offset:64
    buffer_load_dwordx4 v[140:143], v29, s[44:47], s61 offen offset:96
    buffer_load_dwordx4 v[144:147], v29, s[44:47], s61 offen offset:128
    buffer_load_dwordx4 v[148:151], v29, s[44:47], s61 offen offset:160
    buffer_load_dwordx4 v[152:155], v29, s[44:47], s61 offen offset:192
    buffer_load_dwordx4 v[156:159], v29, s[44:47], s61 offen offset:224
    s_lshl_b32 s61, s7, 13
    s_add_u32 s60, s60, s61
    s_add_u32 s61, s60, 4096
    s_lshl2_add_u32 s62, s6, s7
    s_lshl_b32 s62, s62, 8
    s_add_u32 s62, s62, 0x1400000
    v_lshlrev_b32 v28, 3, v28
    v_lshl_add_u32 v28, v30, 2, v28
    s_branch e_done
e_1:
    s_cmp_ge_u32 s3, 4
    s_cbranch_scc1 e_4
    v_lshrrev_b32 v27, 2, v0
    v_mul_u32_u24 v27, 3072, v27
    v_and_b32 v31, 3, v0
    v_lshl_add_u32 v27, v31, 4, v27
    v_add_u32 v26, 48128, v27
    s_cmp_eq_u32 s3, 3
    s_cselect_b32 s62, 0, s3
    s_cselect_b32 s60, 0x2000, 0
    s_lshl_b32 s62, s62, 10
    s_lshl_b32 s7, s17, 6
    s_add_u32 s62, s62, s7
    s_movk_i32 s61, 0x4000
    s_cmp_eq_u32 s3, 2
    s_cselect_b32 s60, 0x10000, s60
    s_cselect_b32 s61, 0x2000, s61
    s_add_u32 s63, s16, s17
    s_waitcnt lgkmcnt(0)
    s_branch e_done
e_4:
    s_cmp_lg_u32 s3, 5
    s_cbranch_scc1 e_5
    s_getpc_b64 s[40:41]
code_pc:
    s_sub_u32 s40, s40, code_pc-interleave_layers__sliding_block__glu_gated_glu__prompt_kernel
    s_subb_u32 s41, s41, 0
    s_bfe_u32 s6, s2, 0x30003
    s_lshl_b32 s6, s6, 13
    v_lshlrev_b32 v24, 7, v0
    v_add_u32 v24, s6, v24
    v_min_u32 v24, code_end-interleave_layers__sliding_block__glu_gated_glu__prompt_kernel-4, v24
    global_load_dword v191, v24, s[40:41]
    s_mov_b64 exec, -1
    v_lshlrev_b32 v24, 7, v0
    s_mul_i32 s56, s2, 6144
    s_mov_b32 exec_hi, 0xffff
    s_waitcnt lgkmcnt(0)
    buffer_load_dword v190, v24, s[48:51], s56 offen
    s_mov_b64 exec, -1
e_5:
    s_cmp_lg_u32 s3, 4
    s_cbranch_scc1 e_done
    v_and_b32 v24, 15, v0
    v_lshlrev_b32 v24, 15, v24
    v_bfe_u32 v25, v0, 4, 1
    v_mul_u32_u24 v25, 98304, v25
    v_lshl_add_u32 v24, v25, 8, v24
    s_lshl4_add_u32 s56, s16, s17
    s_lshl_b32 s56, s56, 7
    s_add_u32 s56, s56, 0x1500000
    s_waitcnt lgkmcnt(0)
    buffer_load_dword v191, v24, s[8:11], s56 offen sc1
e_done:
    s_waitcnt lgkmcnt(0)
    s_mov_b32 s6, 0x1578000
    s_buffer_load_dword s86, s[8:11], s6
    s_and_b32 s6, s2, 7
    s_lshr_b32 s7, s2, 3
    s_lshr_b32 s56, s6, 0
    s_mul_i32 s18, s56, 2
    s_lshr_b32 s56, s7, 4
    s_add_u32 s18, s18, s56
    s_and_b32 s56, s6, 0
    s_mul_i32 s19, s56, 16
    s_and_b32 s56, s7, 15
    s_add_u32 s19, s19, s56
    s_lshr_b32 s56, s6, 1
    s_mul_i32 s20, s56, 4
    s_lshr_b32 s56, s7, 3
    s_add_u32 s20, s20, s56
    s_and_b32 s56, s6, 1
    s_mul_i32 s21, s56, 8
    s_and_b32 s56, s7, 7
    s_add_u32 s21, s21, s56
    s_mov_b32 s22, 0
    s_sub_u32 s23, 7, s3
    s_cmp_lt_u32 s3, 4
    s_cselect_b32 s5, s3, s23
    s_lshl2_add_u32 s4, s16, s5
    s_lshl_b32 s24, s4, 15
    s_lshl_b32 s56, s17, 11
    s_add_u32 s24, s24, s56
    s_lshr_b32 s56, s3, 2
    s_lshl_b32 s56, s56, 10
    s_add_u32 s24, s24, s56
    s_add_u32 s24, s24, 0x800000
    s_mov_b32 s52, -1
    s_mov_b32 s53, 0
    s_lshl_b32 s80, s16, 11
    s_lshl_b32 s56, s17, 7
    s_add_u32 s80, s80, s56
    s_add_u32 s80, s80, 0x1500000
    s_lshl_b32 s81, s17, 17
    s_min_u32 s82, s16, 2
    s_mul_i32 s84, s21, 229376
    s_lshl_b32 s56, s3, 10
    s_add_u32 s84, s84, s56
    s_add_u32 s84, s84, 0x3600000
    s_and_b32 s56, s3, 1
    s_mul_i32 s83, s56, 12480
    s_add_u32 s83, s83, 131072
    s_mov_b32 s25, 0
    s_mov_b32 s26, 0
    s_mov_b32 s27, 0
    s_mov_b32 s28, 0
    s_mov_b32 s29, 0
    s_mov_b32 s30, 0
    s_mov_b32 s31, 0
    s_mov_b32 s32, 0
    s_mov_b32 s33, 0
    s_mov_b32 s34, 0
    s_mov_b32 s35, 0
    s_mov_b32 s36, 0
    s_mov_b32 s37, 0
    s_mov_b32 s38, 0
    s_mov_b32 s39, 0
    s_mov_b32 s40, 0
    s_mov_b32 s54, 0
    s_mov_b32 s55, 0
    v_mov_b32 v2, 0
    v_mov_b32 v3, 0
    v_mov_b32 v4, 0
    v_mov_b32 v5, 0
    v_mov_b32 v6, 0
    v_mov_b32 v7, 0
    v_mov_b32 v8, 0
    v_mov_b32 v9, 0
    v_mov_b32 v10, 0
    v_mov_b32 v11, 0
    v_mov_b32 v14, 0
    v_mov_b32 v15, 0
    s_cmp_eq_u32 s3, 7
    s_cbranch_scc1 h0_start
    s_cmp_eq_u32 s3, 6
    s_cbranch_scc1 h1_start
    s_cmp_ge_u32 s3, 4
    s_cbranch_scc1 h2_start
    v_add_u32 v2, 0x10000, v1
    v_add_u32 v3, 0x20000, v1
    s_lshr_b32 s7, s3, 1
    s_lshl_b32 s56, s7, 12
    v_lshrrev_b32 v4, 5, v0
    v_lshlrev_b32 v4, 9, v4
    v_bfe_u32 v5, v0, 2, 2
    v_lshl_add_u32 v4, v5, 7, v4
    v_bfe_u32 v5, v0, 3, 1
    v_xor_b32 v5, s7, v5
    v_lshl_add_u32 v4, v5, 6, v4
    v_bfe_u32 v5, v0, 4, 1
    v_lshl_add_u32 v4, v5, 5, v4
    v_and_b32 v5, 3, v0
    v_lshl_add_u32 v4, v5, 3, v4
    v_add_u32 v4, s56, v4
    v_add_u32 v5, 0x10000, v4
    v_add_u32 v6, 0x20000, v4
    v_xor_b32 v7, 64, v4
    v_xor_b32 v8, 64, v5
    v_xor_b32 v9, 64, v6
    v_lshlrev_b32 v11, 3, v0
    v_and_b32 v10, 0xff, v11
    v_add_u32 v10, 157056, v10
    s_lshl_b32 s25, s4, 15
    s_lshl_b32 s26, s4, 10
    s_add_u32 s26, s26, 0x1400000
    s_lshl_b32 s56, s17, 17
    s_lshl_b32 s57, s4, 10
    s_add_u32 s56, s56, s57
    s_add_u32 s27, s56, 0x400000
    s_add_u32 s28, s56, 0x600000
    s_add_u32 s40, s56, 0xa00000
    s_and_b32 s6, s3, 1
    s_lshr_b32 s56, s19, 1
    s_and_b32 s56, s56, 2
    s_add_u32 s6, s6, s56
    s_lshl2_add_u32 s6, s18, s6
    s_and_b32 s56, s19, 3
    s_lshr_b32 s57, s19, 3
    s_lshl2_add_u32 s56, s57, s56
    s_lshl1_add_u32 s56, s56, s7
    s_lshl_b32 s57, s6, 15
    s_lshl_b32 s58, s7, 14
    s_add_u32 s29, s57, s58
    s_add_u32 s29, s29, 0x800000
    s_lshl_b32 s58, s56, 11
    s_add_u32 s30, s57, s58
    s_add_u32 s31, s30, 0x200000
    s_add_u32 s38, s30, 0x1800000
    s_lshl_b32 s58, s56, 6
    s_add_u32 s42, s57, s58
    s_lshl_b32 s58, s6, 10
    s_and_b32 s59, s56, 3
    s_lshl_b32 s59, s59, 8
    s_add_u32 s58, s58, s59
    s_add_u32 s32, s58, 0x1410000
    s_add_u32 s39, s58, 0x2c00000
    s_mul_i32 s37, s6, 114688
    s_mul_i32 s58, s7, 57344
    s_add_u32 s37, s37, s58
    s_add_u32 s37, s37, 0xc00000
    s_lshl2_add_u32 s6, s20, s3
    s_lshl_b32 s33, s6, 15
    s_add_u32 s33, s33, 0x200000
    s_lshl_b32 s34, s6, 10
    s_add_u32 s34, s34, 0x1410000
    s_lshr_b32 s56, s21, 1
    s_mul_i32 s56, s56, 14
    s_mul_i32 s57, s6, 112
    s_add_u32 s56, s56, s57
    s_and_b32 s57, s21, 1
    s_add_u32 s36, s56, s57
    s_add_u32 s36, s36, 6
    s_lshl_b32 s36, s36, 10
    s_add_u32 s36, s36, 0xc00000
    s_lshl3_add_u32 s35, s57, s56
    s_lshl_b32 s35, s35, 10
    s_add_u32 s35, s35, 0xc00000
    s_add_u32 s56, s16, s17
    s_add_u32 s66, s56, 0
    s_and_b32 s66, s66, 3
    s_lshl_b32 s66, s66, 13
    s_add_u32 s67, s56, 1
    s_and_b32 s67, s67, 3
    s_lshl_b32 s67, s67, 13
    s_add_u32 s68, s56, 2
    s_and_b32 s68, s68, 3
    s_lshl_b32 s68, s68, 13
    s_add_u32 s69, s56, 3
    s_and_b32 s69, s69, 3
    s_lshl_b32 s69, s69, 13
    s_add_u32 s56, s20, s21
    s_add_u32 s70, s56, 0
    s_and_b32 s70, s70, 3
    s_lshl_b32 s70, s70, 13
    s_add_u32 s71, s56, 1
    s_and_b32 s71, s71, 3
    s_lshl_b32 s71, s71, 13
    s_add_u32 s72, s56, 2
    s_and_b32 s72, s72, 3
    s_lshl_b32 s72, s72, 13
    s_add_u32 s73, s56, 3
    s_and_b32 s73, s73, 3
    s_lshl_b32 s73, s73, 13
    s_lshr_b32 s56, s19, 2
    s_add_u32 s56, s56, s19
    s_lshl1_add_u32 s56, s18, s56
    s_add_u32 s74, s56, 0
    s_and_b32 s74, s74, 3
    s_lshl_b32 s74, s74, 10
    s_add_u32 s75, s56, 1
    s_and_b32 s75, s75, 3
    s_lshl_b32 s75, s75, 10
    s_add_u32 s76, s56, 2
    s_and_b32 s76, s76, 3
    s_lshl_b32 s76, s76, 10
    s_add_u32 s77, s56, 3
    s_and_b32 s77, s77, 3
    s_lshl_b32 s77, s77, 10
    s_cmp_lg_u32 s3, 0
    s_cbranch_scc1 c_p0q
    s_lshl_b32 s63, s16, 11
    s_lshl2_add_u32 s63, s17, s63
    s_add_u32 s63, s63, 0x1500000
    v_lshlrev_b32 v27, 7, v0
    v_mov_b32 v24, 0
    v_mov_b32 v25, 0
    s_waitcnt vmcnt(7)
    v_permlane32_swap_b32 v128, v130
    v_permlane32_swap_b32 v129, v131
    buffer_store_dwordx4 v[128:131], v1, s[8:11], s60 offen offset:0 sc1
    s_waitcnt vmcnt(7)
    v_permlane32_swap_b32 v132, v134
    v_permlane32_swap_b32 v133, v135
    buffer_store_dwordx4 v[132:135], v1, s[8:11], s60 offen offset:1024 sc1
    s_waitcnt vmcnt(7)
    v_permlane32_swap_b32 v136, v138
    v_permlane32_swap_b32 v137, v139
    buffer_store_dwordx4 v[136:139], v1, s[8:11], s60 offen offset:2048 sc1
    s_waitcnt vmcnt(7)
    v_permlane32_swap_b32 v140, v142
    v_permlane32_swap_b32 v141, v143
    buffer_store_dwordx4 v[140:143], v1, s[8:11], s60 offen offset:3072 sc1
    s_waitcnt vmcnt(7)
    v_permlane32_swap_b32 v144, v146
    v_permlane32_swap_b32 v145, v147
    buffer_store_dwordx4 v[144:147], v1, s[8:11], s61 offen offset:0 sc1
    s_waitcnt vmcnt(7)
    v_permlane32_swap_b32 v148, v150
    v_permlane32_swap_b32 v149, v151
    buffer_store_dwordx4 v[148:151], v1, s[8:11], s61 offen offset:1024 sc1
    s_waitcnt vmcnt(7)
    v_permlane32_swap_b32 v152, v154
    v_permlane32_swap_b32 v153, v155
    buffer_store_dwordx4 v[152:155], v1, s[8:11], s61 offen offset:2048 sc1
    s_waitcnt vmcnt(7)
    v_permlane32_swap_b32 v156, v158
    v_permlane32_swap_b32 v157, v159
    buffer_store_dwordx4 v[156:159], v1, s[8:11], s61 offen offset:3072 sc1
    v_dot2c_f32_bf16 v24, 0x3f803f80, v128
    v_dot2c_f32_bf16 v25, v128, v128
    v_dot2c_f32_bf16 v24, 0x3f803f80, v129
    v_dot2c_f32_bf16 v25, v129, v129
    v_dot2c_f32_bf16 v24, 0x3f803f80, v130
    v_dot2c_f32_bf16 v25, v130, v130
    v_dot2c_f32_bf16 v24, 0x3f803f80, v131
    v_dot2c_f32_bf16 v25, v131, v131
    v_dot2c_f32_bf16 v24, 0x3f803f80, v132
    v_dot2c_f32_bf16 v25, v132, v132
    v_dot2c_f32_bf16 v24, 0x3f803f80, v133
    v_dot2c_f32_bf16 v25, v133, v133
    v_dot2c_f32_bf16 v24, 0x3f803f80, v134
    v_dot2c_f32_bf16 v25, v134, v134
    v_dot2c_f32_bf16 v24, 0x3f803f80, v135
    v_dot2c_f32_bf16 v25, v135, v135
    v_dot2c_f32_bf16 v24, 0x3f803f80, v136
    v_dot2c_f32_bf16 v25, v136, v136
    v_dot2c_f32_bf16 v24, 0x3f803f80, v137
    v_dot2c_f32_bf16 v25, v137, v137
    v_dot2c_f32_bf16 v24, 0x3f803f80, v138
    v_dot2c_f32_bf16 v25, v138, v138
    v_dot2c_f32_bf16 v24, 0x3f803f80, v139
    v_dot2c_f32_bf16 v25, v139, v139
    v_dot2c_f32_bf16 v24, 0x3f803f80, v140
    v_dot2c_f32_bf16 v25, v140, v140
    v_dot2c_f32_bf16 v24, 0x3f803f80, v141
    v_dot2c_f32_bf16 v25, v141, v141
    v_dot2c_f32_bf16 v24, 0x3f803f80, v142
    v_dot2c_f32_bf16 v25, v142, v142
    v_dot2c_f32_bf16 v24, 0x3f803f80, v143
    v_dot2c_f32_bf16 v25, v143, v143
    v_dot2c_f32_bf16 v24, 0x3f803f80, v144
    v_dot2c_f32_bf16 v25, v144, v144
    v_dot2c_f32_bf16 v24, 0x3f803f80, v145
    v_dot2c_f32_bf16 v25, v145, v145
    v_dot2c_f32_bf16 v24, 0x3f803f80, v146
    v_dot2c_f32_bf16 v25, v146, v146
    v_dot2c_f32_bf16 v24, 0x3f803f80, v147
    v_dot2c_f32_bf16 v25, v147, v147
    v_dot2c_f32_bf16 v24, 0x3f803f80, v148
    v_dot2c_f32_bf16 v25, v148, v148
    v_dot2c_f32_bf16 v24, 0x3f803f80, v149
    v_dot2c_f32_bf16 v25, v149, v149
    v_dot2c_f32_bf16 v24, 0x3f803f80, v150
    v_dot2c_f32_bf16 v25, v150, v150
    v_dot2c_f32_bf16 v24, 0x3f803f80, v151
    v_dot2c_f32_bf16 v25, v151, v151
    v_dot2c_f32_bf16 v24, 0x3f803f80, v152
    v_dot2c_f32_bf16 v25, v152, v152
    v_dot2c_f32_bf16 v24, 0x3f803f80, v153
    v_dot2c_f32_bf16 v25, v153, v153
    v_dot2c_f32_bf16 v24, 0x3f803f80, v154
    v_dot2c_f32_bf16 v25, v154, v154
    v_dot2c_f32_bf16 v24, 0x3f803f80, v155
    v_dot2c_f32_bf16 v25, v155, v155
    v_dot2c_f32_bf16 v24, 0x3f803f80, v156
    v_dot2c_f32_bf16 v25, v156, v156
    v_dot2c_f32_bf16 v24, 0x3f803f80, v157
    v_dot2c_f32_bf16 v25, v157, v157
    v_dot2c_f32_bf16 v24, 0x3f803f80, v158
    v_dot2c_f32_bf16 v25, v158, v158
    v_dot2c_f32_bf16 v24, 0x3f803f80, v159
    v_dot2c_f32_bf16 v25, v159, v159
    s_nop 2
    v_permlane32_swap_b32 v24, v25
    v_add_f32 v24, v24, v25
    buffer_store_dword v24, v28, s[8:11], s62 offen sc1
    s_barrier
    s_waitcnt lgkmcnt(0)
    s_add_u32 s86, s86, 0x9e3779b9
    s_mov_b32 s87, s86
    v_mov_b32 v26, s86
    s_waitcnt vmcnt(0)
    s_mov_b64 exec, 0xffff
    buffer_atomic_swap v26, v27, s[8:11], s63 offen sc1
    s_mov_b64 exec, -1
    s_barrier
    s_branch c_loop
c_p0q:
    v_lshrrev_b32 v29, 5, v0
    v_lshlrev_b32 v29, 8, v29
    v_bfe_u32 v31, v0, 2, 2
    v_lshl_add_u32 v29, v31, 6, v29
    v_bfe_u32 v31, v0, 4, 1
    v_lshl_add_u32 v29, v31, 5, v29
    v_and_b32 v31, 3, v0
    v_lshl_add_u32 v29, v31, 3, v29
    v_add_u32 v29, s60, v29
    v_add_u32 v28, s60, v1
    v_mov_b32 v24, 0
    s_barrier
    s_add_u32 s6, s63, 0
    s_and_b32 s6, s6, 3
    s_mul_i32 s6, s6, 393216
    s_add_u32 s6, s6, s62
    s_mul_i32 s7, s61, 0
    s_add_u32 s7, s7, s60
    s_add_u32 m0, s7, 0
    s_nop 0
    buffer_load_dwordx4 v27, s[48:51], s6 offen lds
    buffer_load_dwordx4 v26, s[48:51], s6 offen offset:1024 lds
    s_add_u32 s6, s6, 98304
    s_add_u32 m0, s7, 2048
    s_nop 0
    buffer_load_dwordx4 v27, s[48:51], s6 offen lds
    buffer_load_dwordx4 v26, s[48:51], s6 offen offset:1024 lds
    s_add_u32 s6, s6, 98304
    s_add_u32 m0, s7, 4096
    s_nop 0
    buffer_load_dwordx4 v27, s[48:51], s6 offen lds
    buffer_load_dwordx4 v26, s[48:51], s6 offen offset:1024 lds
    s_add_u32 s6, s6, 98304
    s_add_u32 m0, s7, 6144
    s_nop 0
    buffer_load_dwordx4 v27, s[48:51], s6 offen lds
    buffer_load_dwordx4 v26, s[48:51], s6 offen offset:1024 lds
    s_add_u32 s6, s63, 1
    s_and_b32 s6, s6, 3
    s_mul_i32 s6, s6, 393216
    s_add_u32 s6, s6, s62
    s_mul_i32 s7, s61, 1
    s_add_u32 s7, s7, s60
    s_add_u32 m0, s7, 0
    s_nop 0
    buffer_load_dwordx4 v27, s[48:51], s6 offen lds
    buffer_load_dwordx4 v26, s[48:51], s6 offen offset:1024 lds
    s_add_u32 s6, s6, 98304
    s_add_u32 m0, s7, 2048
    s_nop 0
    buffer_load_dwordx4 v27, s[48:51], s6 offen lds
    buffer_load_dwordx4 v26, s[48:51], s6 offen offset:1024 lds
    s_add_u32 s6, s6, 98304
    s_add_u32 m0, s7, 4096
    s_nop 0
    buffer_load_dwordx4 v27, s[48:51], s6 offen lds
    buffer_load_dwordx4 v26, s[48:51], s6 offen offset:1024 lds
    s_add_u32 s6, s6, 98304
    s_add_u32 m0, s7, 6144
    s_nop 0
    buffer_load_dwordx4 v27, s[48:51], s6 offen lds
    buffer_load_dwordx4 v26, s[48:51], s6 offen offset:1024 lds
    s_waitcnt vmcnt(8)
    ds_read_b64_tr_b16 v[128:129], v29 offset:0
    ds_read_b64_tr_b16 v[130:131], v29 offset:512
    ds_read_b64_tr_b16 v[132:133], v29 offset:1024
    ds_read_b64_tr_b16 v[134:135], v29 offset:1536
    ds_read_b64_tr_b16 v[136:137], v29 offset:2048
    ds_read_b64_tr_b16 v[138:139], v29 offset:2560
    ds_read_b64_tr_b16 v[140:141], v29 offset:3072
    ds_read_b64_tr_b16 v[142:143], v29 offset:3584
    ds_read_b64_tr_b16 v[144:145], v29 offset:4096
    ds_read_b64_tr_b16 v[146:147], v29 offset:4608
    ds_read_b64_tr_b16 v[148:149], v29 offset:5120
    ds_read_b64_tr_b16 v[150:151], v29 offset:5632
    ds_read_b64_tr_b16 v[152:153], v29 offset:6144
    ds_read_b64_tr_b16 v[154:155], v29 offset:6656
    ds_read_b64_tr_b16 v[156:157], v29 offset:7168
    ds_read_b64_tr_b16 v[158:159], v29 offset:7680
    s_add_u32 s6, s63, 2
    s_and_b32 s6, s6, 3
    s_mul_i32 s6, s6, 393216
    s_add_u32 s6, s6, s62
    s_mul_i32 s7, s61, 2
    s_add_u32 s7, s7, s60
    s_add_u32 m0, s7, 0
    s_nop 0
    buffer_load_dwordx4 v27, s[48:51], s6 offen lds
    buffer_load_dwordx4 v26, s[48:51], s6 offen offset:1024 lds
    s_add_u32 s6, s6, 98304
    s_add_u32 m0, s7, 2048
    s_nop 0
    buffer_load_dwordx4 v27, s[48:51], s6 offen lds
    buffer_load_dwordx4 v26, s[48:51], s6 offen offset:1024 lds
    s_add_u32 s6, s6, 98304
    s_add_u32 m0, s7, 4096
    s_nop 0
    buffer_load_dwordx4 v27, s[48:51], s6 offen lds
    buffer_load_dwordx4 v26, s[48:51], s6 offen offset:1024 lds
    s_add_u32 s6, s6, 98304
    s_add_u32 m0, s7, 6144
    s_nop 0
    buffer_load_dwordx4 v27, s[48:51], s6 offen lds
    buffer_load_dwordx4 v26, s[48:51], s6 offen offset:1024 lds
    s_waitcnt lgkmcnt(0)
    ds_write_b128 v28, v[128:131] offset:0
    v_dot2c_f32_bf16 v24, 0x3f803f80, v128
    v_dot2c_f32_bf16 v24, 0x3f803f80, v129
    v_dot2c_f32_bf16 v24, 0x3f803f80, v130
    v_dot2c_f32_bf16 v24, 0x3f803f80, v131
    ds_write_b128 v28, v[132:135] offset:1024
    v_dot2c_f32_bf16 v24, 0x3f803f80, v132
    v_dot2c_f32_bf16 v24, 0x3f803f80, v133
    v_dot2c_f32_bf16 v24, 0x3f803f80, v134
    v_dot2c_f32_bf16 v24, 0x3f803f80, v135
    ds_write_b128 v28, v[136:139] offset:2048
    v_dot2c_f32_bf16 v24, 0x3f803f80, v136
    v_dot2c_f32_bf16 v24, 0x3f803f80, v137
    v_dot2c_f32_bf16 v24, 0x3f803f80, v138
    v_dot2c_f32_bf16 v24, 0x3f803f80, v139
    ds_write_b128 v28, v[140:143] offset:3072
    v_dot2c_f32_bf16 v24, 0x3f803f80, v140
    v_dot2c_f32_bf16 v24, 0x3f803f80, v141
    v_dot2c_f32_bf16 v24, 0x3f803f80, v142
    v_dot2c_f32_bf16 v24, 0x3f803f80, v143
    ds_write_b128 v28, v[144:147] offset:4096
    v_dot2c_f32_bf16 v24, 0x3f803f80, v144
    v_dot2c_f32_bf16 v24, 0x3f803f80, v145
    v_dot2c_f32_bf16 v24, 0x3f803f80, v146
    v_dot2c_f32_bf16 v24, 0x3f803f80, v147
    ds_write_b128 v28, v[148:151] offset:5120
    v_dot2c_f32_bf16 v24, 0x3f803f80, v148
    v_dot2c_f32_bf16 v24, 0x3f803f80, v149
    v_dot2c_f32_bf16 v24, 0x3f803f80, v150
    v_dot2c_f32_bf16 v24, 0x3f803f80, v151
    ds_write_b128 v28, v[152:155] offset:6144
    v_dot2c_f32_bf16 v24, 0x3f803f80, v152
    v_dot2c_f32_bf16 v24, 0x3f803f80, v153
    v_dot2c_f32_bf16 v24, 0x3f803f80, v154
    v_dot2c_f32_bf16 v24, 0x3f803f80, v155
    ds_write_b128 v28, v[156:159] offset:7168
    v_dot2c_f32_bf16 v24, 0x3f803f80, v156
    v_dot2c_f32_bf16 v24, 0x3f803f80, v157
    v_dot2c_f32_bf16 v24, 0x3f803f80, v158
    v_dot2c_f32_bf16 v24, 0x3f803f80, v159
    v_add_u32 v28, s61, v28
    v_add_u32 v29, s61, v29
    s_waitcnt vmcnt(8)
    ds_read_b64_tr_b16 v[160:161], v29 offset:0
    ds_read_b64_tr_b16 v[162:163], v29 offset:512
    ds_read_b64_tr_b16 v[164:165], v29 offset:1024
    ds_read_b64_tr_b16 v[166:167], v29 offset:1536
    ds_read_b64_tr_b16 v[168:169], v29 offset:2048
    ds_read_b64_tr_b16 v[170:171], v29 offset:2560
    ds_read_b64_tr_b16 v[172:173], v29 offset:3072
    ds_read_b64_tr_b16 v[174:175], v29 offset:3584
    ds_read_b64_tr_b16 v[176:177], v29 offset:4096
    ds_read_b64_tr_b16 v[178:179], v29 offset:4608
    ds_read_b64_tr_b16 v[180:181], v29 offset:5120
    ds_read_b64_tr_b16 v[182:183], v29 offset:5632
    ds_read_b64_tr_b16 v[184:185], v29 offset:6144
    ds_read_b64_tr_b16 v[186:187], v29 offset:6656
    ds_read_b64_tr_b16 v[188:189], v29 offset:7168
    ds_read_b64_tr_b16 v[190:191], v29 offset:7680
    s_add_u32 s6, s63, 3
    s_and_b32 s6, s6, 3
    s_mul_i32 s6, s6, 393216
    s_add_u32 s6, s6, s62
    s_mul_i32 s7, s61, 3
    s_add_u32 s7, s7, s60
    s_add_u32 m0, s7, 0
    s_nop 0
    buffer_load_dwordx4 v27, s[48:51], s6 offen lds
    buffer_load_dwordx4 v26, s[48:51], s6 offen offset:1024 lds
    s_add_u32 s6, s6, 98304
    s_add_u32 m0, s7, 2048
    s_nop 0
    buffer_load_dwordx4 v27, s[48:51], s6 offen lds
    buffer_load_dwordx4 v26, s[48:51], s6 offen offset:1024 lds
    s_add_u32 s6, s6, 98304
    s_add_u32 m0, s7, 4096
    s_nop 0
    buffer_load_dwordx4 v27, s[48:51], s6 offen lds
    buffer_load_dwordx4 v26, s[48:51], s6 offen offset:1024 lds
    s_add_u32 s6, s6, 98304
    s_add_u32 m0, s7, 6144
    s_nop 0
    buffer_load_dwordx4 v27, s[48:51], s6 offen lds
    buffer_load_dwordx4 v26, s[48:51], s6 offen offset:1024 lds
    s_barrier
    s_waitcnt lgkmcnt(14)
    ds_write_b128 v28, v[160:163] offset:0
    v_dot2c_f32_bf16 v24, 0x3f803f80, v160
    v_dot2c_f32_bf16 v24, 0x3f803f80, v161
    v_dot2c_f32_bf16 v24, 0x3f803f80, v162
    v_dot2c_f32_bf16 v24, 0x3f803f80, v163
    s_waitcnt lgkmcnt(13)
    ds_write_b128 v28, v[164:167] offset:1024
    v_dot2c_f32_bf16 v24, 0x3f803f80, v164
    v_dot2c_f32_bf16 v24, 0x3f803f80, v165
    v_dot2c_f32_bf16 v24, 0x3f803f80, v166
    v_dot2c_f32_bf16 v24, 0x3f803f80, v167
    s_waitcnt lgkmcnt(12)
    ds_write_b128 v28, v[168:171] offset:2048
    v_dot2c_f32_bf16 v24, 0x3f803f80, v168
    v_dot2c_f32_bf16 v24, 0x3f803f80, v169
    v_dot2c_f32_bf16 v24, 0x3f803f80, v170
    v_dot2c_f32_bf16 v24, 0x3f803f80, v171
    s_waitcnt lgkmcnt(11)
    ds_write_b128 v28, v[172:175] offset:3072
    v_dot2c_f32_bf16 v24, 0x3f803f80, v172
    v_dot2c_f32_bf16 v24, 0x3f803f80, v173
    v_dot2c_f32_bf16 v24, 0x3f803f80, v174
    v_dot2c_f32_bf16 v24, 0x3f803f80, v175
    s_waitcnt lgkmcnt(10)
    ds_write_b128 v28, v[176:179] offset:4096
    v_dot2c_f32_bf16 v24, 0x3f803f80, v176
    v_dot2c_f32_bf16 v24, 0x3f803f80, v177
    v_dot2c_f32_bf16 v24, 0x3f803f80, v178
    v_dot2c_f32_bf16 v24, 0x3f803f80, v179
    s_waitcnt lgkmcnt(9)
    ds_write_b128 v28, v[180:183] offset:5120
    v_dot2c_f32_bf16 v24, 0x3f803f80, v180
    v_dot2c_f32_bf16 v24, 0x3f803f80, v181
    v_dot2c_f32_bf16 v24, 0x3f803f80, v182
    v_dot2c_f32_bf16 v24, 0x3f803f80, v183
    s_waitcnt lgkmcnt(8)
    ds_write_b128 v28, v[184:187] offset:6144
    v_dot2c_f32_bf16 v24, 0x3f803f80, v184
    v_dot2c_f32_bf16 v24, 0x3f803f80, v185
    v_dot2c_f32_bf16 v24, 0x3f803f80, v186
    v_dot2c_f32_bf16 v24, 0x3f803f80, v187
    s_waitcnt lgkmcnt(7)
    ds_write_b128 v28, v[188:191] offset:7168
    v_dot2c_f32_bf16 v24, 0x3f803f80, v188
    v_dot2c_f32_bf16 v24, 0x3f803f80, v189
    v_dot2c_f32_bf16 v24, 0x3f803f80, v190
    v_dot2c_f32_bf16 v24, 0x3f803f80, v191
    v_add_u32 v28, s61, v28
    v_add_u32 v29, s61, v29
    s_waitcnt vmcnt(8)
    ds_read_b64_tr_b16 v[128:129], v29 offset:0
    ds_read_b64_tr_b16 v[130:131], v29 offset:512
    ds_read_b64_tr_b16 v[132:133], v29 offset:1024
    ds_read_b64_tr_b16 v[134:135], v29 offset:1536
    ds_read_b64_tr_b16 v[136:137], v29 offset:2048
    ds_read_b64_tr_b16 v[138:139], v29 offset:2560
    ds_read_b64_tr_b16 v[140:141], v29 offset:3072
    ds_read_b64_tr_b16 v[142:143], v29 offset:3584
    ds_read_b64_tr_b16 v[144:145], v29 offset:4096
    ds_read_b64_tr_b16 v[146:147], v29 offset:4608
    ds_read_b64_tr_b16 v[148:149], v29 offset:5120
    ds_read_b64_tr_b16 v[150:151], v29 offset:5632
    ds_read_b64_tr_b16 v[152:153], v29 offset:6144
    ds_read_b64_tr_b16 v[154:155], v29 offset:6656
    ds_read_b64_tr_b16 v[156:157], v29 offset:7168
    ds_read_b64_tr_b16 v[158:159], v29 offset:7680
    s_waitcnt lgkmcnt(14)
    ds_write_b128 v28, v[128:131] offset:0
    v_dot2c_f32_bf16 v24, 0x3f803f80, v128
    v_dot2c_f32_bf16 v24, 0x3f803f80, v129
    v_dot2c_f32_bf16 v24, 0x3f803f80, v130
    v_dot2c_f32_bf16 v24, 0x3f803f80, v131
    s_waitcnt lgkmcnt(13)
    ds_write_b128 v28, v[132:135] offset:1024
    v_dot2c_f32_bf16 v24, 0x3f803f80, v132
    v_dot2c_f32_bf16 v24, 0x3f803f80, v133
    v_dot2c_f32_bf16 v24, 0x3f803f80, v134
    v_dot2c_f32_bf16 v24, 0x3f803f80, v135
    s_waitcnt lgkmcnt(12)
    ds_write_b128 v28, v[136:139] offset:2048
    v_dot2c_f32_bf16 v24, 0x3f803f80, v136
    v_dot2c_f32_bf16 v24, 0x3f803f80, v137
    v_dot2c_f32_bf16 v24, 0x3f803f80, v138
    v_dot2c_f32_bf16 v24, 0x3f803f80, v139
    s_waitcnt lgkmcnt(11)
    ds_write_b128 v28, v[140:143] offset:3072
    v_dot2c_f32_bf16 v24, 0x3f803f80, v140
    v_dot2c_f32_bf16 v24, 0x3f803f80, v141
    v_dot2c_f32_bf16 v24, 0x3f803f80, v142
    v_dot2c_f32_bf16 v24, 0x3f803f80, v143
    s_waitcnt lgkmcnt(10)
    ds_write_b128 v28, v[144:147] offset:4096
    v_dot2c_f32_bf16 v24, 0x3f803f80, v144
    v_dot2c_f32_bf16 v24, 0x3f803f80, v145
    v_dot2c_f32_bf16 v24, 0x3f803f80, v146
    v_dot2c_f32_bf16 v24, 0x3f803f80, v147
    s_waitcnt lgkmcnt(9)
    ds_write_b128 v28, v[148:151] offset:5120
    v_dot2c_f32_bf16 v24, 0x3f803f80, v148
    v_dot2c_f32_bf16 v24, 0x3f803f80, v149
    v_dot2c_f32_bf16 v24, 0x3f803f80, v150
    v_dot2c_f32_bf16 v24, 0x3f803f80, v151
    s_waitcnt lgkmcnt(8)
    ds_write_b128 v28, v[152:155] offset:6144
    v_dot2c_f32_bf16 v24, 0x3f803f80, v152
    v_dot2c_f32_bf16 v24, 0x3f803f80, v153
    v_dot2c_f32_bf16 v24, 0x3f803f80, v154
    v_dot2c_f32_bf16 v24, 0x3f803f80, v155
    s_waitcnt lgkmcnt(7)
    ds_write_b128 v28, v[156:159] offset:7168
    v_dot2c_f32_bf16 v24, 0x3f803f80, v156
    v_dot2c_f32_bf16 v24, 0x3f803f80, v157
    v_dot2c_f32_bf16 v24, 0x3f803f80, v158
    v_dot2c_f32_bf16 v24, 0x3f803f80, v159
    v_add_u32 v28, s61, v28
    v_add_u32 v29, s61, v29
    s_waitcnt vmcnt(0)
    ds_read_b64_tr_b16 v[160:161], v29 offset:0
    ds_read_b64_tr_b16 v[162:163], v29 offset:512
    ds_read_b64_tr_b16 v[164:165], v29 offset:1024
    ds_read_b64_tr_b16 v[166:167], v29 offset:1536
    ds_read_b64_tr_b16 v[168:169], v29 offset:2048
    ds_read_b64_tr_b16 v[170:171], v29 offset:2560
    ds_read_b64_tr_b16 v[172:173], v29 offset:3072
    ds_read_b64_tr_b16 v[174:175], v29 offset:3584
    ds_read_b64_tr_b16 v[176:177], v29 offset:4096
    ds_read_b64_tr_b16 v[178:179], v29 offset:4608
    ds_read_b64_tr_b16 v[180:181], v29 offset:5120
    ds_read_b64_tr_b16 v[182:183], v29 offset:5632
    ds_read_b64_tr_b16 v[184:185], v29 offset:6144
    ds_read_b64_tr_b16 v[186:187], v29 offset:6656
    ds_read_b64_tr_b16 v[188:189], v29 offset:7168
    ds_read_b64_tr_b16 v[190:191], v29 offset:7680
    s_waitcnt lgkmcnt(14)
    ds_write_b128 v28, v[160:163] offset:0
    v_dot2c_f32_bf16 v24, 0x3f803f80, v160
    v_dot2c_f32_bf16 v24, 0x3f803f80, v161
    v_dot2c_f32_bf16 v24, 0x3f803f80, v162
    v_dot2c_f32_bf16 v24, 0x3f803f80, v163
    s_waitcnt lgkmcnt(13)
    ds_write_b128 v28, v[164:167] offset:1024
    v_dot2c_f32_bf16 v24, 0x3f803f80, v164
    v_dot2c_f32_bf16 v24, 0x3f803f80, v165
    v_dot2c_f32_bf16 v24, 0x3f803f80, v166
    v_dot2c_f32_bf16 v24, 0x3f803f80, v167
    s_waitcnt lgkmcnt(12)
    ds_write_b128 v28, v[168:171] offset:2048
    v_dot2c_f32_bf16 v24, 0x3f803f80, v168
    v_dot2c_f32_bf16 v24, 0x3f803f80, v169
    v_dot2c_f32_bf16 v24, 0x3f803f80, v170
    v_dot2c_f32_bf16 v24, 0x3f803f80, v171
    s_waitcnt lgkmcnt(11)
    ds_write_b128 v28, v[172:175] offset:3072
    v_dot2c_f32_bf16 v24, 0x3f803f80, v172
    v_dot2c_f32_bf16 v24, 0x3f803f80, v173
    v_dot2c_f32_bf16 v24, 0x3f803f80, v174
    v_dot2c_f32_bf16 v24, 0x3f803f80, v175
    s_waitcnt lgkmcnt(10)
    ds_write_b128 v28, v[176:179] offset:4096
    v_dot2c_f32_bf16 v24, 0x3f803f80, v176
    v_dot2c_f32_bf16 v24, 0x3f803f80, v177
    v_dot2c_f32_bf16 v24, 0x3f803f80, v178
    v_dot2c_f32_bf16 v24, 0x3f803f80, v179
    s_waitcnt lgkmcnt(9)
    ds_write_b128 v28, v[180:183] offset:5120
    v_dot2c_f32_bf16 v24, 0x3f803f80, v180
    v_dot2c_f32_bf16 v24, 0x3f803f80, v181
    v_dot2c_f32_bf16 v24, 0x3f803f80, v182
    v_dot2c_f32_bf16 v24, 0x3f803f80, v183
    s_waitcnt lgkmcnt(8)
    ds_write_b128 v28, v[184:187] offset:6144
    v_dot2c_f32_bf16 v24, 0x3f803f80, v184
    v_dot2c_f32_bf16 v24, 0x3f803f80, v185
    v_dot2c_f32_bf16 v24, 0x3f803f80, v186
    v_dot2c_f32_bf16 v24, 0x3f803f80, v187
    s_waitcnt lgkmcnt(7)
    ds_write_b128 v28, v[188:191] offset:7168
    v_dot2c_f32_bf16 v24, 0x3f803f80, v188
    v_dot2c_f32_bf16 v24, 0x3f803f80, v189
    v_dot2c_f32_bf16 v24, 0x3f803f80, v190
    v_dot2c_f32_bf16 v24, 0x3f803f80, v191
    v_add_u32 v28, s61, v28
    v_add_u32 v29, s61, v29
    s_nop 0
    v_mov_b32 v25, v24
    s_nop 1
    v_permlane32_swap_b32 v24, v25
    v_add_f32 v24, v24, v25
    v_cvt_pk_bf16_f32 v30, v24, v24
    v_lshlrev_b32 v25, 16, v30
    v_sub_f32 v25, v24, v25
    v_cvt_pk_bf16_f32 v31, v25, 0
    s_lshl_b32 s6, s3, 8
    s_sub_u32 s6, s6, 256
    v_add_u32 v25, s6, v10
    ds_write_b64 v25, v[30:31]
    s_lshr_b32 s6, s16, 2
    s_sub_u32 s6, s6, s63
    s_and_b32 s6, s6, 3
    s_mul_i32 s6, s6, s61
    s_add_u32 s6, s6, s60
    s_and_b32 s7, s16, 3
    s_lshl_b32 s7, s7, 11
    s_add_u32 s6, s6, s7
    v_add_u32 v25, s6, v1
    ds_read_b128 v[128:131], v25
    ds_read_b128 v[132:135], v25 offset:1024
    s_mul_i32 s6, s17, 3
    s_add_u32 s6, s6, s3
    s_sub_u32 s6, s6, 1
    s_lshl_b32 s6, s6, 15
    s_lshl_b32 s7, s16, 11
    s_add_u32 s6, s6, s7
    s_add_u32 s6, s6, 0x3400000
    s_waitcnt lgkmcnt(1)
    buffer_store_dwordx4 v[128:131], v1, s[8:11], s6 offen offset:0 sc1
    s_waitcnt lgkmcnt(0)
    buffer_store_dwordx4 v[132:135], v1, s[8:11], s6 offen offset:1024 sc1
    s_waitcnt lgkmcnt(0)
    s_waitcnt lgkmcnt(0)
    s_add_u32 s86, s86, 0x9e3779b9
    s_mov_b32 s87, s86
c_loop:
    s_lshl_b32 s56, s3, 8
    s_add_u32 s56, s56, 156032
    v_and_b32 v22, 31, v0
    v_lshlrev_b32 v22, 2, v22
    v_add_u32 v22, s56, v22
    v_lshrrev_b32 v16, 5, v0
    v_lshlrev_b32 v23, 4, v16
    v_add_u32 v23, s56, v23
    v_bfe_u32 v17, v0, 4, 1
    v_and_b32 v18, 15, v0
    v_lshlrev_b32 v18, 4, v18
    v_lshl_add_u32 v18, v16, 8, v18
    v_lshl_add_u32 v60, v17, 16, v18
    v_mul_u32_u24 v17, 12480, v17
    v_add_u32 v62, v18, v17
    s_mul_i32 s56, s3, 1040
    s_add_u32 s56, s56, 139392
    v_add_u32 v62, s56, v62
    s_lshl_b32 s56, s3, 10
    v_add_u32 v61, s56, v1
    v_add_u32 v63, 159616, v61
    v_add_u32 v61, 114688, v61
    s_add_u32 s57, s27, 0x10000
    s_barrier
    s_add_u32 s58, s25, s66
    buffer_load_dwordx4 v[128:131], v1, s[8:11], s58 offen offset:0 sc1
    buffer_load_dwordx4 v[132:135], v1, s[8:11], s58 offen offset:1024 sc1
    buffer_load_dwordx4 v[136:139], v1, s[8:11], s58 offen offset:2048 sc1
    buffer_load_dwordx4 v[140:143], v1, s[8:11], s58 offen offset:3072 sc1
    s_add_u32 s58, s58, 0x1000
    buffer_load_dwordx4 v[144:147], v1, s[8:11], s58 offen offset:0 sc1
    buffer_load_dwordx4 v[148:151], v1, s[8:11], s58 offen offset:1024 sc1
    buffer_load_dwordx4 v[152:155], v1, s[8:11], s58 offen offset:2048 sc1
    buffer_load_dwordx4 v[156:159], v1, s[8:11], s58 offen offset:3072 sc1
    s_barrier
    ds_read_b128 v[24:27], v1 offset:0
    ds_read_b128 v[28:31], v1 offset:8192
    ds_read_b128 v[32:35], v1 offset:1024
    ds_read_b128 v[36:39], v1 offset:9216
    ds_read_b128 v[40:43], v1 offset:2048
    s_waitcnt lgkmcnt(3)
    s_waitcnt vmcnt(7)
    v_mfma_f32_32x32x16_bf16 v[64:79], v[24:27], v[128:131], 0
    ds_read_b128 v[44:47], v1 offset:10240
    v_mfma_f32_32x32x16_bf16 v[96:111], v[28:31], v[128:131], 0
    ds_read_b128 v[24:27], v1 offset:3072
    s_add_u32 s58, s25, s67
    buffer_load_dwordx4 v[160:163], v1, s[8:11], s58 offen offset:0 sc1
    buffer_load_dwordx2 v[112:113], v11, s[8:11], s26 offen offset:0 sc1
    buffer_load_dwordx2 v[114:115], v11, s[8:11], s26 offen offset:512 sc1
    buffer_load_dwordx4 v[164:167], v1, s[8:11], s58 offen offset:1024 sc1
    s_waitcnt lgkmcnt(3)
    s_waitcnt vmcnt(10)
    v_mfma_f32_32x32x16_bf16 v[64:79], v[32:35], v[132:135], v[64:79]
    ds_read_b128 v[28:31], v1 offset:11264
    v_mfma_f32_32x32x16_bf16 v[96:111], v[36:39], v[132:135], v[96:111]
    ds_read_b128 v[32:35], v1 offset:4096
    buffer_load_dwordx4 v[168:171], v1, s[8:11], s58 offen offset:2048 sc1
    buffer_load_dwordx4 v[172:175], v1, s[8:11], s58 offen offset:3072 sc1
    s_waitcnt lgkmcnt(3)
    s_waitcnt vmcnt(11)
    v_mfma_f32_32x32x16_bf16 v[64:79], v[40:43], v[136:139], v[64:79]
    ds_read_b128 v[36:39], v1 offset:12288
    v_mfma_f32_32x32x16_bf16 v[96:111], v[44:47], v[136:139], v[96:111]
    ds_read_b128 v[40:43], v1 offset:5120
    s_add_u32 s58, s58, 0x1000
    buffer_load_dwordx4 v[176:179], v1, s[8:11], s58 offen offset:0 sc1
    s_waitcnt lgkmcnt(3)
    s_waitcnt vmcnt(11)
    v_mfma_f32_32x32x16_bf16 v[64:79], v[24:27], v[140:143], v[64:79]
    ds_read_b128 v[44:47], v1 offset:13312
    v_mfma_f32_32x32x16_bf16 v[96:111], v[28:31], v[140:143], v[96:111]
    ds_read_b128 v[24:27], v1 offset:6144
    buffer_load_dwordx4 v[180:183], v1, s[8:11], s58 offen offset:1024 sc1
    s_waitcnt lgkmcnt(3)
    s_waitcnt vmcnt(11)
    v_mfma_f32_32x32x16_bf16 v[64:79], v[32:35], v[144:147], v[64:79]
    ds_read_b128 v[28:31], v1 offset:14336
    v_mfma_f32_32x32x16_bf16 v[96:111], v[36:39], v[144:147], v[96:111]
    ds_read_b128 v[32:35], v1 offset:7168
    buffer_load_dwordx4 v[184:187], v1, s[8:11], s58 offen offset:2048 sc1
    s_waitcnt lgkmcnt(3)
    s_waitcnt vmcnt(11)
    v_mfma_f32_32x32x16_bf16 v[64:79], v[40:43], v[148:151], v[64:79]
    ds_read_b128 v[36:39], v1 offset:15360
    v_mfma_f32_32x32x16_bf16 v[96:111], v[44:47], v[148:151], v[96:111]
    s_barrier
    ds_read_b128 v[40:43], v1 offset:16384
    buffer_load_dwordx4 v[188:191], v1, s[8:11], s58 offen offset:3072 sc1
    s_waitcnt lgkmcnt(3)
    s_waitcnt vmcnt(11)
    v_mfma_f32_32x32x16_bf16 v[64:79], v[24:27], v[152:155], v[64:79]
    ds_read_b128 v[44:47], v1 offset:24576
    v_mfma_f32_32x32x16_bf16 v[96:111], v[28:31], v[152:155], v[96:111]
    ds_read_b128 v[24:27], v1 offset:17408
    s_add_u32 s58, s25, s68
    buffer_load_dwordx4 v[192:195], v1, s[8:11], s58 offen offset:0 sc1
    s_waitcnt lgkmcnt(3)
    s_waitcnt vmcnt(11)
    v_mfma_f32_32x32x16_bf16 v[64:79], v[32:35], v[156:159], v[64:79]
    ds_read_b128 v[28:31], v1 offset:25600
    v_mfma_f32_32x32x16_bf16 v[96:111], v[36:39], v[156:159], v[96:111]
    ds_read_b128 v[32:35], v1 offset:18432
    buffer_load_dwordx4 v[196:199], v1, s[8:11], s58 offen offset:1024 sc1
    s_waitcnt lgkmcnt(3)
    s_waitcnt vmcnt(11)
    v_mfma_f32_32x32x16_bf16 v[64:79], v[40:43], v[160:163], v[64:79]
    ds_read_b128 v[36:39], v1 offset:26624
    v_mfma_f32_32x32x16_bf16 v[96:111], v[44:47], v[160:163], v[96:111]
    ds_read_b128 v[40:43], v1 offset:19456
    buffer_load_dwordx4 v[200:203], v1, s[8:11], s58 offen offset:2048 sc1
    s_waitcnt lgkmcnt(3)
    s_waitcnt vmcnt(9)
    v_mfma_f32_32x32x16_bf16 v[64:79], v[24:27], v[164:167], v[64:79]
    ds_read_b128 v[44:47], v1 offset:27648
    v_mfma_f32_32x32x16_bf16 v[96:111], v[28:31], v[164:167], v[96:111]
    ds_read_b128 v[24:27], v1 offset:20480
    buffer_load_dwordx4 v[204:207], v1, s[8:11], s58 offen offset:3072 sc1
    s_waitcnt lgkmcnt(3)
    s_waitcnt vmcnt(9)
    v_mfma_f32_32x32x16_bf16 v[64:79], v[32:35], v[168:171], v[64:79]
    ds_read_b128 v[28:31], v1 offset:28672
    v_mfma_f32_32x32x16_bf16 v[96:111], v[36:39], v[168:171], v[96:111]
    ds_read_b128 v[32:35], v1 offset:21504
    s_add_u32 s58, s58, 0x1000
    buffer_load_dwordx4 v[208:211], v1, s[8:11], s58 offen offset:0 sc1
    s_waitcnt lgkmcnt(3)
    s_waitcnt vmcnt(9)
    v_mfma_f32_32x32x16_bf16 v[64:79], v[40:43], v[172:175], v[64:79]
    v_add_f32 v112, v112, v114
    v_add_f32 v113, v113, v115
    ds_read_b128 v[36:39], v1 offset:29696
    v_mfma_f32_32x32x16_bf16 v[96:111], v[44:47], v[172:175], v[96:111]
    v_mov_b32 v114, v112
    ds_read_b128 v[40:43], v1 offset:22528
    buffer_load_dwordx4 v[212:215], v1, s[8:11], s58 offen offset:1024 sc1
    s_waitcnt lgkmcnt(3)
    s_waitcnt vmcnt(9)
    v_mfma_f32_32x32x16_bf16 v[64:79], v[24:27], v[176:179], v[64:79]
    v_mov_b32 v115, v113
    v_permlane32_swap_b32 v112, v114
    ds_read_b128 v[44:47], v1 offset:30720
    v_mfma_f32_32x32x16_bf16 v[96:111], v[28:31], v[176:179], v[96:111]
    ds_read_b128 v[24:27], v1 offset:23552
    buffer_load_dwordx4 v[216:219], v1, s[8:11], s58 offen offset:2048 sc1
    s_waitcnt lgkmcnt(3)
    s_waitcnt vmcnt(9)
    v_mfma_f32_32x32x16_bf16 v[64:79], v[32:35], v[180:183], v[64:79]
    v_permlane32_swap_b32 v113, v115
    ds_read_b128 v[28:31], v1 offset:31744
    v_mfma_f32_32x32x16_bf16 v[96:111], v[36:39], v[180:183], v[96:111]
    v_add_f32 v112, v112, v114
    v_add_f32 v113, v113, v115
    s_barrier
    ds_read_b128 v[32:35], v1 offset:32768
    buffer_load_dwordx4 v[220:223], v1, s[8:11], s58 offen offset:3072 sc1
    s_waitcnt lgkmcnt(3)
    s_waitcnt vmcnt(9)
    v_mfma_f32_32x32x16_bf16 v[64:79], v[40:43], v[184:187], v[64:79]
    v_mul_f32 v112, 0xbb000000, v112
    v_mul_f32 v113, 0x3b000000, v113
    ds_read_b128 v[36:39], v1 offset:40960
    v_mfma_f32_32x32x16_bf16 v[96:111], v[44:47], v[184:187], v[96:111]
    v_fma_f32 v113, -v112, v112, v113
    ds_read_b128 v[40:43], v1 offset:33792
    s_add_u32 s58, s25, s69
    buffer_load_dwordx4 v[224:227], v1, s[8:11], s58 offen offset:0 sc1
    s_waitcnt lgkmcnt(3)
    s_waitcnt vmcnt(9)
    v_mfma_f32_32x32x16_bf16 v[64:79], v[24:27], v[188:191], v[64:79]
    v_cndmask_b32 v112, 0, v112, s[52:53]
    v_max_f32 v113, 0, v113
    ds_read_b128 v[44:47], v1 offset:41984
    v_mfma_f32_32x32x16_bf16 v[96:111], v[28:31], v[188:191], v[96:111]
    v_cvt_pk_bf16_f32 v13, v112, 0
    v_add_f32 v113, 0x3727c5ac, v113
    ds_read_b128 v[24:27], v1 offset:34816
    buffer_load_dwordx4 v[228:231], v1, s[8:11], s58 offen offset:1024 sc1
    s_waitcnt lgkmcnt(3)
    s_waitcnt vmcnt(9)
    v_mfma_f32_32x32x16_bf16 v[64:79], v[32:35], v[192:195], v[64:79]
    v_lshlrev_b32 v114, 16, v13
    ds_read_b128 v[28:31], v1 offset:43008
    v_mfma_f32_32x32x16_bf16 v[96:111], v[36:39], v[192:195], v[96:111]
    v_rsq_f32 v20, v113
    ds_read_b128 v[32:35], v1 offset:35840
    buffer_load_dwordx4 v[232:235], v1, s[8:11], s58 offen offset:2048 sc1
    s_waitcnt lgkmcnt(3)
    s_waitcnt vmcnt(9)
    v_mfma_f32_32x32x16_bf16 v[64:79], v[40:43], v[196:199], v[64:79]
    v_sub_f32 v114, v112, v114
    v_mov_b32 v14, 0
    ds_read_b128 v[36:39], v1 offset:44032
    v_mfma_f32_32x32x16_bf16 v[96:111], v[44:47], v[196:199], v[96:111]
    v_mov_b32 v15, 0
    ds_read_b128 v[40:43], v1 offset:36864
    buffer_load_dwordx4 v[236:239], v1, s[8:11], s58 offen offset:3072 sc1
    s_waitcnt lgkmcnt(3)
    s_waitcnt vmcnt(9)
    v_mfma_f32_32x32x16_bf16 v[64:79], v[24:27], v[200:203], v[64:79]
    v_cvt_pk_bf16_f32 v12, v112, v114
    ds_write_b32 v22, v20
    ds_read_b128 v[44:47], v1 offset:45056
    v_mfma_f32_32x32x16_bf16 v[96:111], v[28:31], v[200:203], v[96:111]
    v_mul_f32 v21, 0x3eb8aa3b, v20
    ds_read_b128 v[112:115], v23 offset:0
    ds_read_b128 v[24:27], v1 offset:37888
    s_add_u32 s58, s58, 0x1000
    buffer_load_dwordx4 v[240:243], v1, s[8:11], s58 offen offset:0 sc1
    s_waitcnt lgkmcnt(5)
    s_waitcnt vmcnt(9)
    v_mfma_f32_32x32x16_bf16 v[64:79], v[32:35], v[204:207], v[64:79]
    ds_read_b128 v[116:119], v23 offset:32
    ds_read_b128 v[28:31], v1 offset:46080
    v_mfma_f32_32x32x16_bf16 v[96:111], v[36:39], v[204:207], v[96:111]
    ds_read_b128 v[120:123], v23 offset:64
    ds_read_b128 v[124:127], v23 offset:96
    ds_read_b128 v[32:35], v1 offset:38912
    buffer_load_dwordx4 v[244:247], v1, s[8:11], s58 offen offset:1024 sc1
    s_waitcnt lgkmcnt(7)
    s_waitcnt vmcnt(9)
    v_mfma_f32_32x32x16_bf16 v[64:79], v[40:43], v[208:211], v[64:79]
    ds_read_b128 v[36:39], v1 offset:47104
    v_mfma_f32_32x32x16_bf16 v[96:111], v[44:47], v[208:211], v[96:111]
    ds_read_b128 v[40:43], v1 offset:39936
    buffer_load_dwordx4 v[248:251], v1, s[8:11], s58 offen offset:2048 sc1
    s_waitcnt lgkmcnt(5)
    s_waitcnt vmcnt(9)
    v_mfma_f32_32x32x16_bf16 v[64:79], v[24:27], v[212:215], v[64:79]
    ds_read_b128 v[44:47], v1 offset:48128
    v_mfma_f32_32x32x16_bf16 v[96:111], v[28:31], v[212:215], v[96:111]
    s_barrier
    ds_read_b128 v[24:27], v1 offset:49152
    buffer_load_dwordx4 v[252:255], v1, s[8:11], s58 offen offset:3072 sc1
    s_waitcnt lgkmcnt(3)
    s_waitcnt vmcnt(9)
    v_mfma_f32_32x32x16_bf16 v[64:79], v[32:35], v[216:219], v[64:79]
    ds_read_b128 v[28:31], v1 offset:57344
    v_mfma_f32_32x32x16_bf16 v[96:111], v[36:39], v[216:219], v[96:111]
    ds_read_b128 v[32:35], v1 offset:50176
    s_waitcnt lgkmcnt(3)
    s_waitcnt vmcnt(8)
    v_mfma_f32_32x32x16_bf16 v[64:79], v[40:43], v[220:223], v[64:79]
    ds_read_b128 v[36:39], v1 offset:58368
    v_mfma_f32_32x32x16_bf16 v[96:111], v[44:47], v[220:223], v[96:111]
    ds_read_b128 v[40:43], v1 offset:51200
    s_waitcnt lgkmcnt(3)
    s_waitcnt vmcnt(7)
    v_mfma_f32_32x32x16_bf16 v[64:79], v[24:27], v[224:227], v[64:79]
    ds_read_b128 v[44:47], v1 offset:59392
    v_mfma_f32_32x32x16_bf16 v[96:111], v[28:31], v[224:227], v[96:111]
    ds_read_b128 v[24:27], v1 offset:52224
    s_waitcnt lgkmcnt(3)
    s_waitcnt vmcnt(6)
    v_mfma_f32_32x32x16_bf16 v[64:79], v[32:35], v[228:231], v[64:79]
    ds_read_b128 v[28:31], v1 offset:60416
    v_mfma_f32_32x32x16_bf16 v[96:111], v[36:39], v[228:231], v[96:111]
    ds_read_b128 v[32:35], v1 offset:53248
    s_waitcnt lgkmcnt(3)
    s_waitcnt vmcnt(5)
    v_mfma_f32_32x32x16_bf16 v[64:79], v[40:43], v[232:235], v[64:79]
    ds_read_b128 v[36:39], v1 offset:61440
    v_mfma_f32_32x32x16_bf16 v[96:111], v[44:47], v[232:235], v[96:111]
    ds_read_b128 v[40:43], v1 offset:54272
    s_waitcnt lgkmcnt(3)
    s_waitcnt vmcnt(4)
    v_mfma_f32_32x32x16_bf16 v[64:79], v[24:27], v[236:239], v[64:79]
    ds_read_b128 v[44:47], v1 offset:62464
    v_mfma_f32_32x32x16_bf16 v[96:111], v[28:31], v[236:239], v[96:111]
    ds_read_b128 v[24:27], v1 offset:55296
    s_waitcnt lgkmcnt(3)
    s_waitcnt vmcnt(3)
    v_mfma_f32_32x32x16_bf16 v[64:79], v[32:35], v[240:243], v[64:79]
    ds_read_b128 v[28:31], v1 offset:63488
    v_mfma_f32_32x32x16_bf16 v[96:111], v[36:39], v[240:243], v[96:111]
    ds_read_b128 v[32:35], v1 offset:56320
    s_waitcnt lgkmcnt(3)
    s_waitcnt vmcnt(2)
    v_mfma_f32_32x32x16_bf16 v[64:79], v[40:43], v[244:247], v[64:79]
    ds_read_b128 v[36:39], v1 offset:64512
    v_mfma_f32_32x32x16_bf16 v[96:111], v[44:47], v[244:247], v[96:111]
    ds_read_b64 v[40:41], v10 offset:0
    s_waitcnt lgkmcnt(3)
    s_waitcnt vmcnt(1)
    v_mfma_f32_32x32x16_bf16 v[64:79], v[24:27], v[248:251], v[64:79]
    ds_read_b64 v[44:45], v10 offset:512
    v_mfma_f32_32x32x16_bf16 v[96:111], v[28:31], v[248:251], v[96:111]
    ds_read_b64 v[24:25], v10 offset:256
    s_waitcnt lgkmcnt(3)
    s_waitcnt vmcnt(0)
    v_mfma_f32_32x32x16_bf16 v[64:79], v[32:35], v[252:255], v[64:79]
    s_barrier
    ds_read_b128 v[28:31], v2 offset:0
    v_mfma_f32_32x32x16_bf16 v[96:111], v[36:39], v[252:255], v[96:111]
    ds_read_b128 v[32:35], v2 offset:1024
    s_waitcnt lgkmcnt(3)
    v_mfma_f32_32x32x16_bf16 v[64:79], v[40:43], v[12:15], v[64:79]
    ds_read_b128 v[36:39], v2 offset:2048
    v_mfma_f32_32x32x16_bf16 v[96:111], v[44:47], v[12:15], v[96:111]
    ds_read_b128 v[40:43], v2 offset:3072
    s_waitcnt lgkmcnt(3)
    v_mfma_f32_32x32x16_bf16 v[80:95], v[12:15], v[24:27], 0
    ds_read_b128 v[44:47], v2 offset:4096
    v_mfma_f32_32x32x16_bf16 v[80:95], v[128:131], v[28:31], v[80:95]
    ds_read_b128 v[24:27], v2 offset:5120
    s_waitcnt lgkmcnt(3)
    v_mfma_f32_32x32x16_bf16 v[80:95], v[132:135], v[32:35], v[80:95]
    s_nop 1
    v_mul_f32 v64, v20, v64
    v_mul_f32 v65, v20, v65
    v_mul_f32 v66, v20, v66
    v_mul_f32 v67, v20, v67
    v_mul_f32 v68, v20, v68
    v_mul_f32 v69, v20, v69
    v_mul_f32 v70, v20, v70
    ds_read_b128 v[28:31], v2 offset:6144
    v_mfma_f32_32x32x16_bf16 v[80:95], v[136:139], v[36:39], v[80:95]
    v_mul_f32 v71, v20, v71
    v_mul_f32 v72, v20, v72
    v_mul_f32 v73, v20, v73
    v_mul_f32 v74, v20, v74
    v_mul_f32 v75, v20, v75
    v_mul_f32 v76, v20, v76
    v_mul_f32 v77, v20, v77
    ds_read_b128 v[32:35], v2 offset:7168
    s_waitcnt lgkmcnt(3)
    v_mfma_f32_32x32x16_bf16 v[80:95], v[140:143], v[40:43], v[80:95]
    v_mul_f32 v78, v20, v78
    v_mul_f32 v79, v20, v79
    v_cvt_pk_bf16_f32 v48, v64, v65
    v_cvt_pk_bf16_f32 v49, v66, v67
    v_cvt_pk_bf16_f32 v50, v68, v69
    v_cvt_pk_bf16_f32 v51, v70, v71
    v_cvt_pk_bf16_f32 v52, v72, v73
    ds_read_b128 v[36:39], v2 offset:8192
    v_mfma_f32_32x32x16_bf16 v[80:95], v[144:147], v[44:47], v[80:95]
    v_cvt_pk_bf16_f32 v53, v74, v75
    v_cvt_pk_bf16_f32 v54, v76, v77
    v_cvt_pk_bf16_f32 v55, v78, v79
    buffer_store_dwordx4 v[48:51], v1, s[8:11], s27 offen offset:0 sc1
    buffer_store_dwordx4 v[52:55], v1, s[8:11], s57 offen offset:0 sc1
    ds_write_b128 v61, v[48:51]
    ds_write_b128 v61, v[52:55] offset:12288
    ds_read_b128 v[40:43], v2 offset:9216
    s_waitcnt lgkmcnt(5)
    v_mfma_f32_32x32x16_bf16 v[80:95], v[148:151], v[24:27], v[80:95]
    ds_read_b128 v[44:47], v2 offset:10240
    v_mfma_f32_32x32x16_bf16 v[80:95], v[152:155], v[28:31], v[80:95]
    v_mul_f32 v96, v21, v96
    v_mul_f32 v97, v21, v97
    v_mul_f32 v98, v21, v98
    v_mul_f32 v99, v21, v99
    ds_read_b128 v[24:27], v2 offset:11264
    s_waitcnt lgkmcnt(5)
    v_mfma_f32_32x32x16_bf16 v[80:95], v[156:159], v[32:35], v[80:95]
    v_mul_f32 v100, v21, v100
    v_mul_f32 v101, v21, v101
    v_mul_f32 v102, v21, v102
    v_mul_f32 v103, v21, v103
    ds_read_b128 v[28:31], v2 offset:12288
    v_mfma_f32_32x32x16_bf16 v[80:95], v[160:163], v[36:39], v[80:95]
    v_mul_f32 v104, v21, v104
    v_mul_f32 v105, v21, v105
    v_mul_f32 v106, v21, v106
    v_mul_f32 v107, v21, v107
    v_mul_f32 v108, v21, v108
    ds_read_b128 v[32:35], v2 offset:13312
    s_waitcnt lgkmcnt(3)
    v_mfma_f32_32x32x16_bf16 v[80:95], v[164:167], v[40:43], v[80:95]
    v_mul_f32 v109, v21, v109
    v_mul_f32 v110, v21, v110
    v_mul_f32 v111, v21, v111
    v_cvt_pk_bf16_f32 v16, v96, v97
    ds_read_b128 v[36:39], v2 offset:14336
    v_mfma_f32_32x32x16_bf16 v[80:95], v[168:171], v[44:47], v[80:95]
    v_cvt_pk_bf16_f32 v17, v98, v99
    v_cvt_pk_bf16_f32 v18, v100, v101
    v_cvt_pk_bf16_f32 v19, v102, v103
    v_cvt_pk_bf16_f32 v56, v104, v105
    ds_read_b128 v[40:43], v2 offset:15360
    s_waitcnt lgkmcnt(3)
    v_mfma_f32_32x32x16_bf16 v[80:95], v[172:175], v[24:27], v[80:95]
    v_cvt_pk_bf16_f32 v57, v106, v107
    v_cvt_pk_bf16_f32 v58, v108, v109
    v_cvt_pk_bf16_f32 v59, v110, v111
    ds_write_b128 v63, v[56:59]
    ds_read_b128 v[44:47], v2 offset:16384
    v_mfma_f32_32x32x16_bf16 v[80:95], v[176:179], v[28:31], v[80:95]
    ds_read_b128 v[24:27], v2 offset:17408
    s_waitcnt lgkmcnt(4)
    v_mfma_f32_32x32x16_bf16 v[80:95], v[180:183], v[32:35], v[80:95]
    v_and_b32 v13, 31, v0
    v_lshrrev_b32 v56, 5, v0
    v_lshlrev_b32 v56, 2, v56
    v_sub_u32 v13, v13, v56
    v_mov_b32 v56, 0xff800000
    ds_read_b128 v[28:31], v2 offset:18432
    v_mfma_f32_32x32x16_bf16 v[80:95], v[184:187], v[36:39], v[80:95]
    s_cmp_ge_u32 s4, 8
    s_cselect_b32 s60, 0, 0xff800000
    v_mov_b32 v57, s60
    v_cmp_le_i32 vcc, 0, v13
    ds_read_b128 v[32:35], v2 offset:19456
    s_waitcnt lgkmcnt(3)
    v_mfma_f32_32x32x16_bf16 v[80:95], v[188:191], v[40:43], v[80:95]
    v_cmp_le_i32 s[62:63], 1, v13
    v_cndmask_b32 v64, v56, 0, vcc
    v_cndmask_b32 v96, v57, v56, vcc
    v_cndmask_b32 v65, v56, 0, s[62:63]
    v_cndmask_b32 v97, v57, v56, s[62:63]
    ds_read_b128 v[36:39], v2 offset:20480
    v_mfma_f32_32x32x16_bf16 v[80:95], v[192:195], v[44:47], v[80:95]
    v_cmp_le_i32 vcc, 2, v13
    v_cmp_le_i32 s[62:63], 3, v13
    s_nop 0
    v_cndmask_b32 v66, v56, 0, vcc
    v_cndmask_b32 v98, v57, v56, vcc
    ds_read_b128 v[40:43], v2 offset:21504
    s_waitcnt lgkmcnt(3)
    v_mfma_f32_32x32x16_bf16 v[80:95], v[196:199], v[24:27], v[80:95]
    v_cndmask_b32 v67, v56, 0, s[62:63]
    v_cndmask_b32 v99, v57, v56, s[62:63]
    v_cmp_le_i32 vcc, 8, v13
    v_cmp_le_i32 s[62:63], 9, v13
    s_nop 0
    v_cndmask_b32 v68, v56, 0, vcc
    ds_read_b128 v[44:47], v2 offset:22528
    v_mfma_f32_32x32x16_bf16 v[80:95], v[200:203], v[28:31], v[80:95]
    v_cndmask_b32 v100, v57, v56, vcc
    v_cndmask_b32 v69, v56, 0, s[62:63]
    v_cndmask_b32 v101, v57, v56, s[62:63]
    v_cmp_le_i32 vcc, 10, v13
    ds_read_b128 v[24:27], v2 offset:23552
    s_waitcnt lgkmcnt(3)
    v_mfma_f32_32x32x16_bf16 v[80:95], v[204:207], v[32:35], v[80:95]
    v_cmp_le_i32 s[62:63], 11, v13
    v_cndmask_b32 v70, v56, 0, vcc
    v_cndmask_b32 v102, v57, v56, vcc
    v_cndmask_b32 v71, v56, 0, s[62:63]
    v_cndmask_b32 v103, v57, v56, s[62:63]
    ds_read_b128 v[28:31], v2 offset:24576
    v_mfma_f32_32x32x16_bf16 v[80:95], v[208:211], v[36:39], v[80:95]
    v_cmp_le_i32 vcc, 16, v13
    v_cmp_le_i32 s[62:63], 17, v13
    s_nop 0
    v_cndmask_b32 v72, v56, 0, vcc
    v_cndmask_b32 v104, v57, v56, vcc
    ds_read_b128 v[32:35], v2 offset:25600
    s_waitcnt vmcnt(0)
    s_barrier
    s_waitcnt lgkmcnt(3)
    v_mfma_f32_32x32x16_bf16 v[80:95], v[212:215], v[40:43], v[80:95]
    v_cndmask_b32 v73, v56, 0, s[62:63]
    v_cndmask_b32 v105, v57, v56, s[62:63]
    v_cmp_le_i32 vcc, 18, v13
    v_cmp_le_i32 s[62:63], 19, v13
    s_nop 0
    v_cndmask_b32 v74, v56, 0, vcc
    ds_read_b128 v[36:39], v2 offset:26624
    v_mfma_f32_32x32x16_bf16 v[80:95], v[216:219], v[44:47], v[80:95]
    v_cndmask_b32 v106, v57, v56, vcc
    v_cndmask_b32 v75, v56, 0, s[62:63]
    v_cndmask_b32 v107, v57, v56, s[62:63]
    v_cmp_le_i32 vcc, 24, v13
    v_cmp_le_i32 s[62:63], 25, v13
    ds_read_b128 v[40:43], v2 offset:27648
    s_waitcnt lgkmcnt(3)
    v_mfma_f32_32x32x16_bf16 v[80:95], v[220:223], v[24:27], v[80:95]
    v_cndmask_b32 v76, v56, 0, vcc
    v_cndmask_b32 v108, v57, v56, vcc
    v_cndmask_b32 v77, v56, 0, s[62:63]
    v_cndmask_b32 v109, v57, v56, s[62:63]
    ds_read_b128 v[44:47], v2 offset:28672
    v_mfma_f32_32x32x16_bf16 v[80:95], v[224:227], v[28:31], v[80:95]
    v_cmp_le_i32 vcc, 26, v13
    v_cmp_le_i32 s[62:63], 27, v13
    s_nop 0
    v_cndmask_b32 v78, v56, 0, vcc
    v_cndmask_b32 v110, v57, v56, vcc
    v_cndmask_b32 v79, v56, 0, s[62:63]
    ds_read_b128 v[24:27], v2 offset:29696
    s_waitcnt lgkmcnt(3)
    v_mfma_f32_32x32x16_bf16 v[80:95], v[228:231], v[32:35], v[80:95]
    v_cndmask_b32 v111, v57, v56, s[62:63]
    s_lshr_b32 s61, s3, 2
    s_mul_i32 s61, s61, 12
    s_add_u32 s61, s61, s5
    ds_read_b128 v[28:31], v2 offset:30720
    v_mfma_f32_32x32x16_bf16 v[80:95], v[232:235], v[36:39], v[80:95]
    s_lshl_b32 s60, s61, 10
    s_add_u32 s60, s60, 106496
    v_add_u32 v20, s60, v1
    v_lshrrev_b32 v21, 5, v0
    v_lshlrev_b32 v21, 8, v21
    ds_read_b128 v[32:35], v2 offset:31744
    s_waitcnt lgkmcnt(3)
    v_mfma_f32_32x32x16_bf16 v[80:95], v[236:239], v[40:43], v[80:95]
    v_and_b32 v12, 15, v0
    v_lshl_add_u32 v21, v12, 4, v21
    v_add_u32 v22, 0x200, v21
    v_and_b32 v12, 16, v0
    v_mfma_f32_32x32x16_bf16 v[80:95], v[240:243], v[44:47], v[80:95]
    v_cmp_ne_u32 vcc, 0, v12
    v_mov_b32 v12, 0x400
    s_nop 0
    v_cndmask_b32 v21, v21, v12, vcc
    v_cndmask_b32 v22, v22, v12, vcc
    s_mul_i32 s60, s61, 1040
    s_waitcnt lgkmcnt(1)
    v_mfma_f32_32x32x16_bf16 v[80:95], v[244:247], v[24:27], v[80:95]
    s_add_u32 s60, s60, 131072
    v_add_u32 v21, s60, v21
    v_add_u32 v22, s60, v22
    s_lshl_b32 s60, s16, 12
    v_mfma_f32_32x32x16_bf16 v[80:95], v[248:251], v[28:31], v[80:95]
    s_sub_u32 s60, s60, 8192
    v_add_u32 v12, s60, v1
    v_min_u32 v14, 0x80000000, v12
    v_add_u32 v12, 0x1000, v12
    v_min_u32 v15, 0x80000000, v12
    s_waitcnt lgkmcnt(0)
    v_mfma_f32_32x32x16_bf16 v[80:95], v[252:255], v[32:35], v[80:95]
    s_nop 11
    v_pk_mul_f32 v[80:81], v[80:81], v[112:113]
    v_pk_mul_f32 v[82:83], v[82:83], v[114:115]
    v_pk_mul_f32 v[84:85], v[84:85], v[116:117]
    v_pk_mul_f32 v[86:87], v[86:87], v[118:119]
    v_cvt_pk_bf16_f32 v48, v80, v81
    v_cvt_pk_bf16_f32 v49, v82, v83
    v_cvt_pk_bf16_f32 v50, v84, v85
    v_cvt_pk_bf16_f32 v51, v86, v87
    buffer_store_dwordx4 v[48:51], v60, s[8:11], s28 offen offset:0 sc1
    v_pk_mul_f32 v[88:89], v[88:89], v[120:121]
    v_pk_mul_f32 v[90:91], v[90:91], v[122:123]
    v_pk_mul_f32 v[92:93], v[92:93], v[124:125]
    v_pk_mul_f32 v[94:95], v[94:95], v[126:127]
    v_cvt_pk_bf16_f32 v52, v88, v89
    v_cvt_pk_bf16_f32 v53, v90, v91
    v_cvt_pk_bf16_f32 v54, v92, v93
    v_cvt_pk_bf16_f32 v55, v94, v95
    buffer_store_dwordx4 v[52:55], v60, s[8:11], s28 offen offset:512 sc1
    ds_write_b128 v62, v[48:51]
    ds_write_b128 v62, v[52:55] offset:512
    s_waitcnt lgkmcnt(0)
    s_barrier
attn:
    ds_read_b128 v[32:35], v20 offset:8192
    ds_read_b128 v[40:43], v21 offset:8320
    ds_read_b128 v[44:47], v22 offset:8320
    s_waitcnt lgkmcnt(0)
    v_mfma_f32_32x32x16_bf16 v[80:95], v[32:35], v[16:19], v[64:79]
    ds_read_b128 v[36:39], v20 offset:7168
    s_nop 10
    v_exp_f32 v80, v80
    v_exp_f32 v81, v81
    v_exp_f32 v82, v82
    v_exp_f32 v83, v83
    v_exp_f32 v84, v84
    v_exp_f32 v85, v85
    v_exp_f32 v86, v86
    v_exp_f32 v87, v87
    s_waitcnt lgkmcnt(0)
    v_mfma_f32_32x32x16_bf16 v[112:127], v[36:39], v[16:19], 0
    v_cvt_pk_bf16_f32 v128, v80, v81
    v_cvt_pk_bf16_f32 v129, v82, v83
    v_cvt_pk_bf16_f32 v130, v84, v85
    v_cvt_pk_bf16_f32 v131, v86, v87
    v_exp_f32 v88, v88
    v_exp_f32 v89, v89
    v_mfma_f32_32x32x16_bf16 v[176:191], v[40:43], v[128:131], 0
    v_exp_f32 v90, v90
    v_exp_f32 v91, v91
    v_exp_f32 v92, v92
    v_exp_f32 v93, v93
    v_exp_f32 v94, v94
    v_exp_f32 v95, v95
    v_cvt_pk_bf16_f32 v132, v88, v89
    v_cvt_pk_bf16_f32 v133, v90, v91
    v_cvt_pk_bf16_f32 v134, v92, v93
    v_cvt_pk_bf16_f32 v135, v94, v95
    s_cmp_eq_u32 s3, 6
    s_cbranch_scc1 attn_s2
    s_cmp_ge_u32 s3, 4
    s_cbranch_scc1 attn_s0
    s_waitcnt vmcnt(0)
attn_s0:
    s_barrier
    s_and_b32 s56, s3, 6
    s_cmp_lg_u32 s56, 4
    s_cbranch_scc1 attn_s1
    s_add_u32 m0, s36, 24576
    s_mul_i32 s56, s75, 64
    s_add_u32 s56, s56, s34
    s_add_u32 s56, s56, 32768
    buffer_load_dwordx4 v5, s[88:91], s56 offen offset:0  lds
    buffer_load_dwordx4 v6, s[88:91], s56 offen offset:1024  lds
    s_mul_i32 s56, s75, 64
    s_add_u32 s56, s56, s34
    s_add_u32 s56, s56, 47104
    buffer_load_dwordx4 v5, s[88:91], s56 offen offset:2048  lds
    buffer_load_dwordx4 v6, s[88:91], s56 offen offset:3072  lds
    s_add_u32 m0, s36, 32768
    s_mul_i32 s56, s76, 64
    s_add_u32 s56, s56, s34
    s_add_u32 s56, s56, 0
    buffer_load_dwordx4 v5, s[88:91], s56 offen offset:0  lds
    buffer_load_dwordx4 v6, s[88:91], s56 offen offset:1024  lds
    s_mul_i32 s56, s76, 64
    s_add_u32 s56, s56, s34
    s_add_u32 s56, s56, 14336
    buffer_load_dwordx4 v5, s[88:91], s56 offen offset:2048  lds
    buffer_load_dwordx4 v6, s[88:91], s56 offen offset:3072  lds
    s_add_u32 m0, s36, 40960
    s_mul_i32 s56, s76, 64
    s_add_u32 s56, s56, s34
    s_add_u32 s56, s56, 32768
    buffer_load_dwordx4 v5, s[88:91], s56 offen offset:0  lds
    buffer_load_dwordx4 v6, s[88:91], s56 offen offset:1024  lds
    s_mul_i32 s56, s76, 64
    s_add_u32 s56, s56, s34
    s_add_u32 s56, s56, 47104
    buffer_load_dwordx4 v5, s[88:91], s56 offen offset:2048  lds
    buffer_load_dwordx4 v6, s[88:91], s56 offen offset:3072  lds
attn_s1:
    s_cmp_lg_u32 s3, 7
    s_cbranch_scc1 attn_s2
    s_cmp_ge_u32 s16, 15
    s_cbranch_scc1 attn_s3
    s_add_u32 s56, s80, 0x10000
    s_mov_b64 exec, s[54:55]
    buffer_atomic_swap v10, v7, s[8:11], s56 offen sc1
    s_mov_b64 exec, -1
attn_s3:
    s_cmp_lg_u32 s22, 0
    s_cbranch_scc1 attn_s2
    s_add_u32 s58, s28, 0x48000
    s_mov_b32 s59, 100000
poll1:
    s_sub_u32 s59, s59, 1
    s_cbranch_scc1 poll1_done
    s_buffer_load_dwordx16 s[64:79], s[8:11], s58 glc
    s_waitcnt lgkmcnt(0)
    s_cmp_lg_u64 s[64:65], s[86:87]
    s_cbranch_scc1 poll1
    s_cmp_lg_u64 s[66:67], s[86:87]
    s_cbranch_scc1 poll1
    s_cmp_lg_u64 s[68:69], s[86:87]
    s_cbranch_scc1 poll1
    s_cmp_lg_u64 s[70:71], s[86:87]
    s_cbranch_scc1 poll1
    s_cmp_lg_u64 s[72:73], s[86:87]
    s_cbranch_scc1 poll1
    s_cmp_lg_u64 s[74:75], s[86:87]
    s_cbranch_scc1 poll1
    s_cmp_lg_u64 s[76:77], s[86:87]
    s_cbranch_scc1 poll1
    s_cmp_lg_u64 s[78:79], s[86:87]
    s_cbranch_scc1 poll1
poll1_done:
attn_s2:
    s_cmp_lg_u32 s5, 0
    s_cbranch_scc1 attn_g0
    s_barrier
    ds_read_b128 v[36:39], v20 offset:7168
    s_waitcnt lgkmcnt(0)
    v_mfma_f32_32x32x16_bf16 v[112:127], v[36:39], v[16:19], 0
    s_nop 11
attn_g0:
    ds_read_b128 v[32:35], v20 offset:6144
    v_exp_f32 v112, v112
    v_exp_f32 v113, v113
    v_mfma_f32_32x32x16_bf16 v[176:191], v[44:47], v[132:135], v[176:191]
    v_exp_f32 v114, v114
    v_exp_f32 v115, v115
    v_exp_f32 v116, v116
    v_exp_f32 v117, v117
    v_exp_f32 v118, v118
    v_exp_f32 v119, v119
    s_waitcnt lgkmcnt(0)
    v_mfma_f32_32x32x16_bf16 v[80:95], v[32:35], v[16:19], 0
    v_cvt_pk_bf16_f32 v136, v112, v113
    v_cvt_pk_bf16_f32 v137, v114, v115
    v_cvt_pk_bf16_f32 v138, v116, v117
    v_cvt_pk_bf16_f32 v139, v118, v119
    v_exp_f32 v120, v120
    v_exp_f32 v121, v121
    v_exp_f32 v122, v122
    v_exp_f32 v123, v123
    v_exp_f32 v124, v124
    v_exp_f32 v125, v125
    v_exp_f32 v126, v126
    v_exp_f32 v127, v127
    v_cvt_pk_bf16_f32 v140, v120, v121
    v_cvt_pk_bf16_f32 v141, v122, v123
    v_cvt_pk_bf16_f32 v142, v124, v125
    v_cvt_pk_bf16_f32 v143, v126, v127
    s_cmp_lg_u32 s5, 1
    s_cbranch_scc1 attn_g1
    s_waitcnt vmcnt(0)
    s_barrier
    ds_read_b128 v[32:35], v20 offset:6144
    s_waitcnt lgkmcnt(0)
    v_mfma_f32_32x32x16_bf16 v[80:95], v[32:35], v[16:19], 0
    s_nop 11
attn_g1:
    ds_read_b128 v[36:39], v20 offset:5120
    v_exp_f32 v80, v80
    v_exp_f32 v81, v81
    v_exp_f32 v82, v82
    v_exp_f32 v83, v83
    v_exp_f32 v84, v84
    v_exp_f32 v85, v85
    v_exp_f32 v86, v86
    v_exp_f32 v87, v87
    s_waitcnt lgkmcnt(0)
    v_mfma_f32_32x32x16_bf16 v[112:127], v[36:39], v[16:19], 0
    v_cvt_pk_bf16_f32 v144, v80, v81
    v_cvt_pk_bf16_f32 v145, v82, v83
    v_cvt_pk_bf16_f32 v146, v84, v85
    v_cvt_pk_bf16_f32 v147, v86, v87
    v_exp_f32 v88, v88
    v_exp_f32 v89, v89
    v_exp_f32 v90, v90
    v_exp_f32 v91, v91
    v_exp_f32 v92, v92
    v_exp_f32 v93, v93
    v_exp_f32 v94, v94
    v_exp_f32 v95, v95
    v_cvt_pk_bf16_f32 v148, v88, v89
    v_cvt_pk_bf16_f32 v149, v90, v91
    v_cvt_pk_bf16_f32 v150, v92, v93
    v_cvt_pk_bf16_f32 v151, v94, v95
    s_cmp_lg_u32 s5, 2
    s_cbranch_scc1 attn_g2
    s_barrier
    s_cmp_ge_u32 s3, 4
    s_cbranch_scc1 attn_g2b
    s_add_u32 s58, s80, 0x10000
    s_mov_b32 s59, 100000
    s_cmp_eq_u32 s82, 0
    s_cbranch_scc1 poll2_done
poll2:
    s_sub_u32 s59, s59, 1
    s_cbranch_scc1 poll2_done
    s_buffer_load_dwordx2 s[64:65], s[8:11], s58 glc
    s_waitcnt lgkmcnt(0)
    s_cmp_eq_u32 s82, 1
    s_cselect_b32 s65, s86, s65
    s_cmp_lg_u64 s[64:65], s[86:87]
    s_cbranch_scc1 poll2
poll2_done:
    s_and_b32 s56, s3, 1
    s_lshl_b32 s56, s56, 16
    s_add_u32 s56, s56, s81
    s_add_u32 s56, s56, 0x600000
    s_add_u32 m0, s83, 0
    s_nop 0
    buffer_load_dwordx4 v14, s[8:11], s56 offen offset:0 sc1 lds
    s_add_u32 m0, s83, 16
    s_nop 0
    buffer_load_dwordx4 v14, s[8:11], s56 offen offset:1024 sc1 lds
    s_add_u32 m0, s83, 32
    s_nop 0
    buffer_load_dwordx4 v14, s[8:11], s56 offen offset:2048 sc1 lds
    s_add_u32 m0, s83, 48
    s_nop 0
    buffer_load_dwordx4 v14, s[8:11], s56 offen offset:3072 sc1 lds
    s_add_u32 m0, s83, 4160
    s_nop 0
    buffer_load_dwordx4 v15, s[8:11], s56 offen offset:0 sc1 lds
    s_add_u32 m0, s83, 4176
    s_nop 0
    buffer_load_dwordx4 v15, s[8:11], s56 offen offset:1024 sc1 lds
    s_add_u32 m0, s83, 4192
    s_nop 0
    buffer_load_dwordx4 v15, s[8:11], s56 offen offset:2048 sc1 lds
    s_add_u32 m0, s83, 4208
    s_nop 0
    buffer_load_dwordx4 v15, s[8:11], s56 offen offset:3072 sc1 lds
attn_g2b:
    s_and_b32 s56, s3, 6
    s_cmp_lg_u32 s56, 4
    s_cbranch_scc1 attn_g2d
    s_add_u32 m0, s36, 49152
    s_mul_i32 s56, s77, 64
    s_add_u32 s56, s56, s34
    s_add_u32 s56, s56, 0
    buffer_load_dwordx4 v5, s[88:91], s56 offen offset:0  lds
    buffer_load_dwordx4 v6, s[88:91], s56 offen offset:1024  lds
    s_mul_i32 s56, s77, 64
    s_add_u32 s56, s56, s34
    s_add_u32 s56, s56, 14336
    buffer_load_dwordx4 v5, s[88:91], s56 offen offset:2048  lds
    buffer_load_dwordx4 v6, s[88:91], s56 offen offset:3072  lds
    s_add_u32 m0, s36, 57344
    s_mul_i32 s56, s77, 64
    s_add_u32 s56, s56, s34
    s_add_u32 s56, s56, 32768
    buffer_load_dwordx4 v5, s[88:91], s56 offen offset:0  lds
    buffer_load_dwordx4 v6, s[88:91], s56 offen offset:1024  lds
    s_mul_i32 s56, s77, 64
    s_add_u32 s56, s56, s34
    s_add_u32 s56, s56, 47104
    buffer_load_dwordx4 v5, s[88:91], s56 offen offset:2048  lds
    buffer_load_dwordx4 v6, s[88:91], s56 offen offset:3072  lds
    s_add_u32 m0, s36, 65536
    s_add_u32 s56, s33, s70
    s_add_u32 s56, s56, 0
    buffer_load_dwordx4 v1, s[8:11], s56 offen offset:0 sc1 lds
    buffer_load_dwordx4 v1, s[8:11], s56 offen offset:1024 sc1 lds
    buffer_load_dwordx4 v1, s[8:11], s56 offen offset:2048 sc1 lds
    buffer_load_dwordx4 v1, s[8:11], s56 offen offset:3072 sc1 lds
attn_g2d:
    ds_read_b128 v[36:39], v20 offset:5120
    s_waitcnt lgkmcnt(0)
    v_mfma_f32_32x32x16_bf16 v[112:127], v[36:39], v[16:19], 0
    s_nop 11
attn_g2:
    ds_read_b128 v[32:35], v20 offset:4096
    v_exp_f32 v112, v112
    v_exp_f32 v113, v113
    v_exp_f32 v114, v114
    v_exp_f32 v115, v115
    v_exp_f32 v116, v116
    v_exp_f32 v117, v117
    v_exp_f32 v118, v118
    v_exp_f32 v119, v119
    s_waitcnt lgkmcnt(0)
    v_mfma_f32_32x32x16_bf16 v[80:95], v[32:35], v[16:19], 0
    v_cvt_pk_bf16_f32 v152, v112, v113
    v_cvt_pk_bf16_f32 v153, v114, v115
    v_cvt_pk_bf16_f32 v154, v116, v117
    v_cvt_pk_bf16_f32 v155, v118, v119
    v_exp_f32 v120, v120
    v_exp_f32 v121, v121
    v_exp_f32 v122, v122
    v_exp_f32 v123, v123
    v_exp_f32 v124, v124
    v_exp_f32 v125, v125
    v_exp_f32 v126, v126
    v_exp_f32 v127, v127
    v_cvt_pk_bf16_f32 v156, v120, v121
    v_cvt_pk_bf16_f32 v157, v122, v123
    v_cvt_pk_bf16_f32 v158, v124, v125
    v_cvt_pk_bf16_f32 v159, v126, v127
    s_cmp_lg_u32 s5, 3
    s_cbranch_scc1 attn_g3
    s_barrier
    s_cmp_ge_u32 s3, 4
    s_cbranch_scc1 attn_g3b
    s_add_u32 s58, s80, 0x10000
    s_mov_b32 s59, 100000
    s_cmp_eq_u32 s82, 0
    s_cbranch_scc1 poll3_done
poll3:
    s_sub_u32 s59, s59, 1
    s_cbranch_scc1 poll3_done
    s_buffer_load_dwordx2 s[64:65], s[8:11], s58 glc
    s_waitcnt lgkmcnt(0)
    s_cmp_eq_u32 s82, 1
    s_cselect_b32 s65, s86, s65
    s_cmp_lg_u64 s[64:65], s[86:87]
    s_cbranch_scc1 poll3
poll3_done:
    s_and_b32 s56, s3, 1
    s_lshl_b32 s56, s56, 16
    s_add_u32 s56, s56, s81
    s_add_u32 s56, s56, 0x600000
    s_add_u32 m0, s83, 0
    s_nop 0
    buffer_load_dwordx4 v14, s[8:11], s56 offen offset:0 sc1 lds
    s_add_u32 m0, s83, 16
    s_nop 0
    buffer_load_dwordx4 v14, s[8:11], s56 offen offset:1024 sc1 lds
    s_add_u32 m0, s83, 32
    s_nop 0
    buffer_load_dwordx4 v14, s[8:11], s56 offen offset:2048 sc1 lds
    s_add_u32 m0, s83, 48
    s_nop 0
    buffer_load_dwordx4 v14, s[8:11], s56 offen offset:3072 sc1 lds
    s_add_u32 m0, s83, 4160
    s_nop 0
    buffer_load_dwordx4 v15, s[8:11], s56 offen offset:0 sc1 lds
    s_add_u32 m0, s83, 4176
    s_nop 0
    buffer_load_dwordx4 v15, s[8:11], s56 offen offset:1024 sc1 lds
    s_add_u32 m0, s83, 4192
    s_nop 0
    buffer_load_dwordx4 v15, s[8:11], s56 offen offset:2048 sc1 lds
    s_add_u32 m0, s83, 4208
    s_nop 0
    buffer_load_dwordx4 v15, s[8:11], s56 offen offset:3072 sc1 lds
attn_g3b:
    s_and_b32 s56, s3, 6
    s_cmp_lg_u32 s56, 4
    s_cbranch_scc1 attn_g3d
    s_add_u32 m0, s36, 49152
    s_mul_i32 s56, s77, 64
    s_add_u32 s56, s56, s34
    s_add_u32 s56, s56, 0
    buffer_load_dwordx4 v5, s[88:91], s56 offen offset:0  lds
    buffer_load_dwordx4 v6, s[88:91], s56 offen offset:1024  lds
    s_mul_i32 s56, s77, 64
    s_add_u32 s56, s56, s34
    s_add_u32 s56, s56, 14336
    buffer_load_dwordx4 v5, s[88:91], s56 offen offset:2048  lds
    buffer_load_dwordx4 v6, s[88:91], s56 offen offset:3072  lds
    s_add_u32 m0, s36, 57344
    s_mul_i32 s56, s77, 64
    s_add_u32 s56, s56, s34
    s_add_u32 s56, s56, 32768
    buffer_load_dwordx4 v5, s[88:91], s56 offen offset:0  lds
    buffer_load_dwordx4 v6, s[88:91], s56 offen offset:1024  lds
    s_mul_i32 s56, s77, 64
    s_add_u32 s56, s56, s34
    s_add_u32 s56, s56, 47104
    buffer_load_dwordx4 v5, s[88:91], s56 offen offset:2048  lds
    buffer_load_dwordx4 v6, s[88:91], s56 offen offset:3072  lds
    s_add_u32 m0, s36, 65536
    s_add_u32 s56, s33, s70
    s_add_u32 s56, s56, 0
    buffer_load_dwordx4 v1, s[8:11], s56 offen offset:0 sc1 lds
    buffer_load_dwordx4 v1, s[8:11], s56 offen offset:1024 sc1 lds
    buffer_load_dwordx4 v1, s[8:11], s56 offen offset:2048 sc1 lds
    buffer_load_dwordx4 v1, s[8:11], s56 offen offset:3072 sc1 lds
attn_g3d:
    ds_read_b128 v[32:35], v20 offset:4096
    s_waitcnt lgkmcnt(0)
    v_mfma_f32_32x32x16_bf16 v[80:95], v[32:35], v[16:19], 0
    s_nop 11
attn_g3:
    ds_read_b128 v[36:39], v20 offset:3072
    v_exp_f32 v80, v80
    v_exp_f32 v81, v81
    v_exp_f32 v82, v82
    v_exp_f32 v83, v83
    v_exp_f32 v84, v84
    v_exp_f32 v85, v85
    v_exp_f32 v86, v86
    v_exp_f32 v87, v87
    s_waitcnt lgkmcnt(0)
    v_mfma_f32_32x32x16_bf16 v[112:127], v[36:39], v[16:19], 0
    v_cvt_pk_bf16_f32 v160, v80, v81
    v_cvt_pk_bf16_f32 v161, v82, v83
    v_cvt_pk_bf16_f32 v162, v84, v85
    v_cvt_pk_bf16_f32 v163, v86, v87
    v_exp_f32 v88, v88
    v_exp_f32 v89, v89
    v_exp_f32 v90, v90
    v_exp_f32 v91, v91
    v_exp_f32 v92, v92
    v_exp_f32 v93, v93
    v_exp_f32 v94, v94
    v_exp_f32 v95, v95
    v_cvt_pk_bf16_f32 v164, v88, v89
    v_cvt_pk_bf16_f32 v165, v90, v91
    v_cvt_pk_bf16_f32 v166, v92, v93
    v_cvt_pk_bf16_f32 v167, v94, v95
    ds_read_b128 v[32:35], v20 offset:2048
    v_exp_f32 v112, v112
    v_exp_f32 v113, v113
    v_exp_f32 v114, v114
    v_exp_f32 v115, v115
    v_exp_f32 v116, v116
    v_exp_f32 v117, v117
    v_exp_f32 v118, v118
    v_exp_f32 v119, v119
    s_waitcnt lgkmcnt(0)
    v_mfma_f32_32x32x16_bf16 v[80:95], v[32:35], v[16:19], 0
    v_cvt_pk_bf16_f32 v168, v112, v113
    v_cvt_pk_bf16_f32 v169, v114, v115
    v_cvt_pk_bf16_f32 v170, v116, v117
    v_cvt_pk_bf16_f32 v171, v118, v119
    v_exp_f32 v120, v120
    v_exp_f32 v121, v121
    v_exp_f32 v122, v122
    v_exp_f32 v123, v123
    v_exp_f32 v124, v124
    v_exp_f32 v125, v125
    v_exp_f32 v126, v126
    v_exp_f32 v127, v127
    v_cvt_pk_bf16_f32 v172, v120, v121
    v_cvt_pk_bf16_f32 v173, v122, v123
    v_cvt_pk_bf16_f32 v174, v124, v125
    v_cvt_pk_bf16_f32 v175, v126, v127
    s_cmp_ge_u32 s3, 4
    s_cbranch_scc1 attn_v0
    s_waitcnt vmcnt(0)
attn_v0:
    s_barrier
    s_and_b32 s56, s3, 6
    s_cmp_lg_u32 s56, 4
    s_cbranch_scc1 attn_nd
    s_add_u32 m0, s36, 73728
    s_add_u32 s56, s33, s70
    s_add_u32 s56, s56, 32768
    buffer_load_dwordx4 v1, s[8:11], s56 offen offset:0 sc1 lds
    buffer_load_dwordx4 v1, s[8:11], s56 offen offset:1024 sc1 lds
    buffer_load_dwordx4 v1, s[8:11], s56 offen offset:2048 sc1 lds
    buffer_load_dwordx4 v1, s[8:11], s56 offen offset:3072 sc1 lds
    s_add_u32 m0, s36, 81920
    s_add_u32 s56, s33, s70
    s_add_u32 s56, s56, 65536
    buffer_load_dwordx4 v1, s[8:11], s56 offen offset:0 sc1 lds
    buffer_load_dwordx4 v1, s[8:11], s56 offen offset:1024 sc1 lds
    buffer_load_dwordx4 v1, s[8:11], s56 offen offset:2048 sc1 lds
    buffer_load_dwordx4 v1, s[8:11], s56 offen offset:3072 sc1 lds
    s_add_u32 m0, s36, 90112
    s_add_u32 s56, s33, s71
    s_add_u32 s56, s56, 0
    buffer_load_dwordx4 v1, s[8:11], s56 offen offset:0 sc1 lds
    buffer_load_dwordx4 v1, s[8:11], s56 offen offset:1024 sc1 lds
    buffer_load_dwordx4 v1, s[8:11], s56 offen offset:2048 sc1 lds
    buffer_load_dwordx4 v1, s[8:11], s56 offen offset:3072 sc1 lds
    s_add_u32 m0, s36, 98304
    s_add_u32 s56, s33, s71
    s_add_u32 s56, s56, 32768
    buffer_load_dwordx4 v1, s[8:11], s56 offen offset:0 sc1 lds
    buffer_load_dwordx4 v1, s[8:11], s56 offen offset:1024 sc1 lds
    buffer_load_dwordx4 v1, s[8:11], s56 offen offset:2048 sc1 lds
    buffer_load_dwordx4 v1, s[8:11], s56 offen offset:3072 sc1 lds
attn_nd:
    s_cmp_lg_u32 s3, 6
    s_cbranch_scc1 h1_nwd
    s_cmp_lg_u32 s22, 0
    s_cbranch_scc1 h1_nwd
    v_lshlrev_b32 v24, 7, v0
    s_mul_i32 s56, s2, 7168
    s_mov_b32 exec_hi, 0xffffff
    buffer_load_dword v23, v24, s[92:95], s56 offen
    s_mov_b64 exec, -1
h1_nwd:
    ds_read_b128 v[48:51], v21 offset:7280
    ds_read_b128 v[52:55], v22 offset:7280
    ds_read_b128 v[40:43], v21 offset:6240
    ds_read_b128 v[36:39], v20 offset:1024
    v_exp_f32 v80, v80
    v_exp_f32 v81, v81
    s_waitcnt lgkmcnt(3)
    v_mfma_f32_32x32x16_bf16 v[176:191], v[48:51], v[136:139], v[176:191]
    ds_read_b128 v[44:47], v22 offset:6240
    v_exp_f32 v82, v82
    v_exp_f32 v83, v83
    v_exp_f32 v84, v84
    s_waitcnt lgkmcnt(3)
    v_mfma_f32_32x32x16_bf16 v[176:191], v[52:55], v[140:143], v[176:191]
    ds_read_b128 v[48:51], v21 offset:5200
    v_exp_f32 v85, v85
    v_exp_f32 v86, v86
    s_waitcnt lgkmcnt(3)
    v_mfma_f32_32x32x16_bf16 v[176:191], v[40:43], v[144:147], v[176:191]
    ds_read_b128 v[52:55], v22 offset:5200
    v_exp_f32 v87, v87
    s_waitcnt lgkmcnt(3)
    v_mfma_f32_32x32x16_bf16 v[112:127], v[36:39], v[16:19], 0
    v_cvt_pk_bf16_f32 v128, v80, v81
    v_cvt_pk_bf16_f32 v129, v82, v83
    v_cvt_pk_bf16_f32 v130, v84, v85
    v_cvt_pk_bf16_f32 v131, v86, v87
    v_exp_f32 v88, v88
    v_exp_f32 v89, v89
    s_waitcnt lgkmcnt(2)
    v_mfma_f32_32x32x16_bf16 v[176:191], v[44:47], v[148:151], v[176:191]
    ds_read_b128 v[40:43], v21 offset:4160
    v_exp_f32 v90, v90
    v_exp_f32 v91, v91
    v_exp_f32 v92, v92
    s_waitcnt lgkmcnt(2)
    v_mfma_f32_32x32x16_bf16 v[176:191], v[48:51], v[152:155], v[176:191]
    ds_read_b128 v[44:47], v22 offset:4160
    v_exp_f32 v93, v93
    v_exp_f32 v94, v94
    s_waitcnt lgkmcnt(2)
    v_mfma_f32_32x32x16_bf16 v[176:191], v[52:55], v[156:159], v[176:191]
    ds_read_b128 v[48:51], v21 offset:3120
    v_exp_f32 v95, v95
    v_cvt_pk_bf16_f32 v132, v88, v89
    v_cvt_pk_bf16_f32 v133, v90, v91
    v_cvt_pk_bf16_f32 v134, v92, v93
    v_cvt_pk_bf16_f32 v135, v94, v95
    ds_read_b128 v[32:35], v20 offset:0
    v_exp_f32 v112, v112
    v_exp_f32 v113, v113
    s_waitcnt lgkmcnt(3)
    v_mfma_f32_32x32x16_bf16 v[176:191], v[40:43], v[160:163], v[176:191]
    ds_read_b128 v[52:55], v22 offset:3120
    v_exp_f32 v114, v114
    v_exp_f32 v115, v115
    v_exp_f32 v116, v116
    s_waitcnt lgkmcnt(3)
    v_mfma_f32_32x32x16_bf16 v[176:191], v[44:47], v[164:167], v[176:191]
    ds_read_b128 v[40:43], v21 offset:2080
    v_exp_f32 v117, v117
    v_exp_f32 v118, v118
    s_waitcnt lgkmcnt(3)
    v_mfma_f32_32x32x16_bf16 v[176:191], v[48:51], v[168:171], v[176:191]
    ds_read_b128 v[44:47], v22 offset:2080
    v_exp_f32 v119, v119
    s_waitcnt lgkmcnt(3)
    v_mfma_f32_32x32x16_bf16 v[80:95], v[32:35], v[16:19], v[96:111]
    v_cvt_pk_bf16_f32 v136, v112, v113
    v_cvt_pk_bf16_f32 v137, v114, v115
    v_cvt_pk_bf16_f32 v138, v116, v117
    v_cvt_pk_bf16_f32 v139, v118, v119
    v_exp_f32 v120, v120
    v_exp_f32 v121, v121
    s_waitcnt lgkmcnt(2)
    v_mfma_f32_32x32x16_bf16 v[176:191], v[52:55], v[172:175], v[176:191]
    ds_read_b128 v[48:51], v21 offset:1040
    v_exp_f32 v122, v122
    v_exp_f32 v123, v123
    v_exp_f32 v124, v124
    s_waitcnt lgkmcnt(2)
    v_mfma_f32_32x32x16_bf16 v[176:191], v[40:43], v[128:131], v[176:191]
    ds_read_b128 v[52:55], v22 offset:1040
    v_exp_f32 v125, v125
    v_exp_f32 v126, v126
    s_waitcnt lgkmcnt(2)
    v_mfma_f32_32x32x16_bf16 v[176:191], v[44:47], v[132:135], v[176:191]
    ds_read_b128 v[40:43], v21 offset:0
    v_exp_f32 v127, v127
    v_cvt_pk_bf16_f32 v140, v120, v121
    v_cvt_pk_bf16_f32 v141, v122, v123
    v_cvt_pk_bf16_f32 v142, v124, v125
    v_cvt_pk_bf16_f32 v143, v126, v127
    v_exp_f32 v80, v80
    v_exp_f32 v81, v81
    s_waitcnt lgkmcnt(2)
    v_mfma_f32_32x32x16_bf16 v[176:191], v[48:51], v[136:139], v[176:191]
    ds_read_b128 v[44:47], v22 offset:0
    v_exp_f32 v82, v82
    v_exp_f32 v83, v83
    v_exp_f32 v84, v84
    s_waitcnt lgkmcnt(2)
    v_mfma_f32_32x32x16_bf16 v[176:191], v[52:55], v[140:143], v[176:191]
    v_exp_f32 v85, v85
    v_exp_f32 v86, v86
    v_exp_f32 v87, v87
    v_cvt_pk_bf16_f32 v144, v80, v81
    v_cvt_pk_bf16_f32 v145, v82, v83
    v_cvt_pk_bf16_f32 v146, v84, v85
    v_cvt_pk_bf16_f32 v147, v86, v87
    v_exp_f32 v88, v88
    v_exp_f32 v89, v89
    s_waitcnt lgkmcnt(1)
    v_mfma_f32_32x32x16_bf16 v[176:191], v[40:43], v[144:147], v[176:191]
    v_exp_f32 v90, v90
    v_exp_f32 v91, v91
    v_exp_f32 v92, v92
    v_exp_f32 v93, v93
    v_exp_f32 v94, v94
    v_exp_f32 v95, v95
    v_cvt_pk_bf16_f32 v148, v88, v89
    v_cvt_pk_bf16_f32 v149, v90, v91
    v_cvt_pk_bf16_f32 v150, v92, v93
    v_cvt_pk_bf16_f32 v151, v94, v95
    s_waitcnt lgkmcnt(0)
    s_nop 0
    v_mfma_f32_32x32x16_bf16 v[176:191], v[44:47], v[148:151], v[176:191]
    s_nop 11
    v_cmp_nle_f32 vcc, 0x21800000, v184
    s_mov_b32 s56, 0x5d800000
    v_cmp_nge_f32 s[58:59], s56, v184
    v_rcp_f32 v14, v184
    s_or_b64 vcc, vcc, s[58:59]
    s_cbranch_scc1 attn_exact
attn_fin:
    v_pk_mul_f32 v[176:177], v[176:177], v[14:15] op_sel_hi:[1,0]
    v_pk_mul_f32 v[178:179], v[178:179], v[14:15] op_sel_hi:[1,0]
    v_pk_mul_f32 v[180:181], v[180:181], v[14:15] op_sel_hi:[1,0]
    v_pk_mul_f32 v[182:183], v[182:183], v[14:15] op_sel_hi:[1,0]
    v_cvt_pk_bf16_f32 v56, v176, v177
    v_cvt_pk_bf16_f32 v57, v178, v179
    v_cvt_pk_bf16_f32 v58, v180, v181
    v_cvt_pk_bf16_f32 v59, v182, v183
    buffer_store_dwordx4 v[56:59], v1, s[8:11], s24 offen offset:0 sc1
    s_lshl_b32 s56, s3, 10
    v_add_u32 v20, s56, v1
    v_add_u32 v21, 0x10000, v20
    v_add_u32 v22, 0x20000, v20
    s_waitcnt vmcnt(0) lgkmcnt(0)
    s_barrier
    s_cmp_eq_u32 s3, 7
    s_cbranch_scc1 h0_post
    s_cmp_eq_u32 s3, 6
    s_cbranch_scc1 h1_post
    s_cmp_ge_u32 s3, 4
    s_cbranch_scc1 h2_post
    buffer_load_dwordx4 v[112:115], v1, s[8:11], s30 offen offset:0 sc1
    buffer_load_dwordx4 v[116:119], v1, s[8:11], s30 offen offset:1024 sc1
    s_lshl_b32 s60, s3, 12
    s_add_u32 s60, s60, 139264
    v_add_u32 v120, s60, v1
    s_xor_b32 s60, s3, 2
    s_lshl_b32 s60, s60, 12
    s_add_u32 s60, s60, 139264
    v_add_u32 v121, s60, v1
    v_lshrrev_b32 v122, 5, v0
    v_and_b32 v123, 0xff, v11
    v_lshl_add_u32 v122, v122, 2, v123
    s_waitcnt vmcnt(1)
    v_lshlrev_b32 v48, 16, v112
    v_and_b32 v49, 0xffff0000, v112
    v_lshlrev_b32 v50, 16, v113
    v_and_b32 v51, 0xffff0000, v113
    v_lshlrev_b32 v52, 16, v114
    v_and_b32 v53, 0xffff0000, v114
    v_lshlrev_b32 v54, 16, v115
    v_and_b32 v55, 0xffff0000, v115
    s_waitcnt vmcnt(0)
    v_lshlrev_b32 v56, 16, v116
    v_and_b32 v57, 0xffff0000, v116
    v_lshlrev_b32 v58, 16, v117
    v_and_b32 v59, 0xffff0000, v117
    v_lshlrev_b32 v60, 16, v118
    v_and_b32 v61, 0xffff0000, v118
    v_lshlrev_b32 v62, 16, v119
    v_and_b32 v63, 0xffff0000, v119
    s_barrier
    s_mul_i32 s58, s74, 4
    s_add_u32 s58, s58, s29
    buffer_load_dwordx4 v[128:131], v1, s[8:11], s58 offen offset:0 sc1
    buffer_load_dwordx4 v[132:135], v1, s[8:11], s58 offen offset:1024 sc1
    buffer_load_dwordx4 v[136:139], v1, s[8:11], s58 offen offset:2048 sc1
    buffer_load_dwordx4 v[140:143], v1, s[8:11], s58 offen offset:3072 sc1
    s_mul_i32 s58, s75, 4
    s_add_u32 s58, s58, s29
    buffer_load_dwordx4 v[144:147], v1, s[8:11], s58 offen offset:0 sc1
    buffer_load_dwordx4 v[148:151], v1, s[8:11], s58 offen offset:1024 sc1
    buffer_load_dwordx4 v[152:155], v1, s[8:11], s58 offen offset:2048 sc1
    buffer_load_dwordx4 v[156:159], v1, s[8:11], s58 offen offset:3072 sc1
    ds_read_b64_tr_b16 v[24:25], v4 offset:0
    ds_read_b64_tr_b16 v[26:27], v4 offset:1024
    ds_read_b64_tr_b16 v[28:29], v7 offset:0
    ds_read_b64_tr_b16 v[30:31], v7 offset:1024
    ds_read_b64_tr_b16 v[32:33], v4 offset:2048
    ds_read_b64_tr_b16 v[34:35], v4 offset:3072
    ds_read_b64_tr_b16 v[36:37], v7 offset:2048
    ds_read_b64_tr_b16 v[38:39], v7 offset:3072
    ds_read_b64_tr_b16 v[40:41], v4 offset:8192
    ds_read_b64_tr_b16 v[42:43], v4 offset:9216
    s_waitcnt lgkmcnt(6)
    s_waitcnt vmcnt(7)
    v_mfma_f32_32x32x16_bf16 v[48:63], v[24:27], v[128:131], v[48:63]
    ds_read_b64_tr_b16 v[44:45], v7 offset:8192
    ds_read_b64_tr_b16 v[46:47], v7 offset:9216
    v_mfma_f32_32x32x16_bf16 v[64:79], v[28:31], v[128:131], 0
    ds_read_b64_tr_b16 v[24:25], v4 offset:10240
    ds_read_b64_tr_b16 v[26:27], v4 offset:11264
    s_mul_i32 s58, s76, 4
    s_add_u32 s58, s58, s29
    buffer_load_dwordx4 v[160:163], v1, s[8:11], s58 offen offset:0 sc1
    buffer_load_dwordx4 v[164:167], v1, s[8:11], s58 offen offset:1024 sc1
    s_waitcnt lgkmcnt(6)
    s_waitcnt vmcnt(8)
    v_mfma_f32_32x32x16_bf16 v[48:63], v[32:35], v[132:135], v[48:63]
    ds_read_b64_tr_b16 v[28:29], v7 offset:10240
    ds_read_b64_tr_b16 v[30:31], v7 offset:11264
    v_mfma_f32_32x32x16_bf16 v[64:79], v[36:39], v[132:135], v[64:79]
    ds_read_b64_tr_b16 v[32:33], v4 offset:16384
    ds_read_b64_tr_b16 v[34:35], v4 offset:17408
    buffer_load_dwordx4 v[168:171], v1, s[8:11], s58 offen offset:2048 sc1
    buffer_load_dwordx4 v[172:175], v1, s[8:11], s58 offen offset:3072 sc1
    s_waitcnt lgkmcnt(6)
    s_waitcnt vmcnt(9)
    v_mfma_f32_32x32x16_bf16 v[48:63], v[40:43], v[136:139], v[48:63]
    ds_read_b64_tr_b16 v[36:37], v7 offset:16384
    ds_read_b64_tr_b16 v[38:39], v7 offset:17408
    v_mfma_f32_32x32x16_bf16 v[64:79], v[44:47], v[136:139], v[64:79]
    ds_read_b64_tr_b16 v[40:41], v4 offset:18432
    ds_read_b64_tr_b16 v[42:43], v4 offset:19456
    s_mul_i32 s58, s77, 4
    s_add_u32 s58, s58, s29
    buffer_load_dwordx4 v[176:179], v1, s[8:11], s58 offen offset:0 sc1
    s_waitcnt lgkmcnt(6)
    s_waitcnt vmcnt(9)
    v_mfma_f32_32x32x16_bf16 v[48:63], v[24:27], v[140:143], v[48:63]
    ds_read_b64_tr_b16 v[44:45], v7 offset:18432
    ds_read_b64_tr_b16 v[46:47], v7 offset:19456
    v_mfma_f32_32x32x16_bf16 v[64:79], v[28:31], v[140:143], v[64:79]
    ds_read_b64_tr_b16 v[24:25], v4 offset:24576
    ds_read_b64_tr_b16 v[26:27], v4 offset:25600
    buffer_load_dwordx4 v[180:183], v1, s[8:11], s58 offen offset:1024 sc1
    s_waitcnt lgkmcnt(6)
    s_waitcnt vmcnt(9)
    v_mfma_f32_32x32x16_bf16 v[48:63], v[32:35], v[144:147], v[48:63]
    ds_read_b64_tr_b16 v[28:29], v7 offset:24576
    ds_read_b64_tr_b16 v[30:31], v7 offset:25600
    v_mfma_f32_32x32x16_bf16 v[64:79], v[36:39], v[144:147], v[64:79]
    ds_read_b64_tr_b16 v[32:33], v4 offset:26624
    ds_read_b64_tr_b16 v[34:35], v4 offset:27648
    buffer_load_dwordx4 v[184:187], v1, s[8:11], s58 offen offset:2048 sc1
    s_waitcnt lgkmcnt(6)
    s_waitcnt vmcnt(9)
    v_mfma_f32_32x32x16_bf16 v[48:63], v[40:43], v[148:151], v[48:63]
    ds_read_b64_tr_b16 v[36:37], v7 offset:26624
    ds_read_b64_tr_b16 v[38:39], v7 offset:27648
    v_mfma_f32_32x32x16_bf16 v[64:79], v[44:47], v[148:151], v[64:79]
    ds_read_b64_tr_b16 v[40:41], v4 offset:32768
    ds_read_b64_tr_b16 v[42:43], v4 offset:33792
    buffer_load_dwordx4 v[188:191], v1, s[8:11], s58 offen offset:3072 sc1
    s_waitcnt lgkmcnt(6)
    s_waitcnt vmcnt(9)
    v_mfma_f32_32x32x16_bf16 v[48:63], v[24:27], v[152:155], v[48:63]
    ds_read_b64_tr_b16 v[44:45], v7 offset:32768
    ds_read_b64_tr_b16 v[46:47], v7 offset:33792
    v_mfma_f32_32x32x16_bf16 v[64:79], v[28:31], v[152:155], v[64:79]
    ds_read_b64_tr_b16 v[24:25], v4 offset:34816
    ds_read_b64_tr_b16 v[26:27], v4 offset:35840
    s_waitcnt lgkmcnt(6)
    s_waitcnt vmcnt(8)
    v_mfma_f32_32x32x16_bf16 v[48:63], v[32:35], v[156:159], v[48:63]
    ds_read_b64_tr_b16 v[28:29], v7 offset:34816
    ds_read_b64_tr_b16 v[30:31], v7 offset:35840
    v_mfma_f32_32x32x16_bf16 v[64:79], v[36:39], v[156:159], v[64:79]
    ds_read_b64_tr_b16 v[32:33], v4 offset:40960
    ds_read_b64_tr_b16 v[34:35], v4 offset:41984
    s_waitcnt lgkmcnt(6)
    s_waitcnt vmcnt(7)
    v_mfma_f32_32x32x16_bf16 v[48:63], v[40:43], v[160:163], v[48:63]
    ds_read_b64_tr_b16 v[36:37], v7 offset:40960
    ds_read_b64_tr_b16 v[38:39], v7 offset:41984
    v_mfma_f32_32x32x16_bf16 v[64:79], v[44:47], v[160:163], v[64:79]
    ds_read_b64_tr_b16 v[40:41], v4 offset:43008
    ds_read_b64_tr_b16 v[42:43], v4 offset:44032
    s_waitcnt lgkmcnt(6)
    s_waitcnt vmcnt(6)
    v_mfma_f32_32x32x16_bf16 v[48:63], v[24:27], v[164:167], v[48:63]
    ds_read_b64_tr_b16 v[44:45], v7 offset:43008
    ds_read_b64_tr_b16 v[46:47], v7 offset:44032
    v_mfma_f32_32x32x16_bf16 v[64:79], v[28:31], v[164:167], v[64:79]
    ds_read_b64_tr_b16 v[24:25], v4 offset:49152
    ds_read_b64_tr_b16 v[26:27], v4 offset:50176
    s_waitcnt lgkmcnt(6)
    s_waitcnt vmcnt(5)
    v_mfma_f32_32x32x16_bf16 v[48:63], v[32:35], v[168:171], v[48:63]
    ds_read_b64_tr_b16 v[28:29], v7 offset:49152
    ds_read_b64_tr_b16 v[30:31], v7 offset:50176
    v_mfma_f32_32x32x16_bf16 v[64:79], v[36:39], v[168:171], v[64:79]
    ds_read_b64_tr_b16 v[32:33], v7 offset:51200
    ds_read_b64_tr_b16 v[34:35], v7 offset:52224
    s_waitcnt lgkmcnt(6)
    s_waitcnt vmcnt(4)
    v_mfma_f32_32x32x16_bf16 v[48:63], v[40:43], v[172:175], v[48:63]
    ds_read_b64_tr_b16 v[36:37], v7 offset:57344
    ds_read_b64_tr_b16 v[38:39], v7 offset:58368
    v_mfma_f32_32x32x16_bf16 v[64:79], v[44:47], v[172:175], v[64:79]
    ds_read_b64_tr_b16 v[40:41], v7 offset:59392
    ds_read_b64_tr_b16 v[42:43], v7 offset:60416
    s_waitcnt lgkmcnt(6)
    s_waitcnt vmcnt(3)
    v_mfma_f32_32x32x16_bf16 v[48:63], v[24:27], v[176:179], v[48:63]
    ds_read_b64_tr_b16 v[44:45], v4 offset:51200
    ds_read_b64_tr_b16 v[46:47], v4 offset:52224
    v_mfma_f32_32x32x16_bf16 v[64:79], v[28:31], v[176:179], v[64:79]
    ds_read_b64_tr_b16 v[24:25], v4 offset:57344
    ds_read_b64_tr_b16 v[26:27], v4 offset:58368
    s_waitcnt lgkmcnt(6)
    s_waitcnt vmcnt(2)
    v_mfma_f32_32x32x16_bf16 v[64:79], v[32:35], v[180:183], v[64:79]
    ds_read_b64_tr_b16 v[28:29], v4 offset:59392
    ds_read_b64_tr_b16 v[30:31], v4 offset:60416
    s_waitcnt vmcnt(1)
    v_mfma_f32_32x32x16_bf16 v[64:79], v[36:39], v[184:187], v[64:79]
    s_waitcnt lgkmcnt(4)
    s_waitcnt vmcnt(0)
    v_mfma_f32_32x32x16_bf16 v[64:79], v[40:43], v[188:191], v[64:79]
    v_mfma_f32_32x32x16_bf16 v[48:63], v[44:47], v[180:183], v[48:63]
    s_waitcnt lgkmcnt(0)
    v_mfma_f32_32x32x16_bf16 v[48:63], v[24:27], v[184:187], v[48:63]
    v_mfma_f32_32x32x16_bf16 v[48:63], v[28:31], v[188:191], v[48:63]
    s_nop 7
    ds_write_b128 v120, v[64:67] offset:0
    ds_write_b128 v120, v[68:71] offset:1024
    ds_write_b128 v120, v[72:75] offset:2048
    ds_write_b128 v120, v[76:79] offset:3072
    s_waitcnt lgkmcnt(0)
    s_barrier
    ds_read_b128 v[24:27], v121 offset:0
    ds_read_b128 v[28:31], v121 offset:1024
    ds_read_b128 v[32:35], v121 offset:2048
    ds_read_b128 v[36:39], v121 offset:3072
    s_waitcnt lgkmcnt(3)
    v_pk_add_f32 v[48:49], v[48:49], v[24:25]
    v_pk_add_f32 v[50:51], v[50:51], v[26:27]
    s_waitcnt lgkmcnt(2)
    v_pk_add_f32 v[52:53], v[52:53], v[28:29]
    v_pk_add_f32 v[54:55], v[54:55], v[30:31]
    v_cvt_pk_bf16_f32 v112, v48, v49
    v_cvt_pk_bf16_f32 v113, v50, v51
    v_cvt_pk_bf16_f32 v114, v52, v53
    v_cvt_pk_bf16_f32 v115, v54, v55
    buffer_store_dwordx4 v[112:115], v1, s[8:11], s31 offen offset:0 sc1
    s_waitcnt lgkmcnt(1)
    v_pk_add_f32 v[56:57], v[56:57], v[32:33]
    v_pk_add_f32 v[58:59], v[58:59], v[34:35]
    s_waitcnt lgkmcnt(0)
    v_pk_add_f32 v[60:61], v[60:61], v[36:37]
    v_pk_add_f32 v[62:63], v[62:63], v[38:39]
    v_cvt_pk_bf16_f32 v116, v56, v57
    v_cvt_pk_bf16_f32 v117, v58, v59
    v_cvt_pk_bf16_f32 v118, v60, v61
    v_cvt_pk_bf16_f32 v119, v62, v63
    buffer_store_dwordx4 v[116:119], v1, s[8:11], s31 offen offset:1024 sc1
    v_pk_add_f32 v[24:25], v[48:49], v[50:51]
    v_pk_mul_f32 v[26:27], v[48:49], v[48:49]
    v_pk_fma_f32 v[26:27], v[50:51], v[50:51], v[26:27]
    v_pk_add_f32 v[24:25], v[24:25], v[52:53]
    v_pk_fma_f32 v[26:27], v[52:53], v[52:53], v[26:27]
    v_pk_add_f32 v[24:25], v[24:25], v[54:55]
    v_pk_fma_f32 v[26:27], v[54:55], v[54:55], v[26:27]
    v_pk_add_f32 v[24:25], v[24:25], v[56:57]
    v_pk_fma_f32 v[26:27], v[56:57], v[56:57], v[26:27]
    v_pk_add_f32 v[24:25], v[24:25], v[58:59]
    v_pk_fma_f32 v[26:27], v[58:59], v[58:59], v[26:27]
    v_pk_add_f32 v[24:25], v[24:25], v[60:61]
    v_pk_fma_f32 v[26:27], v[60:61], v[60:61], v[26:27]
    v_pk_add_f32 v[24:25], v[24:25], v[62:63]
    v_pk_fma_f32 v[26:27], v[62:63], v[62:63], v[26:27]
    v_add_f32 v16, v24, v25
    v_add_f32 v17, v26, v27
    s_nop 1
    v_permlane32_swap_b32 v16, v17
    v_add_f32 v16, v16, v17
    buffer_atomic_add_f32 v16, v122, s[8:11], s32 offen sc1
    s_waitcnt vmcnt(0) lgkmcnt(0)
    s_barrier
    s_add_u32 s57, s35, 4096
    s_barrier
    s_add_u32 s58, s33, s70
    buffer_load_dwordx4 v[128:131], v1, s[8:11], s58 offen offset:0 sc1
    buffer_load_dwordx4 v[132:135], v1, s[8:11], s58 offen offset:1024 sc1
    buffer_load_dwordx4 v[136:139], v1, s[8:11], s58 offen offset:2048 sc1
    buffer_load_dwordx4 v[140:143], v1, s[8:11], s58 offen offset:3072 sc1
    s_add_u32 s58, s58, 0x1000
    buffer_load_dwordx4 v[144:147], v1, s[8:11], s58 offen offset:0 sc1
    buffer_load_dwordx4 v[148:151], v1, s[8:11], s58 offen offset:1024 sc1
    buffer_load_dwordx4 v[152:155], v1, s[8:11], s58 offen offset:2048 sc1
    buffer_load_dwordx4 v[156:159], v1, s[8:11], s58 offen offset:3072 sc1
    ds_read_b128 v[24:27], v2 offset:0
    ds_read_b128 v[28:31], v2 offset:8192
    ds_read_b128 v[32:35], v2 offset:16384
    ds_read_b128 v[36:39], v2 offset:1024
    ds_read_b128 v[40:43], v2 offset:9216
    s_waitcnt lgkmcnt(3)
    s_waitcnt vmcnt(7)
    v_mfma_f32_32x32x16_bf16 v[80:95], v[24:27], v[128:131], 0
    ds_read_b128 v[44:47], v2 offset:17408
    v_mfma_f32_32x32x16_bf16 v[96:111], v[28:31], v[128:131], 0
    ds_read_b128 v[24:27], v2 offset:2048
    s_waitcnt lgkmcnt(3)
    v_mfma_f32_32x32x16_bf16 v[112:127], v[32:35], v[128:131], 0
    ds_read_b128 v[28:31], v2 offset:10240
    s_add_u32 s58, s33, s71
    buffer_load_dwordx4 v[160:163], v1, s[8:11], s58 offen offset:0 sc1
    buffer_load_dwordx2 v[48:49], v11, s[8:11], s34 offen offset:0 sc1
    buffer_load_dwordx2 v[50:51], v11, s[8:11], s34 offen offset:512 sc1
    buffer_load_dwordx4 v[164:167], v1, s[8:11], s58 offen offset:1024 sc1
    s_waitcnt vmcnt(10)
    v_mfma_f32_32x32x16_bf16 v[80:95], v[36:39], v[132:135], v[80:95]
    ds_read_b128 v[32:35], v2 offset:18432
    s_waitcnt lgkmcnt(3)
    v_mfma_f32_32x32x16_bf16 v[96:111], v[40:43], v[132:135], v[96:111]
    ds_read_b128 v[36:39], v2 offset:3072
    v_mfma_f32_32x32x16_bf16 v[112:127], v[44:47], v[132:135], v[112:127]
    ds_read_b128 v[40:43], v2 offset:11264
    buffer_load_dwordx4 v[168:171], v1, s[8:11], s58 offen offset:2048 sc1
    buffer_load_dwordx4 v[172:175], v1, s[8:11], s58 offen offset:3072 sc1
    s_waitcnt lgkmcnt(3)
    s_waitcnt vmcnt(11)
    v_mfma_f32_32x32x16_bf16 v[80:95], v[24:27], v[136:139], v[80:95]
    ds_read_b128 v[44:47], v2 offset:19456
    v_mfma_f32_32x32x16_bf16 v[96:111], v[28:31], v[136:139], v[96:111]
    ds_read_b128 v[24:27], v2 offset:4096
    s_waitcnt lgkmcnt(3)
    v_mfma_f32_32x32x16_bf16 v[112:127], v[32:35], v[136:139], v[112:127]
    ds_read_b128 v[28:31], v2 offset:12288
    s_add_u32 s58, s58, 0x1000
    buffer_load_dwordx4 v[176:179], v1, s[8:11], s58 offen offset:0 sc1
    s_waitcnt vmcnt(11)
    v_mfma_f32_32x32x16_bf16 v[80:95], v[36:39], v[140:143], v[80:95]
    ds_read_b128 v[32:35], v2 offset:20480
    s_waitcnt lgkmcnt(3)
    v_mfma_f32_32x32x16_bf16 v[96:111], v[40:43], v[140:143], v[96:111]
    ds_read_b128 v[36:39], v2 offset:5120
    v_mfma_f32_32x32x16_bf16 v[112:127], v[44:47], v[140:143], v[112:127]
    ds_read_b128 v[40:43], v2 offset:13312
    buffer_load_dwordx4 v[180:183], v1, s[8:11], s58 offen offset:1024 sc1
    s_waitcnt lgkmcnt(3)
    s_waitcnt vmcnt(11)
    v_mfma_f32_32x32x16_bf16 v[80:95], v[24:27], v[144:147], v[80:95]
    ds_read_b128 v[44:47], v2 offset:21504
    v_mfma_f32_32x32x16_bf16 v[96:111], v[28:31], v[144:147], v[96:111]
    ds_read_b128 v[24:27], v2 offset:6144
    s_waitcnt lgkmcnt(3)
    v_mfma_f32_32x32x16_bf16 v[112:127], v[32:35], v[144:147], v[112:127]
    ds_read_b128 v[28:31], v2 offset:14336
    buffer_load_dwordx4 v[184:187], v1, s[8:11], s58 offen offset:2048 sc1
    s_waitcnt vmcnt(11)
    v_mfma_f32_32x32x16_bf16 v[80:95], v[36:39], v[148:151], v[80:95]
    ds_read_b128 v[32:35], v2 offset:22528
    s_waitcnt lgkmcnt(3)
    v_mfma_f32_32x32x16_bf16 v[96:111], v[40:43], v[148:151], v[96:111]
    ds_read_b128 v[36:39], v2 offset:7168
    v_mfma_f32_32x32x16_bf16 v[112:127], v[44:47], v[148:151], v[112:127]
    ds_read_b128 v[40:43], v2 offset:15360
    buffer_load_dwordx4 v[188:191], v1, s[8:11], s58 offen offset:3072 sc1
    s_waitcnt lgkmcnt(3)
    s_waitcnt vmcnt(11)
    v_mfma_f32_32x32x16_bf16 v[80:95], v[24:27], v[152:155], v[80:95]
    ds_read_b128 v[44:47], v2 offset:23552
    v_mfma_f32_32x32x16_bf16 v[96:111], v[28:31], v[152:155], v[96:111]
    s_barrier
    ds_read_b128 v[24:27], v2 offset:24576
    s_waitcnt lgkmcnt(3)
    v_mfma_f32_32x32x16_bf16 v[112:127], v[32:35], v[152:155], v[112:127]
    ds_read_b128 v[28:31], v2 offset:32768
    s_add_u32 s58, s33, s72
    buffer_load_dwordx4 v[192:195], v1, s[8:11], s58 offen offset:0 sc1
    s_waitcnt vmcnt(11)
    v_mfma_f32_32x32x16_bf16 v[80:95], v[36:39], v[156:159], v[80:95]
    ds_read_b128 v[32:35], v2 offset:40960
    s_waitcnt lgkmcnt(3)
    v_mfma_f32_32x32x16_bf16 v[96:111], v[40:43], v[156:159], v[96:111]
    ds_read_b128 v[36:39], v2 offset:25600
    v_mfma_f32_32x32x16_bf16 v[112:127], v[44:47], v[156:159], v[112:127]
    ds_read_b128 v[40:43], v2 offset:33792
    buffer_load_dwordx4 v[196:199], v1, s[8:11], s58 offen offset:1024 sc1
    s_waitcnt lgkmcnt(3)
    s_waitcnt vmcnt(11)
    v_mfma_f32_32x32x16_bf16 v[80:95], v[24:27], v[160:163], v[80:95]
    ds_read_b128 v[44:47], v2 offset:41984
    v_mfma_f32_32x32x16_bf16 v[96:111], v[28:31], v[160:163], v[96:111]
    ds_read_b128 v[24:27], v2 offset:26624
    s_waitcnt lgkmcnt(3)
    v_mfma_f32_32x32x16_bf16 v[112:127], v[32:35], v[160:163], v[112:127]
    ds_read_b128 v[28:31], v2 offset:34816
    buffer_load_dwordx4 v[200:203], v1, s[8:11], s58 offen offset:2048 sc1
    s_waitcnt vmcnt(9)
    v_mfma_f32_32x32x16_bf16 v[80:95], v[36:39], v[164:167], v[80:95]
    ds_read_b128 v[32:35], v2 offset:43008
    s_waitcnt lgkmcnt(3)
    v_mfma_f32_32x32x16_bf16 v[96:111], v[40:43], v[164:167], v[96:111]
    ds_read_b128 v[36:39], v2 offset:27648
    v_mfma_f32_32x32x16_bf16 v[112:127], v[44:47], v[164:167], v[112:127]
    ds_read_b128 v[40:43], v2 offset:35840
    buffer_load_dwordx4 v[204:207], v1, s[8:11], s58 offen offset:3072 sc1
    s_waitcnt lgkmcnt(3)
    s_waitcnt vmcnt(9)
    v_mfma_f32_32x32x16_bf16 v[80:95], v[24:27], v[168:171], v[80:95]
    ds_read_b128 v[44:47], v2 offset:44032
    v_mfma_f32_32x32x16_bf16 v[96:111], v[28:31], v[168:171], v[96:111]
    ds_read_b128 v[24:27], v2 offset:28672
    s_waitcnt lgkmcnt(3)
    v_mfma_f32_32x32x16_bf16 v[112:127], v[32:35], v[168:171], v[112:127]
    ds_read_b128 v[28:31], v2 offset:36864
    s_add_u32 s58, s58, 0x1000
    buffer_load_dwordx4 v[208:211], v1, s[8:11], s58 offen offset:0 sc1
    s_waitcnt vmcnt(9)
    v_mfma_f32_32x32x16_bf16 v[80:95], v[36:39], v[172:175], v[80:95]
    v_add_f32 v48, v48, v50
    ds_read_b128 v[32:35], v2 offset:45056
    s_waitcnt lgkmcnt(3)
    v_mfma_f32_32x32x16_bf16 v[96:111], v[40:43], v[172:175], v[96:111]
    v_add_f32 v49, v49, v51
    ds_read_b128 v[36:39], v2 offset:29696
    v_mfma_f32_32x32x16_bf16 v[112:127], v[44:47], v[172:175], v[112:127]
    v_mov_b32 v50, v48
    v_mov_b32 v51, v49
    ds_read_b128 v[40:43], v2 offset:37888
    buffer_load_dwordx4 v[212:215], v1, s[8:11], s58 offen offset:1024 sc1
    s_waitcnt lgkmcnt(3)
    s_waitcnt vmcnt(9)
    v_mfma_f32_32x32x16_bf16 v[80:95], v[24:27], v[176:179], v[80:95]
    ds_read_b128 v[44:47], v2 offset:46080
    v_mfma_f32_32x32x16_bf16 v[96:111], v[28:31], v[176:179], v[96:111]
    v_permlane32_swap_b32 v48, v50
    ds_read_b128 v[24:27], v2 offset:30720
    s_waitcnt lgkmcnt(3)
    v_mfma_f32_32x32x16_bf16 v[112:127], v[32:35], v[176:179], v[112:127]
    v_permlane32_swap_b32 v49, v51
    ds_read_b128 v[28:31], v2 offset:38912
    buffer_load_dwordx4 v[216:219], v1, s[8:11], s58 offen offset:2048 sc1
    s_waitcnt vmcnt(9)
    v_mfma_f32_32x32x16_bf16 v[80:95], v[36:39], v[180:183], v[80:95]
    v_add_f32 v48, v48, v50
    ds_read_b128 v[32:35], v2 offset:47104
    s_waitcnt lgkmcnt(3)
    v_mfma_f32_32x32x16_bf16 v[96:111], v[40:43], v[180:183], v[96:111]
    v_add_f32 v49, v49, v51
    ds_read_b128 v[36:39], v2 offset:31744
    v_mfma_f32_32x32x16_bf16 v[112:127], v[44:47], v[180:183], v[112:127]
    v_mul_f32 v48, 0xbb000000, v48
    ds_read_b128 v[40:43], v2 offset:39936
    buffer_load_dwordx4 v[220:223], v1, s[8:11], s58 offen offset:3072 sc1
    s_waitcnt lgkmcnt(3)
    s_waitcnt vmcnt(9)
    v_mfma_f32_32x32x16_bf16 v[80:95], v[24:27], v[184:187], v[80:95]
    v_mul_f32 v49, 0x3b000000, v49
    ds_read_b128 v[44:47], v2 offset:48128
    v_mfma_f32_32x32x16_bf16 v[96:111], v[28:31], v[184:187], v[96:111]
    v_fma_f32 v49, -v48, v48, v49
    v_cndmask_b32 v48, 0, v48, s[52:53]
    s_barrier
    ds_read_b128 v[24:27], v2 offset:49152
    s_waitcnt lgkmcnt(3)
    v_mfma_f32_32x32x16_bf16 v[112:127], v[32:35], v[184:187], v[112:127]
    v_max_f32 v49, 0, v49
    ds_read_b128 v[28:31], v2 offset:57344
    s_add_u32 s58, s33, s73
    buffer_load_dwordx4 v[224:227], v1, s[8:11], s58 offen offset:0 sc1
    s_waitcnt vmcnt(9)
    v_mfma_f32_32x32x16_bf16 v[80:95], v[36:39], v[188:191], v[80:95]
    v_cvt_pk_bf16_f32 v13, v48, 0
    ds_read_b128 v[32:35], v3 offset:0
    s_waitcnt lgkmcnt(3)
    v_mfma_f32_32x32x16_bf16 v[96:111], v[40:43], v[188:191], v[96:111]
    v_add_f32 v49, 0x3727c5ac, v49
    ds_read_b128 v[36:39], v2 offset:50176
    v_mfma_f32_32x32x16_bf16 v[112:127], v[44:47], v[188:191], v[112:127]
    v_lshlrev_b32 v50, 16, v13
    ds_read_b128 v[40:43], v2 offset:58368
    buffer_load_dwordx4 v[228:231], v1, s[8:11], s58 offen offset:1024 sc1
    s_waitcnt lgkmcnt(3)
    s_waitcnt vmcnt(9)
    v_mfma_f32_32x32x16_bf16 v[80:95], v[24:27], v[192:195], v[80:95]
    v_rsq_f32 v20, v49
    ds_read_b128 v[44:47], v3 offset:1024
    v_mfma_f32_32x32x16_bf16 v[96:111], v[28:31], v[192:195], v[96:111]
    v_sub_f32 v50, v48, v50
    ds_read_b128 v[24:27], v2 offset:51200
    s_waitcnt lgkmcnt(3)
    v_mfma_f32_32x32x16_bf16 v[112:127], v[32:35], v[192:195], v[112:127]
    v_mov_b32 v14, 0
    ds_read_b128 v[28:31], v2 offset:59392
    buffer_load_dwordx4 v[232:235], v1, s[8:11], s58 offen offset:2048 sc1
    s_waitcnt vmcnt(9)
    v_mfma_f32_32x32x16_bf16 v[80:95], v[36:39], v[196:199], v[80:95]
    v_mov_b32 v15, 0
    ds_read_b128 v[32:35], v3 offset:2048
    s_waitcnt lgkmcnt(3)
    v_mfma_f32_32x32x16_bf16 v[96:111], v[40:43], v[196:199], v[96:111]
    v_cvt_pk_bf16_f32 v12, v48, v50
    ds_read_b128 v[36:39], v2 offset:52224
    v_mfma_f32_32x32x16_bf16 v[112:127], v[44:47], v[196:199], v[112:127]
    v_sqrt_f32 v21, v49
    ds_read_b128 v[40:43], v2 offset:60416
    buffer_load_dwordx4 v[236:239], v1, s[8:11], s58 offen offset:3072 sc1
    s_waitcnt lgkmcnt(3)
    s_waitcnt vmcnt(9)
    v_mfma_f32_32x32x16_bf16 v[80:95], v[24:27], v[200:203], v[80:95]
    v_mul_f32 v20, 0xbfb8aa3b, v20
    ds_read_b128 v[44:47], v3 offset:3072
    v_mfma_f32_32x32x16_bf16 v[96:111], v[28:31], v[200:203], v[96:111]
    ds_read_b128 v[24:27], v2 offset:53248
    s_waitcnt lgkmcnt(3)
    v_mfma_f32_32x32x16_bf16 v[112:127], v[32:35], v[200:203], v[112:127]
    ds_read_b128 v[28:31], v2 offset:61440
    s_add_u32 s58, s58, 0x1000
    buffer_load_dwordx4 v[240:243], v1, s[8:11], s58 offen offset:0 sc1
    s_waitcnt vmcnt(9)
    v_mfma_f32_32x32x16_bf16 v[80:95], v[36:39], v[204:207], v[80:95]
    ds_read_b128 v[32:35], v3 offset:4096
    s_waitcnt lgkmcnt(3)
    v_mfma_f32_32x32x16_bf16 v[96:111], v[40:43], v[204:207], v[96:111]
    ds_read_b128 v[36:39], v2 offset:54272
    v_mfma_f32_32x32x16_bf16 v[112:127], v[44:47], v[204:207], v[112:127]
    ds_read_b128 v[40:43], v2 offset:62464
    buffer_load_dwordx4 v[244:247], v1, s[8:11], s58 offen offset:1024 sc1
    s_waitcnt lgkmcnt(3)
    s_waitcnt vmcnt(9)
    v_mfma_f32_32x32x16_bf16 v[80:95], v[24:27], v[208:211], v[80:95]
    ds_read_b128 v[44:47], v3 offset:5120
    v_mfma_f32_32x32x16_bf16 v[96:111], v[28:31], v[208:211], v[96:111]
    ds_read_b128 v[24:27], v2 offset:55296
    s_waitcnt lgkmcnt(3)
    v_mfma_f32_32x32x16_bf16 v[112:127], v[32:35], v[208:211], v[112:127]
    ds_read_b128 v[28:31], v2 offset:63488
    buffer_load_dwordx4 v[248:251], v1, s[8:11], s58 offen offset:2048 sc1
    s_waitcnt vmcnt(9)
    v_mfma_f32_32x32x16_bf16 v[80:95], v[36:39], v[212:215], v[80:95]
    ds_read_b128 v[32:35], v3 offset:6144
    s_waitcnt lgkmcnt(3)
    v_mfma_f32_32x32x16_bf16 v[96:111], v[40:43], v[212:215], v[96:111]
    ds_read_b128 v[36:39], v2 offset:56320
    v_mfma_f32_32x32x16_bf16 v[112:127], v[44:47], v[212:215], v[112:127]
    ds_read_b128 v[40:43], v2 offset:64512
    buffer_load_dwordx4 v[252:255], v1, s[8:11], s58 offen offset:3072 sc1
    s_waitcnt lgkmcnt(3)
    s_waitcnt vmcnt(9)
    v_mfma_f32_32x32x16_bf16 v[80:95], v[24:27], v[216:219], v[80:95]
    ds_read_b128 v[44:47], v3 offset:7168
    v_mfma_f32_32x32x16_bf16 v[96:111], v[28:31], v[216:219], v[96:111]
    s_barrier
    ds_read_b128 v[24:27], v1 offset:0
    s_waitcnt lgkmcnt(3)
    v_mfma_f32_32x32x16_bf16 v[112:127], v[32:35], v[216:219], v[112:127]
    ds_read_b128 v[28:31], v1 offset:8192
    s_waitcnt vmcnt(8)
    v_mfma_f32_32x32x16_bf16 v[80:95], v[36:39], v[220:223], v[80:95]
    ds_read_b128 v[32:35], v1 offset:16384
    s_waitcnt lgkmcnt(3)
    v_mfma_f32_32x32x16_bf16 v[96:111], v[40:43], v[220:223], v[96:111]
    ds_read_b128 v[36:39], v1 offset:1024
    v_mfma_f32_32x32x16_bf16 v[112:127], v[44:47], v[220:223], v[112:127]
    ds_read_b128 v[40:43], v1 offset:9216
    s_waitcnt lgkmcnt(3)
    s_waitcnt vmcnt(7)
    v_mfma_f32_32x32x16_bf16 v[80:95], v[24:27], v[224:227], v[80:95]
    ds_read_b128 v[44:47], v1 offset:17408
    v_mfma_f32_32x32x16_bf16 v[96:111], v[28:31], v[224:227], v[96:111]
    ds_read_b128 v[24:27], v1 offset:2048
    s_waitcnt lgkmcnt(3)
    v_mfma_f32_32x32x16_bf16 v[112:127], v[32:35], v[224:227], v[112:127]
    ds_read_b128 v[28:31], v1 offset:10240
    s_waitcnt vmcnt(6)
    v_mfma_f32_32x32x16_bf16 v[80:95], v[36:39], v[228:231], v[80:95]
    ds_read_b128 v[32:35], v1 offset:18432
    s_waitcnt lgkmcnt(3)
    v_mfma_f32_32x32x16_bf16 v[96:111], v[40:43], v[228:231], v[96:111]
    ds_read_b128 v[36:39], v1 offset:3072
    v_mfma_f32_32x32x16_bf16 v[112:127], v[44:47], v[228:231], v[112:127]
    ds_read_b128 v[40:43], v1 offset:11264
    s_waitcnt lgkmcnt(3)
    s_waitcnt vmcnt(5)
    v_mfma_f32_32x32x16_bf16 v[80:95], v[24:27], v[232:235], v[80:95]
    ds_read_b128 v[44:47], v1 offset:19456
    v_mfma_f32_32x32x16_bf16 v[96:111], v[28:31], v[232:235], v[96:111]
    ds_read_b128 v[24:27], v1 offset:4096
    s_waitcnt lgkmcnt(3)
    v_mfma_f32_32x32x16_bf16 v[112:127], v[32:35], v[232:235], v[112:127]
    ds_read_b128 v[28:31], v1 offset:12288
    s_waitcnt vmcnt(4)
    v_mfma_f32_32x32x16_bf16 v[80:95], v[36:39], v[236:239], v[80:95]
    ds_read_b128 v[32:35], v1 offset:20480
    s_waitcnt lgkmcnt(3)
    v_mfma_f32_32x32x16_bf16 v[96:111], v[40:43], v[236:239], v[96:111]
    ds_read_b128 v[36:39], v1 offset:5120
    v_mfma_f32_32x32x16_bf16 v[112:127], v[44:47], v[236:239], v[112:127]
    ds_read_b128 v[40:43], v1 offset:13312
    s_waitcnt lgkmcnt(3)
    s_waitcnt vmcnt(3)
    v_mfma_f32_32x32x16_bf16 v[80:95], v[24:27], v[240:243], v[80:95]
    ds_read_b128 v[44:47], v1 offset:21504
    v_mfma_f32_32x32x16_bf16 v[96:111], v[28:31], v[240:243], v[96:111]
    ds_read_b128 v[24:27], v1 offset:6144
    s_waitcnt lgkmcnt(3)
    v_mfma_f32_32x32x16_bf16 v[112:127], v[32:35], v[240:243], v[112:127]
    ds_read_b128 v[28:31], v1 offset:14336
    s_waitcnt vmcnt(2)
    v_mfma_f32_32x32x16_bf16 v[80:95], v[36:39], v[244:247], v[80:95]
    ds_read_b128 v[32:35], v1 offset:22528
    s_waitcnt lgkmcnt(3)
    v_mfma_f32_32x32x16_bf16 v[96:111], v[40:43], v[244:247], v[96:111]
    ds_read_b128 v[36:39], v1 offset:7168
    v_mfma_f32_32x32x16_bf16 v[112:127], v[44:47], v[244:247], v[112:127]
    ds_read_b128 v[40:43], v1 offset:15360
    s_waitcnt lgkmcnt(3)
    s_waitcnt vmcnt(1)
    v_mfma_f32_32x32x16_bf16 v[80:95], v[24:27], v[248:251], v[80:95]
    ds_read_b128 v[44:47], v1 offset:23552
    v_mfma_f32_32x32x16_bf16 v[96:111], v[28:31], v[248:251], v[96:111]
    ds_read_b64 v[24:25], v10 offset:768
    s_waitcnt lgkmcnt(3)
    v_mfma_f32_32x32x16_bf16 v[112:127], v[32:35], v[248:251], v[112:127]
    ds_read_b64 v[28:29], v10 offset:1024
    s_waitcnt vmcnt(0)
    v_mfma_f32_32x32x16_bf16 v[80:95], v[36:39], v[252:255], v[80:95]
    ds_read_b64 v[32:33], v10 offset:1280
    s_waitcnt lgkmcnt(3)
    v_mfma_f32_32x32x16_bf16 v[96:111], v[40:43], v[252:255], v[96:111]
    s_barrier
    ds_read_b128 v[36:39], v1 offset:24576
    v_mfma_f32_32x32x16_bf16 v[112:127], v[44:47], v[252:255], v[112:127]
    ds_read_b128 v[40:43], v1 offset:32768
    s_waitcnt lgkmcnt(3)
    v_mfma_f32_32x32x16_bf16 v[80:95], v[24:27], v[12:15], v[80:95]
    ds_read_b128 v[44:47], v1 offset:25600
    v_mfma_f32_32x32x16_bf16 v[96:111], v[28:31], v[12:15], v[96:111]
    ds_read_b128 v[24:27], v1 offset:33792
    s_waitcnt lgkmcnt(3)
    v_mfma_f32_32x32x16_bf16 v[112:127], v[32:35], v[12:15], v[112:127]
    ds_read_b128 v[28:31], v1 offset:26624
    v_mfma_f32_32x32x16_bf16 v[48:63], v[36:39], v[128:131], 0
    ds_read_b128 v[32:35], v1 offset:34816
    s_waitcnt lgkmcnt(3)
    v_mfma_f32_32x32x16_bf16 v[64:79], v[40:43], v[128:131], 0
    ds_read_b128 v[36:39], v1 offset:27648
    v_mfma_f32_32x32x16_bf16 v[48:63], v[44:47], v[132:135], v[48:63]
    ds_read_b128 v[40:43], v1 offset:35840
    s_waitcnt lgkmcnt(3)
    v_mfma_f32_32x32x16_bf16 v[64:79], v[24:27], v[132:135], v[64:79]
    ds_read_b128 v[44:47], v1 offset:28672
    v_mfma_f32_32x32x16_bf16 v[48:63], v[28:31], v[136:139], v[48:63]
    ds_read_b128 v[24:27], v1 offset:36864
    v_mul_f32 v80, v20, v80
    v_mul_f32 v81, v20, v81
    v_exp_f32 v80, v80
    s_waitcnt lgkmcnt(3)
    v_mfma_f32_32x32x16_bf16 v[64:79], v[32:35], v[136:139], v[64:79]
    ds_read_b128 v[28:31], v1 offset:29696
    v_mul_f32 v82, v20, v82
    v_exp_f32 v81, v81
    v_fma_f32 v80, v80, v21, v21
    v_mul_f32 v83, v20, v83
    v_mfma_f32_32x32x16_bf16 v[48:63], v[36:39], v[140:143], v[48:63]
    ds_read_b128 v[32:35], v1 offset:37888
    v_exp_f32 v82, v82
    v_fma_f32 v81, v81, v21, v21
    s_waitcnt lgkmcnt(3)
    v_mfma_f32_32x32x16_bf16 v[64:79], v[40:43], v[140:143], v[64:79]
    ds_read_b128 v[36:39], v1 offset:30720
    v_rcp_f32 v80, v80
    v_mul_f32 v84, v20, v84
    v_exp_f32 v83, v83
    v_mfma_f32_32x32x16_bf16 v[48:63], v[44:47], v[144:147], v[48:63]
    ds_read_b128 v[40:43], v1 offset:38912
    v_fma_f32 v82, v82, v21, v21
    v_rcp_f32 v81, v81
    v_mul_f32 v96, v80, v96
    s_waitcnt lgkmcnt(3)
    v_mfma_f32_32x32x16_bf16 v[64:79], v[24:27], v[144:147], v[64:79]
    ds_read_b128 v[44:47], v1 offset:31744
    v_mul_f32 v85, v20, v85
    v_exp_f32 v84, v84
    v_fma_f32 v83, v83, v21, v21
    v_mfma_f32_32x32x16_bf16 v[48:63], v[28:31], v[148:151], v[48:63]
    ds_read_b128 v[24:27], v1 offset:39936
    v_rcp_f32 v82, v82
    v_mul_f32 v97, v81, v97
    v_mul_f32 v86, v20, v86
    s_waitcnt lgkmcnt(3)
    v_mfma_f32_32x32x16_bf16 v[64:79], v[32:35], v[148:151], v[64:79]
    s_barrier
    ds_read_b128 v[28:31], v1 offset:40960
    v_exp_f32 v85, v85
    v_fma_f32 v84, v84, v21, v21
    v_mfma_f32_32x32x16_bf16 v[48:63], v[36:39], v[152:155], v[48:63]
    ds_read_b128 v[32:35], v1 offset:49152
    v_rcp_f32 v83, v83
    v_mul_f32 v98, v82, v98
    v_mul_f32 v87, v20, v87
    s_waitcnt lgkmcnt(3)
    v_mfma_f32_32x32x16_bf16 v[64:79], v[40:43], v[152:155], v[64:79]
    ds_read_b128 v[36:39], v1 offset:41984
    v_exp_f32 v86, v86
    v_fma_f32 v85, v85, v21, v21
    v_rcp_f32 v84, v84
    v_mfma_f32_32x32x16_bf16 v[48:63], v[44:47], v[156:159], v[48:63]
    ds_read_b128 v[40:43], v1 offset:50176
    v_mul_f32 v99, v83, v99
    v_exp_f32 v87, v87
    v_fma_f32 v86, v86, v21, v21
    s_waitcnt lgkmcnt(3)
    v_mfma_f32_32x32x16_bf16 v[64:79], v[24:27], v[156:159], v[64:79]
    ds_read_b128 v[44:47], v1 offset:43008
    v_rcp_f32 v85, v85
    v_mul_f32 v100, v84, v100
    v_fma_f32 v87, v87, v21, v21
    v_mfma_f32_32x32x16_bf16 v[48:63], v[28:31], v[160:163], v[48:63]
    ds_read_b128 v[24:27], v1 offset:51200
    v_rcp_f32 v86, v86
    v_mul_f32 v101, v85, v101
    s_waitcnt lgkmcnt(3)
    v_mfma_f32_32x32x16_bf16 v[64:79], v[32:35], v[160:163], v[64:79]
    ds_read_b128 v[28:31], v1 offset:44032
    v_rcp_f32 v87, v87
    v_mul_f32 v102, v86, v102
    v_mul_f32 v103, v87, v103
    v_cvt_pk_bf16_f32 v16, v96, v97
    v_mfma_f32_32x32x16_bf16 v[48:63], v[36:39], v[164:167], v[48:63]
    ds_read_b128 v[32:35], v1 offset:52224
    v_cvt_pk_bf16_f32 v17, v98, v99
    v_cvt_pk_bf16_f32 v18, v100, v101
    v_cvt_pk_bf16_f32 v19, v102, v103
    s_waitcnt lgkmcnt(3)
    v_mfma_f32_32x32x16_bf16 v[64:79], v[40:43], v[164:167], v[64:79]
    ds_read_b128 v[36:39], v1 offset:45056
    buffer_store_dwordx4 v[16:19], v1, s[8:11], s35 offen offset:0 sc1
    v_mul_f32 v88, v20, v88
    v_mul_f32 v89, v20, v89
    v_mfma_f32_32x32x16_bf16 v[48:63], v[44:47], v[168:171], v[48:63]
    ds_read_b128 v[40:43], v1 offset:53248
    v_exp_f32 v88, v88
    v_mul_f32 v90, v20, v90
    s_waitcnt lgkmcnt(3)
    v_mfma_f32_32x32x16_bf16 v[64:79], v[24:27], v[168:171], v[64:79]
    ds_read_b128 v[44:47], v1 offset:46080
    v_exp_f32 v89, v89
    v_fma_f32 v88, v88, v21, v21
    v_mul_f32 v91, v20, v91
    v_mfma_f32_32x32x16_bf16 v[48:63], v[28:31], v[172:175], v[48:63]
    ds_read_b128 v[24:27], v1 offset:54272
    v_exp_f32 v90, v90
    v_fma_f32 v89, v89, v21, v21
    s_waitcnt lgkmcnt(3)
    v_mfma_f32_32x32x16_bf16 v[64:79], v[32:35], v[172:175], v[64:79]
    ds_read_b128 v[28:31], v1 offset:47104
    v_rcp_f32 v88, v88
    v_mul_f32 v92, v20, v92
    v_exp_f32 v91, v91
    v_mfma_f32_32x32x16_bf16 v[48:63], v[36:39], v[176:179], v[48:63]
    ds_read_b128 v[32:35], v1 offset:55296
    v_fma_f32 v90, v90, v21, v21
    v_rcp_f32 v89, v89
    v_mul_f32 v104, v88, v104
    s_waitcnt lgkmcnt(3)
    v_mfma_f32_32x32x16_bf16 v[64:79], v[40:43], v[176:179], v[64:79]
    ds_read_b128 v[36:39], v1 offset:48128
    v_mul_f32 v93, v20, v93
    v_exp_f32 v92, v92
    v_fma_f32 v91, v91, v21, v21
    v_mfma_f32_32x32x16_bf16 v[48:63], v[44:47], v[180:183], v[48:63]
    ds_read_b128 v[40:43], v1 offset:56320
    v_rcp_f32 v90, v90
    v_mul_f32 v105, v89, v105
    v_mul_f32 v94, v20, v94
    s_waitcnt lgkmcnt(3)
    v_mfma_f32_32x32x16_bf16 v[64:79], v[24:27], v[180:183], v[64:79]
    s_barrier
    ds_read_b128 v[44:47], v1 offset:57344
    v_exp_f32 v93, v93
    v_fma_f32 v92, v92, v21, v21
    v_mfma_f32_32x32x16_bf16 v[48:63], v[28:31], v[184:187], v[48:63]
    ds_read_b128 v[24:27], v3 offset:8192
    v_rcp_f32 v91, v91
    v_mul_f32 v106, v90, v106
    v_mul_f32 v95, v20, v95
    s_waitcnt lgkmcnt(3)
    v_mfma_f32_32x32x16_bf16 v[64:79], v[32:35], v[184:187], v[64:79]
    ds_read_b128 v[28:31], v1 offset:58368
    v_exp_f32 v94, v94
    v_fma_f32 v93, v93, v21, v21
    v_rcp_f32 v92, v92
    v_mfma_f32_32x32x16_bf16 v[48:63], v[36:39], v[188:191], v[48:63]
    ds_read_b128 v[32:35], v3 offset:9216
    v_mul_f32 v107, v91, v107
    v_exp_f32 v95, v95
    v_fma_f32 v94, v94, v21, v21
    s_waitcnt lgkmcnt(3)
    v_mfma_f32_32x32x16_bf16 v[64:79], v[40:43], v[188:191], v[64:79]
    ds_read_b128 v[36:39], v1 offset:59392
    v_rcp_f32 v93, v93
    v_mul_f32 v108, v92, v108
    v_fma_f32 v95, v95, v21, v21
    v_mfma_f32_32x32x16_bf16 v[48:63], v[44:47], v[192:195], v[48:63]
    ds_read_b128 v[40:43], v3 offset:10240
    v_rcp_f32 v94, v94
    v_mul_f32 v109, v93, v109
    s_waitcnt lgkmcnt(3)
    v_mfma_f32_32x32x16_bf16 v[64:79], v[24:27], v[192:195], v[64:79]
    ds_read_b128 v[44:47], v1 offset:60416
    v_rcp_f32 v95, v95
    v_mul_f32 v110, v94, v110
    v_mul_f32 v111, v95, v111
    v_cvt_pk_bf16_f32 v16, v104, v105
    v_mfma_f32_32x32x16_bf16 v[48:63], v[28:31], v[196:199], v[48:63]
    ds_read_b128 v[24:27], v3 offset:11264
    v_cvt_pk_bf16_f32 v17, v106, v107
    v_cvt_pk_bf16_f32 v18, v108, v109
    v_cvt_pk_bf16_f32 v19, v110, v111
    s_waitcnt lgkmcnt(3)
    v_mfma_f32_32x32x16_bf16 v[64:79], v[32:35], v[196:199], v[64:79]
    ds_read_b128 v[28:31], v1 offset:61440
    buffer_store_dwordx4 v[16:19], v1, s[8:11], s35 offen offset:1024 sc1
    v_mul_f32 v112, v20, v112
    v_mul_f32 v113, v20, v113
    v_mfma_f32_32x32x16_bf16 v[48:63], v[36:39], v[200:203], v[48:63]
    ds_read_b128 v[32:35], v3 offset:12288
    v_exp_f32 v112, v112
    v_mul_f32 v114, v20, v114
    s_waitcnt lgkmcnt(3)
    v_mfma_f32_32x32x16_bf16 v[64:79], v[40:43], v[200:203], v[64:79]
    ds_read_b128 v[36:39], v1 offset:62464
    v_exp_f32 v113, v113
    v_fma_f32 v112, v112, v21, v21
    v_mul_f32 v115, v20, v115
    v_mfma_f32_32x32x16_bf16 v[48:63], v[44:47], v[204:207], v[48:63]
    ds_read_b128 v[40:43], v3 offset:13312
    v_exp_f32 v114, v114
    v_fma_f32 v113, v113, v21, v21
    s_waitcnt lgkmcnt(3)
    v_mfma_f32_32x32x16_bf16 v[64:79], v[24:27], v[204:207], v[64:79]
    ds_read_b128 v[44:47], v1 offset:63488
    v_rcp_f32 v112, v112
    v_mul_f32 v116, v20, v116
    v_exp_f32 v115, v115
    v_mfma_f32_32x32x16_bf16 v[48:63], v[28:31], v[208:211], v[48:63]
    ds_read_b128 v[24:27], v3 offset:14336
    v_fma_f32 v114, v114, v21, v21
    v_rcp_f32 v113, v113
    v_mul_f32 v120, v112, v120
    s_waitcnt lgkmcnt(3)
    v_mfma_f32_32x32x16_bf16 v[64:79], v[32:35], v[208:211], v[64:79]
    ds_read_b128 v[28:31], v1 offset:64512
    v_mul_f32 v117, v20, v117
    v_exp_f32 v116, v116
    v_fma_f32 v115, v115, v21, v21
    v_mfma_f32_32x32x16_bf16 v[48:63], v[36:39], v[212:215], v[48:63]
    ds_read_b128 v[32:35], v3 offset:15360
    v_rcp_f32 v114, v114
    v_mul_f32 v121, v113, v121
    v_mul_f32 v118, v20, v118
    s_waitcnt lgkmcnt(3)
    v_mfma_f32_32x32x16_bf16 v[64:79], v[40:43], v[212:215], v[64:79]
    s_barrier
    ds_read_b128 v[36:39], v3 offset:16384
    v_exp_f32 v117, v117
    v_fma_f32 v116, v116, v21, v21
    v_mfma_f32_32x32x16_bf16 v[48:63], v[44:47], v[216:219], v[48:63]
    ds_read_b128 v[40:43], v2 offset:0
    v_rcp_f32 v115, v115
    v_mul_f32 v122, v114, v122
    v_mul_f32 v119, v20, v119
    s_waitcnt lgkmcnt(3)
    v_mfma_f32_32x32x16_bf16 v[64:79], v[24:27], v[216:219], v[64:79]
    ds_read_b128 v[44:47], v3 offset:17408
    v_exp_f32 v118, v118
    v_fma_f32 v117, v117, v21, v21
    v_rcp_f32 v116, v116
    v_mfma_f32_32x32x16_bf16 v[48:63], v[28:31], v[220:223], v[48:63]
    ds_read_b128 v[24:27], v2 offset:1024
    v_mul_f32 v123, v115, v123
    v_exp_f32 v119, v119
    v_fma_f32 v118, v118, v21, v21
    s_waitcnt lgkmcnt(3)
    v_mfma_f32_32x32x16_bf16 v[64:79], v[32:35], v[220:223], v[64:79]
    ds_read_b128 v[28:31], v3 offset:18432
    v_rcp_f32 v117, v117
    v_mul_f32 v124, v116, v124
    v_fma_f32 v119, v119, v21, v21
    v_mfma_f32_32x32x16_bf16 v[48:63], v[36:39], v[224:227], v[48:63]
    ds_read_b128 v[32:35], v2 offset:2048
    v_rcp_f32 v118, v118
    v_mul_f32 v125, v117, v125
    s_waitcnt lgkmcnt(3)
    v_mfma_f32_32x32x16_bf16 v[64:79], v[40:43], v[224:227], v[64:79]
    ds_read_b128 v[36:39], v3 offset:19456
    v_rcp_f32 v119, v119
    v_mul_f32 v126, v118, v126
    v_mul_f32 v127, v119, v127
    v_cvt_pk_bf16_f32 v16, v120, v121
    v_mfma_f32_32x32x16_bf16 v[48:63], v[44:47], v[228:231], v[48:63]
    ds_read_b128 v[40:43], v2 offset:3072
    v_cvt_pk_bf16_f32 v17, v122, v123
    v_cvt_pk_bf16_f32 v18, v124, v125
    v_cvt_pk_bf16_f32 v19, v126, v127
    s_waitcnt lgkmcnt(3)
    v_mfma_f32_32x32x16_bf16 v[64:79], v[24:27], v[228:231], v[64:79]
    ds_read_b128 v[44:47], v3 offset:20480
    buffer_store_dwordx4 v[16:19], v1, s[8:11], s36 offen offset:0 sc1
    v_mfma_f32_32x32x16_bf16 v[48:63], v[28:31], v[232:235], v[48:63]
    ds_read_b128 v[24:27], v2 offset:4096
    s_waitcnt lgkmcnt(3)
    v_mfma_f32_32x32x16_bf16 v[64:79], v[32:35], v[232:235], v[64:79]
    ds_read_b128 v[28:31], v3 offset:21504
    v_mfma_f32_32x32x16_bf16 v[48:63], v[36:39], v[236:239], v[48:63]
    ds_read_b128 v[32:35], v2 offset:5120
    s_waitcnt lgkmcnt(3)
    v_mfma_f32_32x32x16_bf16 v[64:79], v[40:43], v[236:239], v[64:79]
    ds_read_b128 v[36:39], v3 offset:22528
    v_mfma_f32_32x32x16_bf16 v[48:63], v[44:47], v[240:243], v[48:63]
    ds_read_b128 v[40:43], v2 offset:6144
    s_waitcnt lgkmcnt(3)
    v_mfma_f32_32x32x16_bf16 v[64:79], v[24:27], v[240:243], v[64:79]
    ds_read_b128 v[44:47], v3 offset:23552
    v_mfma_f32_32x32x16_bf16 v[48:63], v[28:31], v[244:247], v[48:63]
    ds_read_b128 v[24:27], v2 offset:7168
    s_waitcnt lgkmcnt(3)
    v_mfma_f32_32x32x16_bf16 v[64:79], v[32:35], v[244:247], v[64:79]
    ds_read_b64 v[28:29], v10 offset:1536
    v_mfma_f32_32x32x16_bf16 v[48:63], v[36:39], v[248:251], v[48:63]
    ds_read_b64 v[32:33], v10 offset:1792
    s_waitcnt lgkmcnt(3)
    v_mfma_f32_32x32x16_bf16 v[64:79], v[40:43], v[248:251], v[64:79]
    s_barrier
    ds_read_b128 v[36:39], v2 offset:8192
    v_mfma_f32_32x32x16_bf16 v[48:63], v[44:47], v[252:255], v[48:63]
    ds_read_b128 v[40:43], v2 offset:16384
    s_waitcnt lgkmcnt(3)
    v_mfma_f32_32x32x16_bf16 v[64:79], v[24:27], v[252:255], v[64:79]
    ds_read_b128 v[44:47], v2 offset:9216
    v_mfma_f32_32x32x16_bf16 v[48:63], v[28:31], v[12:15], v[48:63]
    ds_read_b128 v[24:27], v2 offset:17408
    s_waitcnt lgkmcnt(3)
    v_mfma_f32_32x32x16_bf16 v[64:79], v[32:35], v[12:15], v[64:79]
    ds_read_b128 v[28:31], v2 offset:10240
    v_mfma_f32_32x32x16_bf16 v[80:95], v[36:39], v[128:131], 0
    ds_read_b128 v[32:35], v2 offset:18432
    s_waitcnt lgkmcnt(3)
    v_mfma_f32_32x32x16_bf16 v[96:111], v[40:43], v[128:131], 0
    ds_read_b128 v[36:39], v2 offset:11264
    v_mfma_f32_32x32x16_bf16 v[80:95], v[44:47], v[132:135], v[80:95]
    ds_read_b128 v[40:43], v2 offset:19456
    s_waitcnt lgkmcnt(3)
    v_mfma_f32_32x32x16_bf16 v[96:111], v[24:27], v[132:135], v[96:111]
    ds_read_b128 v[44:47], v2 offset:12288
    v_mfma_f32_32x32x16_bf16 v[80:95], v[28:31], v[136:139], v[80:95]
    ds_read_b128 v[24:27], v2 offset:20480
    buffer_load_dwordx4 v[112:115], v1, s[8:11], s31 offen offset:0 sc1
    s_waitcnt lgkmcnt(3)
    v_mfma_f32_32x32x16_bf16 v[96:111], v[32:35], v[136:139], v[96:111]
    ds_read_b128 v[28:31], v2 offset:13312
    buffer_load_dwordx4 v[116:119], v1, s[8:11], s31 offen offset:1024 sc1
    v_mul_f32 v48, v20, v48
    v_mfma_f32_32x32x16_bf16 v[80:95], v[36:39], v[140:143], v[80:95]
    ds_read_b128 v[32:35], v2 offset:21504
    v_mul_f32 v49, v20, v49
    v_exp_f32 v48, v48
    s_waitcnt lgkmcnt(3)
    v_mfma_f32_32x32x16_bf16 v[96:111], v[40:43], v[140:143], v[96:111]
    ds_read_b128 v[36:39], v2 offset:14336
    v_mul_f32 v50, v20, v50
    v_exp_f32 v49, v49
    v_fma_f32 v48, v48, v21, v21
    v_mfma_f32_32x32x16_bf16 v[80:95], v[44:47], v[144:147], v[80:95]
    ds_read_b128 v[40:43], v2 offset:22528
    v_mul_f32 v51, v20, v51
    v_exp_f32 v50, v50
    s_waitcnt lgkmcnt(3)
    v_mfma_f32_32x32x16_bf16 v[96:111], v[24:27], v[144:147], v[96:111]
    ds_read_b128 v[44:47], v2 offset:15360
    v_fma_f32 v49, v49, v21, v21
    v_rcp_f32 v48, v48
    v_mul_f32 v52, v20, v52
    v_mfma_f32_32x32x16_bf16 v[80:95], v[28:31], v[148:151], v[80:95]
    ds_read_b128 v[24:27], v2 offset:23552
    v_exp_f32 v51, v51
    v_fma_f32 v50, v50, v21, v21
    s_waitcnt lgkmcnt(3)
    v_mfma_f32_32x32x16_bf16 v[96:111], v[32:35], v[148:151], v[96:111]
    s_waitcnt vmcnt(2)
    s_barrier
    ds_read_b128 v[28:31], v2 offset:24576
    v_rcp_f32 v49, v49
    v_mfma_f32_32x32x16_bf16 v[80:95], v[36:39], v[152:155], v[80:95]
    ds_read_b128 v[32:35], v2 offset:32768
    v_mul_f32 v64, v48, v64
    v_mul_f32 v53, v20, v53
    s_waitcnt lgkmcnt(3)
    v_mfma_f32_32x32x16_bf16 v[96:111], v[40:43], v[152:155], v[96:111]
    ds_read_b128 v[36:39], v2 offset:25600
    v_exp_f32 v52, v52
    v_fma_f32 v51, v51, v21, v21
    v_mfma_f32_32x32x16_bf16 v[80:95], v[44:47], v[156:159], v[80:95]
    ds_read_b128 v[40:43], v2 offset:33792
    v_rcp_f32 v50, v50
    v_mul_f32 v65, v49, v65
    s_waitcnt lgkmcnt(3)
    v_mfma_f32_32x32x16_bf16 v[96:111], v[24:27], v[156:159], v[96:111]
    ds_read_b128 v[44:47], v2 offset:26624
    v_mul_f32 v54, v20, v54
    v_exp_f32 v53, v53
    v_fma_f32 v52, v52, v21, v21
    v_mfma_f32_32x32x16_bf16 v[80:95], v[28:31], v[160:163], v[80:95]
    ds_read_b128 v[24:27], v2 offset:34816
    v_rcp_f32 v51, v51
    v_mul_f32 v66, v50, v66
    s_waitcnt lgkmcnt(3)
    v_mfma_f32_32x32x16_bf16 v[96:111], v[32:35], v[160:163], v[96:111]
    ds_read_b128 v[28:31], v2 offset:27648
    v_mul_f32 v55, v20, v55
    v_exp_f32 v54, v54
    v_fma_f32 v53, v53, v21, v21
    v_mfma_f32_32x32x16_bf16 v[80:95], v[36:39], v[164:167], v[80:95]
    ds_read_b128 v[32:35], v2 offset:35840
    v_rcp_f32 v52, v52
    v_mul_f32 v67, v51, v67
    s_waitcnt lgkmcnt(3)
    v_mfma_f32_32x32x16_bf16 v[96:111], v[40:43], v[164:167], v[96:111]
    ds_read_b128 v[36:39], v2 offset:28672
    v_exp_f32 v55, v55
    v_fma_f32 v54, v54, v21, v21
    v_mfma_f32_32x32x16_bf16 v[80:95], v[44:47], v[168:171], v[80:95]
    ds_read_b128 v[40:43], v2 offset:36864
    v_rcp_f32 v53, v53
    v_mul_f32 v68, v52, v68
    s_waitcnt lgkmcnt(3)
    v_mfma_f32_32x32x16_bf16 v[96:111], v[24:27], v[168:171], v[96:111]
    ds_read_b128 v[44:47], v2 offset:29696
    v_fma_f32 v55, v55, v21, v21
    v_rcp_f32 v54, v54
    v_mul_f32 v69, v53, v69
    v_mfma_f32_32x32x16_bf16 v[80:95], v[28:31], v[172:175], v[80:95]
    ds_read_b128 v[24:27], v2 offset:37888
    v_rcp_f32 v55, v55
    v_mul_f32 v70, v54, v70
    s_waitcnt lgkmcnt(3)
    v_mfma_f32_32x32x16_bf16 v[96:111], v[32:35], v[172:175], v[96:111]
    ds_read_b128 v[28:31], v2 offset:30720
    v_mul_f32 v71, v55, v71
    v_cvt_pk_bf16_f32 v16, v64, v65
    v_cvt_pk_bf16_f32 v17, v66, v67
    v_cvt_pk_bf16_f32 v18, v68, v69
    v_mfma_f32_32x32x16_bf16 v[80:95], v[36:39], v[176:179], v[80:95]
    ds_read_b128 v[32:35], v2 offset:38912
    v_cvt_pk_bf16_f32 v19, v70, v71
    s_waitcnt lgkmcnt(3)
    v_mfma_f32_32x32x16_bf16 v[96:111], v[40:43], v[176:179], v[96:111]
    ds_read_b128 v[36:39], v2 offset:31744
    buffer_store_dwordx4 v[16:19], v1, s[8:11], s35 offen offset:2048 sc1
    v_mul_f32 v56, v20, v56
    v_mfma_f32_32x32x16_bf16 v[80:95], v[44:47], v[180:183], v[80:95]
    ds_read_b128 v[40:43], v2 offset:39936
    v_mul_f32 v57, v20, v57
    v_exp_f32 v56, v56
    s_waitcnt lgkmcnt(3)
    v_mfma_f32_32x32x16_bf16 v[96:111], v[24:27], v[180:183], v[96:111]
    s_barrier
    ds_read_b128 v[44:47], v1 offset:0
    v_mul_f32 v58, v20, v58
    v_exp_f32 v57, v57
    v_mfma_f32_32x32x16_bf16 v[80:95], v[28:31], v[184:187], v[80:95]
    ds_read_b128 v[24:27], v1 offset:8192
    v_fma_f32 v56, v56, v21, v21
    v_mul_f32 v59, v20, v59
    s_waitcnt lgkmcnt(3)
    v_mfma_f32_32x32x16_bf16 v[96:111], v[32:35], v[184:187], v[96:111]
    ds_read_b128 v[28:31], v1 offset:1024
    v_exp_f32 v58, v58
    v_fma_f32 v57, v57, v21, v21
    v_mfma_f32_32x32x16_bf16 v[80:95], v[36:39], v[188:191], v[80:95]
    ds_read_b128 v[32:35], v1 offset:9216
    v_rcp_f32 v56, v56
    v_mul_f32 v60, v20, v60
    s_waitcnt lgkmcnt(3)
    v_mfma_f32_32x32x16_bf16 v[96:111], v[40:43], v[188:191], v[96:111]
    ds_read_b128 v[36:39], v1 offset:2048
    v_exp_f32 v59, v59
    v_fma_f32 v58, v58, v21, v21
    v_mfma_f32_32x32x16_bf16 v[80:95], v[44:47], v[192:195], v[80:95]
    ds_read_b128 v[40:43], v1 offset:10240
    v_rcp_f32 v57, v57
    v_mul_f32 v72, v56, v72
    s_waitcnt lgkmcnt(3)
    v_mfma_f32_32x32x16_bf16 v[96:111], v[24:27], v[192:195], v[96:111]
    ds_read_b128 v[44:47], v1 offset:3072
    v_mul_f32 v61, v20, v61
    v_exp_f32 v60, v60
    v_fma_f32 v59, v59, v21, v21
    v_mfma_f32_32x32x16_bf16 v[80:95], v[28:31], v[196:199], v[80:95]
    ds_read_b128 v[24:27], v1 offset:11264
    v_rcp_f32 v58, v58
    v_mul_f32 v73, v57, v73
    s_waitcnt lgkmcnt(3)
    v_mfma_f32_32x32x16_bf16 v[96:111], v[32:35], v[196:199], v[96:111]
    ds_read_b128 v[28:31], v1 offset:4096
    v_mul_f32 v62, v20, v62
    v_exp_f32 v61, v61
    v_fma_f32 v60, v60, v21, v21
    v_mfma_f32_32x32x16_bf16 v[80:95], v[36:39], v[200:203], v[80:95]
    ds_read_b128 v[32:35], v1 offset:12288
    v_rcp_f32 v59, v59
    v_mul_f32 v74, v58, v74
    s_waitcnt lgkmcnt(3)
    v_mfma_f32_32x32x16_bf16 v[96:111], v[40:43], v[200:203], v[96:111]
    ds_read_b128 v[36:39], v1 offset:5120
    v_mul_f32 v63, v20, v63
    v_exp_f32 v62, v62
    v_fma_f32 v61, v61, v21, v21
    v_mfma_f32_32x32x16_bf16 v[80:95], v[44:47], v[204:207], v[80:95]
    ds_read_b128 v[40:43], v1 offset:13312
    v_rcp_f32 v60, v60
    v_mul_f32 v75, v59, v75
    s_waitcnt lgkmcnt(3)
    v_mfma_f32_32x32x16_bf16 v[96:111], v[24:27], v[204:207], v[96:111]
    ds_read_b128 v[44:47], v1 offset:6144
    v_exp_f32 v63, v63
    v_fma_f32 v62, v62, v21, v21
    v_mfma_f32_32x32x16_bf16 v[80:95], v[28:31], v[208:211], v[80:95]
    ds_read_b128 v[24:27], v1 offset:14336
    v_rcp_f32 v61, v61
    v_mul_f32 v76, v60, v76
    s_waitcnt lgkmcnt(3)
    v_mfma_f32_32x32x16_bf16 v[96:111], v[32:35], v[208:211], v[96:111]
    ds_read_b128 v[28:31], v1 offset:7168
    v_fma_f32 v63, v63, v21, v21
    v_rcp_f32 v62, v62
    v_mul_f32 v77, v61, v77
    v_mfma_f32_32x32x16_bf16 v[80:95], v[36:39], v[212:215], v[80:95]
    ds_read_b128 v[32:35], v1 offset:15360
    v_rcp_f32 v63, v63
    v_mul_f32 v78, v62, v78
    s_waitcnt lgkmcnt(3)
    v_mfma_f32_32x32x16_bf16 v[96:111], v[40:43], v[212:215], v[96:111]
    s_barrier
    ds_read_b128 v[36:39], v1 offset:16384
    v_mul_f32 v79, v63, v79
    v_cvt_pk_bf16_f32 v16, v72, v73
    v_cvt_pk_bf16_f32 v17, v74, v75
    v_mfma_f32_32x32x16_bf16 v[80:95], v[44:47], v[216:219], v[80:95]
    ds_read_b128 v[40:43], v1 offset:24576
    v_cvt_pk_bf16_f32 v18, v76, v77
    v_cvt_pk_bf16_f32 v19, v78, v79
    s_waitcnt lgkmcnt(3)
    v_mfma_f32_32x32x16_bf16 v[96:111], v[24:27], v[216:219], v[96:111]
    ds_read_b128 v[44:47], v1 offset:17408
    buffer_store_dwordx4 v[16:19], v1, s[8:11], s35 offen offset:3072 sc1
    s_lshl_b32 s60, s3, 12
    v_mfma_f32_32x32x16_bf16 v[80:95], v[28:31], v[220:223], v[80:95]
    ds_read_b128 v[24:27], v1 offset:25600
    s_add_u32 s60, s60, 81920
    v_add_u32 v120, s60, v1
    s_xor_b32 s60, s3, 2
    s_waitcnt lgkmcnt(3)
    v_mfma_f32_32x32x16_bf16 v[96:111], v[32:35], v[220:223], v[96:111]
    ds_read_b128 v[28:31], v1 offset:18432
    s_lshl_b32 s60, s60, 12
    s_add_u32 s60, s60, 81920
    v_add_u32 v121, s60, v1
    v_lshrrev_b32 v122, 5, v0
    v_mfma_f32_32x32x16_bf16 v[80:95], v[36:39], v[224:227], v[80:95]
    ds_read_b128 v[32:35], v1 offset:26624
    v_and_b32 v123, 0xff, v11
    v_lshl_add_u32 v122, v122, 2, v123
    s_waitcnt vmcnt(3)
    v_lshlrev_b32 v48, 16, v112
    s_waitcnt lgkmcnt(3)
    v_mfma_f32_32x32x16_bf16 v[96:111], v[40:43], v[224:227], v[96:111]
    ds_read_b128 v[36:39], v1 offset:19456
    v_and_b32 v49, 0xffff0000, v112
    v_lshlrev_b32 v50, 16, v113
    v_and_b32 v51, 0xffff0000, v113
    v_lshlrev_b32 v52, 16, v114
    v_mfma_f32_32x32x16_bf16 v[80:95], v[44:47], v[228:231], v[80:95]
    ds_read_b128 v[40:43], v1 offset:27648
    v_and_b32 v53, 0xffff0000, v114
    v_lshlrev_b32 v54, 16, v115
    v_and_b32 v55, 0xffff0000, v115
    s_waitcnt lgkmcnt(3)
    v_mfma_f32_32x32x16_bf16 v[96:111], v[24:27], v[228:231], v[96:111]
    ds_read_b128 v[44:47], v1 offset:20480
    s_waitcnt vmcnt(2)
    v_lshlrev_b32 v56, 16, v116
    v_and_b32 v57, 0xffff0000, v116
    v_lshlrev_b32 v58, 16, v117
    v_and_b32 v59, 0xffff0000, v117
    v_mfma_f32_32x32x16_bf16 v[80:95], v[28:31], v[232:235], v[80:95]
    ds_read_b128 v[24:27], v1 offset:28672
    v_lshlrev_b32 v60, 16, v118
    v_and_b32 v61, 0xffff0000, v118
    v_lshlrev_b32 v62, 16, v119
    s_waitcnt lgkmcnt(3)
    v_mfma_f32_32x32x16_bf16 v[96:111], v[32:35], v[232:235], v[96:111]
    ds_read_b128 v[28:31], v1 offset:21504
    v_and_b32 v63, 0xffff0000, v119
    v_mfma_f32_32x32x16_bf16 v[80:95], v[36:39], v[236:239], v[80:95]
    ds_read_b128 v[32:35], v1 offset:29696
    s_waitcnt lgkmcnt(3)
    v_mfma_f32_32x32x16_bf16 v[96:111], v[40:43], v[236:239], v[96:111]
    ds_read_b128 v[36:39], v1 offset:22528
    v_mfma_f32_32x32x16_bf16 v[80:95], v[44:47], v[240:243], v[80:95]
    ds_read_b128 v[40:43], v1 offset:30720
    s_waitcnt lgkmcnt(3)
    v_mfma_f32_32x32x16_bf16 v[96:111], v[24:27], v[240:243], v[96:111]
    ds_read_b128 v[44:47], v1 offset:23552
    v_mfma_f32_32x32x16_bf16 v[80:95], v[28:31], v[244:247], v[80:95]
    ds_read_b128 v[24:27], v1 offset:31744
    s_waitcnt lgkmcnt(3)
    v_mfma_f32_32x32x16_bf16 v[96:111], v[32:35], v[244:247], v[96:111]
    ds_read_b64 v[28:29], v10 offset:2048
    v_mfma_f32_32x32x16_bf16 v[80:95], v[36:39], v[248:251], v[80:95]
    ds_read_b64 v[32:33], v10 offset:2304
    s_waitcnt lgkmcnt(3)
    v_mfma_f32_32x32x16_bf16 v[96:111], v[40:43], v[248:251], v[96:111]
    v_mfma_f32_32x32x16_bf16 v[80:95], v[44:47], v[252:255], v[80:95]
    s_waitcnt lgkmcnt(1)
    v_mfma_f32_32x32x16_bf16 v[96:111], v[24:27], v[252:255], v[96:111]
    v_mfma_f32_32x32x16_bf16 v[80:95], v[28:31], v[12:15], v[80:95]
    s_waitcnt lgkmcnt(0)
    v_mfma_f32_32x32x16_bf16 v[96:111], v[32:35], v[12:15], v[96:111]
    s_waitcnt vmcnt(0)
    s_barrier
    s_mul_i32 s59, s74, 14
    s_add_u32 s59, s59, s37
    buffer_load_dwordx4 v[128:131], v1, s[8:11], s59 offen offset:0 sc1
    buffer_load_dwordx4 v[132:135], v1, s[8:11], s59 offen offset:1024 sc1
    s_add_u32 s59, s59, 0x1000
    buffer_load_dwordx4 v[136:139], v1, s[8:11], s59 offen offset:2048 sc1
    buffer_load_dwordx4 v[140:143], v1, s[8:11], s59 offen offset:3072 sc1
    s_add_u32 s59, s59, 0x1000
    buffer_load_dwordx4 v[144:147], v1, s[8:11], s59 offen offset:0 sc1
    buffer_load_dwordx4 v[148:151], v1, s[8:11], s59 offen offset:1024 sc1
    s_mul_i32 s59, s75, 14
    s_add_u32 s59, s59, s37
    buffer_load_dwordx4 v[152:155], v1, s[8:11], s59 offen offset:0 sc1
    buffer_load_dwordx4 v[156:159], v1, s[8:11], s59 offen offset:1024 sc1
    ds_read_b64_tr_b16 v[24:25], v4 offset:32768
    ds_read_b64_tr_b16 v[26:27], v4 offset:33792
    ds_read_b64_tr_b16 v[28:29], v7 offset:32768
    ds_read_b64_tr_b16 v[30:31], v7 offset:33792
    ds_read_b64_tr_b16 v[32:33], v4 offset:34816
    ds_read_b64_tr_b16 v[34:35], v4 offset:35840
    ds_read_b64_tr_b16 v[36:37], v7 offset:34816
    ds_read_b64_tr_b16 v[38:39], v7 offset:35840
    ds_read_b64_tr_b16 v[40:41], v5 offset:40960
    ds_read_b64_tr_b16 v[42:43], v5 offset:41984
    v_mul_f32 v80, v20, v80
    v_mul_f32 v81, v20, v81
    v_exp_f32 v80, v80
    v_mul_f32 v82, v20, v82
    v_exp_f32 v81, v81
    v_fma_f32 v80, v80, v21, v21
    v_mul_f32 v83, v20, v83
    v_exp_f32 v82, v82
    v_fma_f32 v81, v81, v21, v21
    v_rcp_f32 v80, v80
    v_mul_f32 v84, v20, v84
    v_exp_f32 v83, v83
    v_fma_f32 v82, v82, v21, v21
    v_rcp_f32 v81, v81
    v_mul_f32 v96, v80, v96
    v_mul_f32 v85, v20, v85
    v_exp_f32 v84, v84
    v_fma_f32 v83, v83, v21, v21
    v_rcp_f32 v82, v82
    v_mul_f32 v97, v81, v97
    v_mul_f32 v86, v20, v86
    v_exp_f32 v85, v85
    v_fma_f32 v84, v84, v21, v21
    v_rcp_f32 v83, v83
    v_mul_f32 v98, v82, v98
    v_mul_f32 v87, v20, v87
    v_exp_f32 v86, v86
    v_fma_f32 v85, v85, v21, v21
    v_rcp_f32 v84, v84
    v_mul_f32 v99, v83, v99
    v_exp_f32 v87, v87
    v_fma_f32 v86, v86, v21, v21
    v_rcp_f32 v85, v85
    v_mul_f32 v100, v84, v100
    v_fma_f32 v87, v87, v21, v21
    v_rcp_f32 v86, v86
    v_mul_f32 v101, v85, v101
    v_rcp_f32 v87, v87
    v_mul_f32 v102, v86, v102
    v_mul_f32 v103, v87, v103
    v_cvt_pk_bf16_f32 v16, v96, v97
    v_cvt_pk_bf16_f32 v17, v98, v99
    v_cvt_pk_bf16_f32 v18, v100, v101
    v_cvt_pk_bf16_f32 v19, v102, v103
    buffer_store_dwordx4 v[16:19], v1, s[8:11], s57 offen offset:0 sc1
    v_mul_f32 v88, v20, v88
    v_mul_f32 v89, v20, v89
    v_exp_f32 v88, v88
    v_mul_f32 v90, v20, v90
    v_exp_f32 v89, v89
    v_fma_f32 v88, v88, v21, v21
    v_mul_f32 v91, v20, v91
    v_exp_f32 v90, v90
    v_fma_f32 v89, v89, v21, v21
    v_rcp_f32 v88, v88
    v_mul_f32 v92, v20, v92
    v_exp_f32 v91, v91
    v_fma_f32 v90, v90, v21, v21
    v_rcp_f32 v89, v89
    v_mul_f32 v104, v88, v104
    v_mul_f32 v93, v20, v93
    v_exp_f32 v92, v92
    v_fma_f32 v91, v91, v21, v21
    v_rcp_f32 v90, v90
    v_mul_f32 v105, v89, v105
    v_mul_f32 v94, v20, v94
    v_exp_f32 v93, v93
    v_fma_f32 v92, v92, v21, v21
    v_rcp_f32 v91, v91
    v_mul_f32 v106, v90, v106
    v_mul_f32 v95, v20, v95
    v_exp_f32 v94, v94
    v_fma_f32 v93, v93, v21, v21
    v_rcp_f32 v92, v92
    v_mul_f32 v107, v91, v107
    v_exp_f32 v95, v95
    v_fma_f32 v94, v94, v21, v21
    v_rcp_f32 v93, v93
    v_mul_f32 v108, v92, v108
    v_fma_f32 v95, v95, v21, v21
    v_rcp_f32 v94, v94
    v_mul_f32 v109, v93, v109
    v_rcp_f32 v95, v95
    v_mul_f32 v110, v94, v110
    v_mul_f32 v111, v95, v111
    v_cvt_pk_bf16_f32 v16, v104, v105
    v_cvt_pk_bf16_f32 v17, v106, v107
    v_cvt_pk_bf16_f32 v18, v108, v109
    v_cvt_pk_bf16_f32 v19, v110, v111
    buffer_store_dwordx4 v[16:19], v1, s[8:11], s57 offen offset:1024 sc1
    s_waitcnt lgkmcnt(6)
    s_waitcnt vmcnt(9)
    v_mfma_f32_32x32x16_bf16 v[48:63], v[24:27], v[128:131], v[48:63]
    ds_read_b64_tr_b16 v[44:45], v8 offset:40960
    ds_read_b64_tr_b16 v[46:47], v8 offset:41984
    v_mfma_f32_32x32x16_bf16 v[64:79], v[28:31], v[128:131], 0
    ds_read_b64_tr_b16 v[24:25], v5 offset:43008
    ds_read_b64_tr_b16 v[26:27], v5 offset:44032
    s_add_u32 s59, s59, 0x1000
    buffer_load_dwordx4 v[160:163], v1, s[8:11], s59 offen offset:2048 sc1
    buffer_load_dwordx4 v[164:167], v1, s[8:11], s59 offen offset:3072 sc1
    s_waitcnt lgkmcnt(6)
    s_waitcnt vmcnt(10)
    v_mfma_f32_32x32x16_bf16 v[48:63], v[32:35], v[132:135], v[48:63]
    ds_read_b64_tr_b16 v[28:29], v8 offset:43008
    ds_read_b64_tr_b16 v[30:31], v8 offset:44032
    v_mfma_f32_32x32x16_bf16 v[64:79], v[36:39], v[132:135], v[64:79]
    s_barrier
    ds_read_b64_tr_b16 v[32:33], v4 offset:40960
    ds_read_b64_tr_b16 v[34:35], v4 offset:41984
    s_add_u32 s59, s59, 0x1000
    buffer_load_dwordx4 v[168:171], v1, s[8:11], s59 offen offset:0 sc1
    s_waitcnt lgkmcnt(6)
    s_waitcnt vmcnt(10)
    v_mfma_f32_32x32x16_bf16 v[48:63], v[40:43], v[136:139], v[48:63]
    ds_read_b64_tr_b16 v[36:37], v7 offset:40960
    ds_read_b64_tr_b16 v[38:39], v7 offset:41984
    v_mfma_f32_32x32x16_bf16 v[64:79], v[44:47], v[136:139], v[64:79]
    ds_read_b64_tr_b16 v[40:41], v4 offset:43008
    ds_read_b64_tr_b16 v[42:43], v4 offset:44032
    buffer_load_dwordx4 v[172:175], v1, s[8:11], s59 offen offset:1024 sc1
    s_waitcnt lgkmcnt(6)
    s_waitcnt vmcnt(10)
    v_mfma_f32_32x32x16_bf16 v[48:63], v[24:27], v[140:143], v[48:63]
    ds_read_b64_tr_b16 v[44:45], v7 offset:43008
    ds_read_b64_tr_b16 v[46:47], v7 offset:44032
    v_mfma_f32_32x32x16_bf16 v[64:79], v[28:31], v[140:143], v[64:79]
    ds_read_b64_tr_b16 v[24:25], v4 offset:49152
    ds_read_b64_tr_b16 v[26:27], v4 offset:50176
    s_mul_i32 s59, s76, 14
    s_add_u32 s59, s59, s37
    buffer_load_dwordx4 v[176:179], v1, s[8:11], s59 offen offset:0 sc1
    s_waitcnt lgkmcnt(6)
    s_waitcnt vmcnt(10)
    v_mfma_f32_32x32x16_bf16 v[48:63], v[32:35], v[144:147], v[48:63]
    ds_read_b64_tr_b16 v[28:29], v7 offset:49152
    ds_read_b64_tr_b16 v[30:31], v7 offset:50176
    v_mfma_f32_32x32x16_bf16 v[64:79], v[36:39], v[144:147], v[64:79]
    ds_read_b64_tr_b16 v[32:33], v4 offset:51200
    ds_read_b64_tr_b16 v[34:35], v4 offset:52224
    buffer_load_dwordx4 v[180:183], v1, s[8:11], s59 offen offset:1024 sc1
    s_waitcnt lgkmcnt(6)
    s_waitcnt vmcnt(10)
    v_mfma_f32_32x32x16_bf16 v[48:63], v[40:43], v[148:151], v[48:63]
    ds_read_b64_tr_b16 v[36:37], v7 offset:51200
    ds_read_b64_tr_b16 v[38:39], v7 offset:52224
    v_mfma_f32_32x32x16_bf16 v[64:79], v[44:47], v[148:151], v[64:79]
    s_waitcnt vmcnt(6)
    s_barrier
    ds_read_b64_tr_b16 v[40:41], v5 offset:49152
    ds_read_b64_tr_b16 v[42:43], v5 offset:50176
    s_add_u32 s59, s59, 0x1000
    buffer_load_dwordx4 v[184:187], v1, s[8:11], s59 offen offset:2048 sc1
    s_waitcnt lgkmcnt(6)
    v_mfma_f32_32x32x16_bf16 v[48:63], v[24:27], v[152:155], v[48:63]
    ds_read_b64_tr_b16 v[44:45], v8 offset:49152
    ds_read_b64_tr_b16 v[46:47], v8 offset:50176
    v_mfma_f32_32x32x16_bf16 v[64:79], v[28:31], v[152:155], v[64:79]
    ds_read_b64_tr_b16 v[24:25], v5 offset:51200
    ds_read_b64_tr_b16 v[26:27], v5 offset:52224
    buffer_load_dwordx4 v[188:191], v1, s[8:11], s59 offen offset:3072 sc1
    s_waitcnt lgkmcnt(6)
    v_mfma_f32_32x32x16_bf16 v[48:63], v[32:35], v[156:159], v[48:63]
    ds_read_b64_tr_b16 v[28:29], v8 offset:51200
    ds_read_b64_tr_b16 v[30:31], v8 offset:52224
    v_mfma_f32_32x32x16_bf16 v[64:79], v[36:39], v[156:159], v[64:79]
    ds_read_b64_tr_b16 v[32:33], v4 offset:57344
    ds_read_b64_tr_b16 v[34:35], v4 offset:58368
    s_add_u32 s59, s59, 0x1000
    buffer_load_dwordx4 v[192:195], v1, s[8:11], s59 offen offset:0 sc1
    s_waitcnt lgkmcnt(6)
    s_waitcnt vmcnt(8)
    v_mfma_f32_32x32x16_bf16 v[48:63], v[40:43], v[160:163], v[48:63]
    ds_read_b64_tr_b16 v[36:37], v7 offset:57344
    ds_read_b64_tr_b16 v[38:39], v7 offset:58368
    v_mfma_f32_32x32x16_bf16 v[64:79], v[44:47], v[160:163], v[64:79]
    ds_read_b64_tr_b16 v[40:41], v4 offset:59392
    ds_read_b64_tr_b16 v[42:43], v4 offset:60416
    buffer_load_dwordx4 v[196:199], v1, s[8:11], s59 offen offset:1024 sc1
    s_waitcnt lgkmcnt(6)
    s_waitcnt vmcnt(8)
    v_mfma_f32_32x32x16_bf16 v[48:63], v[24:27], v[164:167], v[48:63]
    ds_read_b64_tr_b16 v[44:45], v7 offset:59392
    ds_read_b64_tr_b16 v[46:47], v7 offset:60416
    v_mfma_f32_32x32x16_bf16 v[64:79], v[28:31], v[164:167], v[64:79]
    s_barrier
    ds_read_b64_tr_b16 v[24:25], v5 offset:57344
    ds_read_b64_tr_b16 v[26:27], v5 offset:58368
    s_mul_i32 s59, s77, 14
    s_add_u32 s59, s59, s37
    buffer_load_dwordx4 v[200:203], v1, s[8:11], s59 offen offset:0 sc1
    s_waitcnt lgkmcnt(6)
    s_waitcnt vmcnt(8)
    v_mfma_f32_32x32x16_bf16 v[48:63], v[32:35], v[168:171], v[48:63]
    ds_read_b64_tr_b16 v[28:29], v8 offset:57344
    ds_read_b64_tr_b16 v[30:31], v8 offset:58368
    v_mfma_f32_32x32x16_bf16 v[64:79], v[36:39], v[168:171], v[64:79]
    ds_read_b64_tr_b16 v[32:33], v5 offset:59392
    ds_read_b64_tr_b16 v[34:35], v5 offset:60416
    buffer_load_dwordx4 v[204:207], v1, s[8:11], s59 offen offset:1024 sc1
    s_waitcnt lgkmcnt(6)
    s_waitcnt vmcnt(8)
    v_mfma_f32_32x32x16_bf16 v[48:63], v[40:43], v[172:175], v[48:63]
    ds_read_b64_tr_b16 v[36:37], v8 offset:59392
    ds_read_b64_tr_b16 v[38:39], v8 offset:60416
    v_mfma_f32_32x32x16_bf16 v[64:79], v[44:47], v[172:175], v[64:79]
    ds_read_b64_tr_b16 v[40:41], v6 offset:0
    ds_read_b64_tr_b16 v[42:43], v6 offset:1024
    s_add_u32 s59, s59, 0x1000
    buffer_load_dwordx4 v[208:211], v1, s[8:11], s59 offen offset:2048 sc1
    s_waitcnt lgkmcnt(6)
    s_waitcnt vmcnt(8)
    v_mfma_f32_32x32x16_bf16 v[48:63], v[24:27], v[176:179], v[48:63]
    ds_read_b64_tr_b16 v[44:45], v9 offset:0
    ds_read_b64_tr_b16 v[46:47], v9 offset:1024
    v_mfma_f32_32x32x16_bf16 v[64:79], v[28:31], v[176:179], v[64:79]
    ds_read_b64_tr_b16 v[24:25], v6 offset:2048
    ds_read_b64_tr_b16 v[26:27], v6 offset:3072
    buffer_load_dwordx4 v[212:215], v1, s[8:11], s59 offen offset:3072 sc1
    s_waitcnt lgkmcnt(6)
    s_waitcnt vmcnt(8)
    v_mfma_f32_32x32x16_bf16 v[48:63], v[32:35], v[180:183], v[48:63]
    ds_read_b64_tr_b16 v[28:29], v9 offset:2048
    ds_read_b64_tr_b16 v[30:31], v9 offset:3072
    v_mfma_f32_32x32x16_bf16 v[64:79], v[36:39], v[180:183], v[64:79]
    s_barrier
    ds_read_b64_tr_b16 v[32:33], v5 offset:0
    ds_read_b64_tr_b16 v[34:35], v5 offset:1024
    s_add_u32 s59, s59, 0x1000
    buffer_load_dwordx4 v[216:219], v1, s[8:11], s59 offen offset:0 sc1
    s_waitcnt lgkmcnt(6)
    s_waitcnt vmcnt(8)
    v_mfma_f32_32x32x16_bf16 v[48:63], v[40:43], v[184:187], v[48:63]
    ds_read_b64_tr_b16 v[36:37], v8 offset:0
    ds_read_b64_tr_b16 v[38:39], v8 offset:1024
    v_mfma_f32_32x32x16_bf16 v[64:79], v[44:47], v[184:187], v[64:79]
    ds_read_b64_tr_b16 v[40:41], v5 offset:2048
    ds_read_b64_tr_b16 v[42:43], v5 offset:3072
    buffer_load_dwordx4 v[220:223], v1, s[8:11], s59 offen offset:1024 sc1
    s_waitcnt lgkmcnt(6)
    s_waitcnt vmcnt(8)
    v_mfma_f32_32x32x16_bf16 v[48:63], v[24:27], v[188:191], v[48:63]
    ds_read_b64_tr_b16 v[44:45], v8 offset:2048
    ds_read_b64_tr_b16 v[46:47], v8 offset:3072
    v_mfma_f32_32x32x16_bf16 v[64:79], v[28:31], v[188:191], v[64:79]
    ds_read_b64_tr_b16 v[24:25], v6 offset:8192
    ds_read_b64_tr_b16 v[26:27], v6 offset:9216
    s_mul_i32 s59, s74, 14
    s_add_u32 s59, s59, s37
    buffer_load_dwordx4 v[224:227], v1, s[8:11], s59 offen offset:2048 sc1
    s_waitcnt lgkmcnt(6)
    s_waitcnt vmcnt(8)
    v_mfma_f32_32x32x16_bf16 v[48:63], v[32:35], v[192:195], v[48:63]
    ds_read_b64_tr_b16 v[28:29], v9 offset:8192
    ds_read_b64_tr_b16 v[30:31], v9 offset:9216
    v_mfma_f32_32x32x16_bf16 v[64:79], v[36:39], v[192:195], v[64:79]
    ds_read_b64_tr_b16 v[32:33], v6 offset:10240
    ds_read_b64_tr_b16 v[34:35], v6 offset:11264
    buffer_load_dwordx4 v[228:231], v1, s[8:11], s59 offen offset:3072 sc1
    s_waitcnt lgkmcnt(6)
    s_waitcnt vmcnt(8)
    v_mfma_f32_32x32x16_bf16 v[48:63], v[40:43], v[196:199], v[48:63]
    ds_read_b64_tr_b16 v[36:37], v9 offset:10240
    ds_read_b64_tr_b16 v[38:39], v9 offset:11264
    v_mfma_f32_32x32x16_bf16 v[64:79], v[44:47], v[196:199], v[64:79]
    s_barrier
    ds_read_b64_tr_b16 v[40:41], v6 offset:16384
    ds_read_b64_tr_b16 v[42:43], v6 offset:17408
    s_add_u32 s59, s59, 0x2000
    buffer_load_dwordx4 v[232:235], v1, s[8:11], s59 offen offset:2048 sc1
    s_waitcnt lgkmcnt(6)
    s_waitcnt vmcnt(8)
    v_mfma_f32_32x32x16_bf16 v[48:63], v[24:27], v[200:203], v[48:63]
    ds_read_b64_tr_b16 v[44:45], v9 offset:16384
    ds_read_b64_tr_b16 v[46:47], v9 offset:17408
    v_mfma_f32_32x32x16_bf16 v[64:79], v[28:31], v[200:203], v[64:79]
    ds_read_b64_tr_b16 v[24:25], v6 offset:18432
    ds_read_b64_tr_b16 v[26:27], v6 offset:19456
    buffer_load_dwordx4 v[236:239], v1, s[8:11], s59 offen offset:3072 sc1
    s_waitcnt lgkmcnt(6)
    s_waitcnt vmcnt(8)
    v_mfma_f32_32x32x16_bf16 v[48:63], v[32:35], v[204:207], v[48:63]
    ds_read_b64_tr_b16 v[28:29], v9 offset:18432
    ds_read_b64_tr_b16 v[30:31], v9 offset:19456
    v_mfma_f32_32x32x16_bf16 v[64:79], v[36:39], v[204:207], v[64:79]
    ds_read_b64_tr_b16 v[32:33], v5 offset:8192
    ds_read_b64_tr_b16 v[34:35], v5 offset:9216
    s_mul_i32 s59, s75, 14
    s_add_u32 s59, s59, s37
    buffer_load_dwordx4 v[240:243], v1, s[8:11], s59 offen offset:2048 sc1
    s_waitcnt lgkmcnt(6)
    s_waitcnt vmcnt(8)
    v_mfma_f32_32x32x16_bf16 v[48:63], v[40:43], v[208:211], v[48:63]
    ds_read_b64_tr_b16 v[36:37], v8 offset:8192
    ds_read_b64_tr_b16 v[38:39], v8 offset:9216
    v_mfma_f32_32x32x16_bf16 v[64:79], v[44:47], v[208:211], v[64:79]
    ds_read_b64_tr_b16 v[40:41], v5 offset:10240
    ds_read_b64_tr_b16 v[42:43], v5 offset:11264
    buffer_load_dwordx4 v[244:247], v1, s[8:11], s59 offen offset:3072 sc1
    s_waitcnt lgkmcnt(6)
    s_waitcnt vmcnt(8)
    v_mfma_f32_32x32x16_bf16 v[48:63], v[24:27], v[212:215], v[48:63]
    ds_read_b64_tr_b16 v[44:45], v8 offset:10240
    ds_read_b64_tr_b16 v[46:47], v8 offset:11264
    v_mfma_f32_32x32x16_bf16 v[64:79], v[28:31], v[212:215], v[64:79]
    s_barrier
    ds_read_b64_tr_b16 v[24:25], v5 offset:16384
    ds_read_b64_tr_b16 v[26:27], v5 offset:17408
    s_add_u32 s59, s59, 0x2000
    buffer_load_dwordx4 v[248:251], v1, s[8:11], s59 offen offset:2048 sc1
    s_waitcnt lgkmcnt(6)
    s_waitcnt vmcnt(8)
    v_mfma_f32_32x32x16_bf16 v[48:63], v[32:35], v[216:219], v[48:63]
    ds_read_b64_tr_b16 v[28:29], v8 offset:16384
    ds_read_b64_tr_b16 v[30:31], v8 offset:17408
    v_mfma_f32_32x32x16_bf16 v[64:79], v[36:39], v[216:219], v[64:79]
    ds_read_b64_tr_b16 v[32:33], v5 offset:18432
    ds_read_b64_tr_b16 v[34:35], v5 offset:19456
    buffer_load_dwordx4 v[252:255], v1, s[8:11], s59 offen offset:3072 sc1
    s_waitcnt lgkmcnt(6)
    s_waitcnt vmcnt(8)
    v_mfma_f32_32x32x16_bf16 v[48:63], v[40:43], v[220:223], v[48:63]
    ds_read_b64_tr_b16 v[36:37], v8 offset:18432
    ds_read_b64_tr_b16 v[38:39], v8 offset:19456
    v_mfma_f32_32x32x16_bf16 v[64:79], v[44:47], v[220:223], v[64:79]
    ds_read_b64_tr_b16 v[40:41], v5 offset:24576
    ds_read_b64_tr_b16 v[42:43], v5 offset:25600
    s_mul_i32 s59, s76, 14
    s_add_u32 s59, s59, s37
    buffer_load_dwordx4 v[128:131], v1, s[8:11], s59 offen offset:2048 sc1
    s_waitcnt lgkmcnt(6)
    s_waitcnt vmcnt(8)
    v_mfma_f32_32x32x16_bf16 v[48:63], v[24:27], v[224:227], v[48:63]
    ds_read_b64_tr_b16 v[44:45], v8 offset:24576
    ds_read_b64_tr_b16 v[46:47], v8 offset:25600
    v_mfma_f32_32x32x16_bf16 v[64:79], v[28:31], v[224:227], v[64:79]
    ds_read_b64_tr_b16 v[24:25], v5 offset:26624
    ds_read_b64_tr_b16 v[26:27], v5 offset:27648
    buffer_load_dwordx4 v[132:135], v1, s[8:11], s59 offen offset:3072 sc1
    s_waitcnt lgkmcnt(6)
    s_waitcnt vmcnt(8)
    v_mfma_f32_32x32x16_bf16 v[48:63], v[32:35], v[228:231], v[48:63]
    ds_read_b64_tr_b16 v[28:29], v8 offset:26624
    ds_read_b64_tr_b16 v[30:31], v8 offset:27648
    v_mfma_f32_32x32x16_bf16 v[64:79], v[36:39], v[228:231], v[64:79]
    s_barrier
    ds_read_b64_tr_b16 v[32:33], v5 offset:32768
    ds_read_b64_tr_b16 v[34:35], v5 offset:33792
    s_add_u32 s59, s59, 0x2000
    buffer_load_dwordx4 v[136:139], v1, s[8:11], s59 offen offset:2048 sc1
    s_waitcnt lgkmcnt(6)
    s_waitcnt vmcnt(8)
    v_mfma_f32_32x32x16_bf16 v[48:63], v[40:43], v[232:235], v[48:63]
    ds_read_b64_tr_b16 v[36:37], v8 offset:32768
    ds_read_b64_tr_b16 v[38:39], v8 offset:33792
    v_mfma_f32_32x32x16_bf16 v[64:79], v[44:47], v[232:235], v[64:79]
    ds_read_b64_tr_b16 v[40:41], v5 offset:34816
    ds_read_b64_tr_b16 v[42:43], v5 offset:35840
    buffer_load_dwordx4 v[140:143], v1, s[8:11], s59 offen offset:3072 sc1
    s_waitcnt lgkmcnt(6)
    s_waitcnt vmcnt(8)
    v_mfma_f32_32x32x16_bf16 v[48:63], v[24:27], v[236:239], v[48:63]
    ds_read_b64_tr_b16 v[44:45], v8 offset:34816
    ds_read_b64_tr_b16 v[46:47], v8 offset:35840
    v_mfma_f32_32x32x16_bf16 v[64:79], v[28:31], v[236:239], v[64:79]
    ds_read_b64_tr_b16 v[24:25], v4 offset:0
    ds_read_b64_tr_b16 v[26:27], v4 offset:1024
    s_mul_i32 s59, s77, 14
    s_add_u32 s59, s59, s37
    buffer_load_dwordx4 v[144:147], v1, s[8:11], s59 offen offset:2048 sc1
    s_waitcnt lgkmcnt(6)
    s_waitcnt vmcnt(8)
    v_mfma_f32_32x32x16_bf16 v[48:63], v[32:35], v[240:243], v[48:63]
    ds_read_b64_tr_b16 v[28:29], v7 offset:0
    ds_read_b64_tr_b16 v[30:31], v7 offset:1024
    v_mfma_f32_32x32x16_bf16 v[64:79], v[36:39], v[240:243], v[64:79]
    ds_read_b64_tr_b16 v[32:33], v4 offset:2048
    ds_read_b64_tr_b16 v[34:35], v4 offset:3072
    buffer_load_dwordx4 v[148:151], v1, s[8:11], s59 offen offset:3072 sc1
    s_waitcnt lgkmcnt(6)
    s_waitcnt vmcnt(8)
    v_mfma_f32_32x32x16_bf16 v[48:63], v[40:43], v[244:247], v[48:63]
    ds_read_b64_tr_b16 v[36:37], v7 offset:2048
    ds_read_b64_tr_b16 v[38:39], v7 offset:3072
    v_mfma_f32_32x32x16_bf16 v[64:79], v[44:47], v[244:247], v[64:79]
    s_barrier
    ds_read_b64_tr_b16 v[40:41], v4 offset:8192
    ds_read_b64_tr_b16 v[42:43], v4 offset:9216
    s_add_u32 s59, s59, 0x2000
    buffer_load_dwordx4 v[152:155], v1, s[8:11], s59 offen offset:2048 sc1
    s_waitcnt lgkmcnt(6)
    s_waitcnt vmcnt(8)
    v_mfma_f32_32x32x16_bf16 v[48:63], v[24:27], v[248:251], v[48:63]
    ds_read_b64_tr_b16 v[44:45], v7 offset:8192
    ds_read_b64_tr_b16 v[46:47], v7 offset:9216
    v_mfma_f32_32x32x16_bf16 v[64:79], v[28:31], v[248:251], v[64:79]
    ds_read_b64_tr_b16 v[24:25], v4 offset:10240
    ds_read_b64_tr_b16 v[26:27], v4 offset:11264
    buffer_load_dwordx4 v[156:159], v1, s[8:11], s59 offen offset:3072 sc1
    s_waitcnt lgkmcnt(6)
    s_waitcnt vmcnt(8)
    v_mfma_f32_32x32x16_bf16 v[48:63], v[32:35], v[252:255], v[48:63]
    ds_read_b64_tr_b16 v[28:29], v7 offset:10240
    ds_read_b64_tr_b16 v[30:31], v7 offset:11264
    v_mfma_f32_32x32x16_bf16 v[64:79], v[36:39], v[252:255], v[64:79]
    ds_read_b64_tr_b16 v[32:33], v4 offset:16384
    ds_read_b64_tr_b16 v[34:35], v4 offset:17408
    s_mul_i32 s59, s74, 14
    s_add_u32 s59, s59, s37
    s_add_u32 s59, s59, 4096
    buffer_load_dwordx4 v[160:163], v1, s[8:11], s59 offen offset:0 sc1
    s_waitcnt lgkmcnt(6)
    s_waitcnt vmcnt(8)
    v_mfma_f32_32x32x16_bf16 v[48:63], v[40:43], v[128:131], v[48:63]
    ds_read_b64_tr_b16 v[36:37], v7 offset:16384
    ds_read_b64_tr_b16 v[38:39], v7 offset:17408
    v_mfma_f32_32x32x16_bf16 v[64:79], v[44:47], v[128:131], v[64:79]
    ds_read_b64_tr_b16 v[40:41], v4 offset:18432
    ds_read_b64_tr_b16 v[42:43], v4 offset:19456
    buffer_load_dwordx4 v[164:167], v1, s[8:11], s59 offen offset:1024 sc1
    s_waitcnt lgkmcnt(6)
    s_waitcnt vmcnt(8)
    v_mfma_f32_32x32x16_bf16 v[48:63], v[24:27], v[132:135], v[48:63]
    ds_read_b64_tr_b16 v[44:45], v7 offset:18432
    ds_read_b64_tr_b16 v[46:47], v7 offset:19456
    v_mfma_f32_32x32x16_bf16 v[64:79], v[28:31], v[132:135], v[64:79]
    s_barrier
    ds_read_b64_tr_b16 v[24:25], v4 offset:24576
    ds_read_b64_tr_b16 v[26:27], v4 offset:25600
    s_add_u32 s59, s59, 0x2000
    buffer_load_dwordx4 v[168:171], v1, s[8:11], s59 offen offset:0 sc1
    s_waitcnt lgkmcnt(6)
    s_waitcnt vmcnt(8)
    v_mfma_f32_32x32x16_bf16 v[48:63], v[32:35], v[136:139], v[48:63]
    ds_read_b64_tr_b16 v[28:29], v7 offset:24576
    ds_read_b64_tr_b16 v[30:31], v7 offset:25600
    v_mfma_f32_32x32x16_bf16 v[64:79], v[36:39], v[136:139], v[64:79]
    ds_read_b64_tr_b16 v[32:33], v4 offset:26624
    ds_read_b64_tr_b16 v[34:35], v4 offset:27648
    buffer_load_dwordx4 v[172:175], v1, s[8:11], s59 offen offset:1024 sc1
    s_waitcnt lgkmcnt(6)
    s_waitcnt vmcnt(8)
    v_mfma_f32_32x32x16_bf16 v[48:63], v[40:43], v[140:143], v[48:63]
    ds_read_b64_tr_b16 v[36:37], v7 offset:26624
    ds_read_b64_tr_b16 v[38:39], v7 offset:27648
    v_mfma_f32_32x32x16_bf16 v[64:79], v[44:47], v[140:143], v[64:79]
    ds_read_b64_tr_b16 v[40:41], v5 offset:40960
    ds_read_b64_tr_b16 v[42:43], v5 offset:41984
    s_mul_i32 s59, s75, 14
    s_add_u32 s59, s59, s37
    s_add_u32 s59, s59, 4096
    buffer_load_dwordx4 v[176:179], v1, s[8:11], s59 offen offset:0 sc1
    s_waitcnt lgkmcnt(6)
    s_waitcnt vmcnt(8)
    v_mfma_f32_32x32x16_bf16 v[48:63], v[24:27], v[144:147], v[48:63]
    ds_read_b64_tr_b16 v[44:45], v8 offset:40960
    ds_read_b64_tr_b16 v[46:47], v8 offset:41984
    v_mfma_f32_32x32x16_bf16 v[64:79], v[28:31], v[144:147], v[64:79]
    ds_read_b64_tr_b16 v[24:25], v5 offset:43008
    ds_read_b64_tr_b16 v[26:27], v5 offset:44032
    buffer_load_dwordx4 v[180:183], v1, s[8:11], s59 offen offset:1024 sc1
    s_waitcnt lgkmcnt(6)
    s_waitcnt vmcnt(8)
    v_mfma_f32_32x32x16_bf16 v[48:63], v[32:35], v[148:151], v[48:63]
    ds_read_b64_tr_b16 v[28:29], v8 offset:43008
    ds_read_b64_tr_b16 v[30:31], v8 offset:44032
    v_mfma_f32_32x32x16_bf16 v[64:79], v[36:39], v[148:151], v[64:79]
    s_barrier
    ds_read_b64_tr_b16 v[32:33], v4 offset:32768
    ds_read_b64_tr_b16 v[34:35], v4 offset:33792
    s_add_u32 s59, s59, 0x2000
    buffer_load_dwordx4 v[184:187], v1, s[8:11], s59 offen offset:0 sc1
    s_waitcnt lgkmcnt(6)
    s_waitcnt vmcnt(8)
    v_mfma_f32_32x32x16_bf16 v[48:63], v[40:43], v[152:155], v[48:63]
    ds_read_b64_tr_b16 v[36:37], v7 offset:32768
    ds_read_b64_tr_b16 v[38:39], v7 offset:33792
    v_mfma_f32_32x32x16_bf16 v[64:79], v[44:47], v[152:155], v[64:79]
    ds_read_b64_tr_b16 v[40:41], v4 offset:34816
    ds_read_b64_tr_b16 v[42:43], v4 offset:35840
    buffer_load_dwordx4 v[188:191], v1, s[8:11], s59 offen offset:1024 sc1
    s_waitcnt lgkmcnt(6)
    s_waitcnt vmcnt(8)
    v_mfma_f32_32x32x16_bf16 v[48:63], v[24:27], v[156:159], v[48:63]
    ds_read_b64_tr_b16 v[44:45], v7 offset:34816
    ds_read_b64_tr_b16 v[46:47], v7 offset:35840
    v_mfma_f32_32x32x16_bf16 v[64:79], v[28:31], v[156:159], v[64:79]
    ds_read_b64_tr_b16 v[24:25], v4 offset:49152
    ds_read_b64_tr_b16 v[26:27], v4 offset:50176
    s_mul_i32 s59, s76, 14
    s_add_u32 s59, s59, s37
    s_add_u32 s59, s59, 4096
    buffer_load_dwordx4 v[192:195], v1, s[8:11], s59 offen offset:0 sc1
    s_waitcnt lgkmcnt(6)
    s_waitcnt vmcnt(8)
    v_mfma_f32_32x32x16_bf16 v[48:63], v[32:35], v[160:163], v[48:63]
    ds_read_b64_tr_b16 v[28:29], v7 offset:49152
    ds_read_b64_tr_b16 v[30:31], v7 offset:50176
    v_mfma_f32_32x32x16_bf16 v[64:79], v[36:39], v[160:163], v[64:79]
    ds_read_b64_tr_b16 v[32:33], v4 offset:51200
    ds_read_b64_tr_b16 v[34:35], v4 offset:52224
    buffer_load_dwordx4 v[196:199], v1, s[8:11], s59 offen offset:1024 sc1
    s_waitcnt lgkmcnt(6)
    s_waitcnt vmcnt(8)
    v_mfma_f32_32x32x16_bf16 v[48:63], v[40:43], v[164:167], v[48:63]
    ds_read_b64_tr_b16 v[36:37], v7 offset:51200
    ds_read_b64_tr_b16 v[38:39], v7 offset:52224
    v_mfma_f32_32x32x16_bf16 v[64:79], v[44:47], v[164:167], v[64:79]
    s_barrier
    ds_read_b64_tr_b16 v[40:41], v5 offset:49152
    ds_read_b64_tr_b16 v[42:43], v5 offset:50176
    s_add_u32 s59, s59, 0x2000
    buffer_load_dwordx4 v[200:203], v1, s[8:11], s59 offen offset:0 sc1
    s_waitcnt lgkmcnt(6)
    s_waitcnt vmcnt(8)
    v_mfma_f32_32x32x16_bf16 v[48:63], v[24:27], v[168:171], v[48:63]
    ds_read_b64_tr_b16 v[44:45], v8 offset:49152
    ds_read_b64_tr_b16 v[46:47], v8 offset:50176
    v_mfma_f32_32x32x16_bf16 v[64:79], v[28:31], v[168:171], v[64:79]
    ds_read_b64_tr_b16 v[24:25], v5 offset:51200
    ds_read_b64_tr_b16 v[26:27], v5 offset:52224
    buffer_load_dwordx4 v[204:207], v1, s[8:11], s59 offen offset:1024 sc1
    s_waitcnt lgkmcnt(6)
    s_waitcnt vmcnt(8)
    v_mfma_f32_32x32x16_bf16 v[48:63], v[32:35], v[172:175], v[48:63]
    ds_read_b64_tr_b16 v[28:29], v8 offset:51200
    ds_read_b64_tr_b16 v[30:31], v8 offset:52224
    v_mfma_f32_32x32x16_bf16 v[64:79], v[36:39], v[172:175], v[64:79]
    ds_read_b64_tr_b16 v[32:33], v6 offset:0
    ds_read_b64_tr_b16 v[34:35], v6 offset:1024
    s_mul_i32 s59, s77, 14
    s_add_u32 s59, s59, s37
    s_add_u32 s59, s59, 4096
    buffer_load_dwordx4 v[208:211], v1, s[8:11], s59 offen offset:0 sc1
    s_waitcnt lgkmcnt(6)
    s_waitcnt vmcnt(8)
    v_mfma_f32_32x32x16_bf16 v[48:63], v[40:43], v[176:179], v[48:63]
    ds_read_b64_tr_b16 v[36:37], v9 offset:0
    ds_read_b64_tr_b16 v[38:39], v9 offset:1024
    v_mfma_f32_32x32x16_bf16 v[64:79], v[44:47], v[176:179], v[64:79]
    ds_read_b64_tr_b16 v[40:41], v6 offset:2048
    ds_read_b64_tr_b16 v[42:43], v6 offset:3072
    buffer_load_dwordx4 v[212:215], v1, s[8:11], s59 offen offset:1024 sc1
    s_waitcnt lgkmcnt(6)
    s_waitcnt vmcnt(8)
    v_mfma_f32_32x32x16_bf16 v[48:63], v[24:27], v[180:183], v[48:63]
    ds_read_b64_tr_b16 v[44:45], v9 offset:2048
    ds_read_b64_tr_b16 v[46:47], v9 offset:3072
    v_mfma_f32_32x32x16_bf16 v[64:79], v[28:31], v[180:183], v[64:79]
    s_barrier
    ds_read_b64_tr_b16 v[24:25], v6 offset:8192
    ds_read_b64_tr_b16 v[26:27], v6 offset:9216
    s_add_u32 s59, s59, 0x2000
    buffer_load_dwordx4 v[216:219], v1, s[8:11], s59 offen offset:0 sc1
    s_waitcnt lgkmcnt(6)
    s_waitcnt vmcnt(8)
    v_mfma_f32_32x32x16_bf16 v[48:63], v[32:35], v[184:187], v[48:63]
    ds_read_b64_tr_b16 v[28:29], v9 offset:8192
    ds_read_b64_tr_b16 v[30:31], v9 offset:9216
    v_mfma_f32_32x32x16_bf16 v[64:79], v[36:39], v[184:187], v[64:79]
    ds_read_b64_tr_b16 v[32:33], v6 offset:10240
    ds_read_b64_tr_b16 v[34:35], v6 offset:11264
    buffer_load_dwordx4 v[220:223], v1, s[8:11], s59 offen offset:1024 sc1
    s_waitcnt lgkmcnt(6)
    s_waitcnt vmcnt(8)
    v_mfma_f32_32x32x16_bf16 v[48:63], v[40:43], v[188:191], v[48:63]
    ds_read_b64_tr_b16 v[36:37], v9 offset:10240
    ds_read_b64_tr_b16 v[38:39], v9 offset:11264
    v_mfma_f32_32x32x16_bf16 v[64:79], v[44:47], v[188:191], v[64:79]
    ds_read_b64_tr_b16 v[40:41], v6 offset:16384
    ds_read_b64_tr_b16 v[42:43], v6 offset:17408
    s_waitcnt lgkmcnt(6)
    s_waitcnt vmcnt(7)
    v_mfma_f32_32x32x16_bf16 v[48:63], v[24:27], v[192:195], v[48:63]
    ds_read_b64_tr_b16 v[44:45], v9 offset:16384
    ds_read_b64_tr_b16 v[46:47], v9 offset:17408
    v_mfma_f32_32x32x16_bf16 v[64:79], v[28:31], v[192:195], v[64:79]
    ds_read_b64_tr_b16 v[24:25], v6 offset:18432
    ds_read_b64_tr_b16 v[26:27], v6 offset:19456
    s_waitcnt lgkmcnt(6)
    s_waitcnt vmcnt(6)
    v_mfma_f32_32x32x16_bf16 v[48:63], v[32:35], v[196:199], v[48:63]
    ds_read_b64_tr_b16 v[28:29], v9 offset:18432
    ds_read_b64_tr_b16 v[30:31], v9 offset:19456
    v_mfma_f32_32x32x16_bf16 v[64:79], v[36:39], v[196:199], v[64:79]
    s_barrier
    ds_read_b64_tr_b16 v[32:33], v5 offset:57344
    ds_read_b64_tr_b16 v[34:35], v5 offset:58368
    s_waitcnt lgkmcnt(6)
    s_waitcnt vmcnt(5)
    v_mfma_f32_32x32x16_bf16 v[48:63], v[40:43], v[200:203], v[48:63]
    ds_read_b64_tr_b16 v[36:37], v8 offset:57344
    ds_read_b64_tr_b16 v[38:39], v8 offset:58368
    v_mfma_f32_32x32x16_bf16 v[64:79], v[44:47], v[200:203], v[64:79]
    ds_read_b64_tr_b16 v[40:41], v8 offset:59392
    ds_read_b64_tr_b16 v[42:43], v8 offset:60416
    s_waitcnt lgkmcnt(6)
    s_waitcnt vmcnt(4)
    v_mfma_f32_32x32x16_bf16 v[48:63], v[24:27], v[204:207], v[48:63]
    ds_read_b64_tr_b16 v[44:45], v8 offset:32768
    ds_read_b64_tr_b16 v[46:47], v8 offset:33792
    v_mfma_f32_32x32x16_bf16 v[64:79], v[28:31], v[204:207], v[64:79]
    ds_read_b64_tr_b16 v[24:25], v8 offset:34816
    ds_read_b64_tr_b16 v[26:27], v8 offset:35840
    s_waitcnt lgkmcnt(6)
    s_waitcnt vmcnt(3)
    v_mfma_f32_32x32x16_bf16 v[48:63], v[32:35], v[208:211], v[48:63]
    ds_read_b64_tr_b16 v[28:29], v5 offset:59392
    ds_read_b64_tr_b16 v[30:31], v5 offset:60416
    v_mfma_f32_32x32x16_bf16 v[64:79], v[36:39], v[208:211], v[64:79]
    ds_read_b64_tr_b16 v[32:33], v5 offset:32768
    ds_read_b64_tr_b16 v[34:35], v5 offset:33792
    s_waitcnt lgkmcnt(6)
    s_waitcnt vmcnt(2)
    v_mfma_f32_32x32x16_bf16 v[64:79], v[40:43], v[212:215], v[64:79]
    ds_read_b64_tr_b16 v[36:37], v5 offset:34816
    ds_read_b64_tr_b16 v[38:39], v5 offset:35840
    s_waitcnt vmcnt(1)
    v_mfma_f32_32x32x16_bf16 v[64:79], v[44:47], v[216:219], v[64:79]
    s_waitcnt lgkmcnt(4)
    s_waitcnt vmcnt(0)
    v_mfma_f32_32x32x16_bf16 v[64:79], v[24:27], v[220:223], v[64:79]
    v_mfma_f32_32x32x16_bf16 v[48:63], v[28:31], v[212:215], v[48:63]
    s_waitcnt lgkmcnt(0)
    v_mfma_f32_32x32x16_bf16 v[48:63], v[32:35], v[216:219], v[48:63]
    v_mfma_f32_32x32x16_bf16 v[48:63], v[36:39], v[220:223], v[48:63]
    s_nop 7
    ds_write_b128 v120, v[64:67] offset:0
    ds_write_b128 v120, v[68:71] offset:1024
    ds_write_b128 v120, v[72:75] offset:2048
    ds_write_b128 v120, v[76:79] offset:3072
    s_waitcnt lgkmcnt(0)
    s_barrier
    ds_read_b128 v[24:27], v121 offset:0
    ds_read_b128 v[28:31], v121 offset:1024
    ds_read_b128 v[32:35], v121 offset:2048
    ds_read_b128 v[36:39], v121 offset:3072
    s_waitcnt lgkmcnt(3)
    v_pk_add_f32 v[48:49], v[48:49], v[24:25]
    v_pk_add_f32 v[50:51], v[50:51], v[26:27]
    s_waitcnt lgkmcnt(2)
    v_pk_add_f32 v[52:53], v[52:53], v[28:29]
    v_pk_add_f32 v[54:55], v[54:55], v[30:31]
    v_cvt_pk_bf16_f32 v112, v48, v49
    v_cvt_pk_bf16_f32 v113, v50, v51
    v_cvt_pk_bf16_f32 v114, v52, v53
    v_cvt_pk_bf16_f32 v115, v54, v55
    s_waitcnt lgkmcnt(1)
    v_pk_add_f32 v[56:57], v[56:57], v[32:33]
    v_pk_add_f32 v[58:59], v[58:59], v[34:35]
    s_waitcnt lgkmcnt(0)
    v_pk_add_f32 v[60:61], v[60:61], v[36:37]
    v_pk_add_f32 v[62:63], v[62:63], v[38:39]
    v_cvt_pk_bf16_f32 v116, v56, v57
    v_cvt_pk_bf16_f32 v117, v58, v59
    v_cvt_pk_bf16_f32 v118, v60, v61
    v_cvt_pk_bf16_f32 v119, v62, v63
    s_cmp_lg_u32 s22, 0
    s_cbranch_scc1 c_final
    buffer_store_dwordx4 v[112:115], v1, s[8:11], s38 offen offset:0 sc1
    buffer_store_dwordx4 v[116:119], v1, s[8:11], s38 offen offset:1024 sc1
    v_pk_add_f32 v[24:25], v[48:49], v[50:51]
    v_pk_mul_f32 v[26:27], v[48:49], v[48:49]
    v_pk_fma_f32 v[26:27], v[50:51], v[50:51], v[26:27]
    v_pk_add_f32 v[24:25], v[24:25], v[52:53]
    v_pk_fma_f32 v[26:27], v[52:53], v[52:53], v[26:27]
    v_pk_add_f32 v[24:25], v[24:25], v[54:55]
    v_pk_fma_f32 v[26:27], v[54:55], v[54:55], v[26:27]
    v_pk_add_f32 v[24:25], v[24:25], v[56:57]
    v_pk_fma_f32 v[26:27], v[56:57], v[56:57], v[26:27]
    v_pk_add_f32 v[24:25], v[24:25], v[58:59]
    v_pk_fma_f32 v[26:27], v[58:59], v[58:59], v[26:27]
    v_pk_add_f32 v[24:25], v[24:25], v[60:61]
    v_pk_fma_f32 v[26:27], v[60:61], v[60:61], v[26:27]
    v_pk_add_f32 v[24:25], v[24:25], v[62:63]
    v_pk_fma_f32 v[26:27], v[62:63], v[62:63], v[26:27]
    v_add_f32 v16, v24, v25
    v_add_f32 v17, v26, v27
    s_nop 1
    v_permlane32_swap_b32 v16, v17
    v_add_f32 v16, v16, v17
    buffer_atomic_add_f32 v16, v122, s[8:11], s39 offen sc1
    s_waitcnt vmcnt(0) lgkmcnt(0)
    s_barrier
    s_add_u32 s24, s24, 0x1800000
    s_add_u32 s25, s25, 0x1800000
    s_add_u32 s26, s26, 0x1800000
    s_add_u32 s27, s27, 0x1800000
    s_add_u32 s28, s28, 0x1800000
    s_add_u32 s29, s29, 0x1800000
    s_add_u32 s30, s30, 0x1800000
    s_add_u32 s31, s31, 0x1800000
    s_add_u32 s32, s32, 0x1800000
    s_add_u32 s33, s33, 0x1800000
    s_add_u32 s34, s34, 0x1800000
    s_add_u32 s35, s35, 0x1800000
    s_add_u32 s36, s36, 0x1800000
    s_add_u32 s37, s37, 0x1800000
    s_add_u32 s38, s38, 0x1800000
    s_add_u32 s39, s39, 0x1800000
    s_add_u32 s40, s40, 0x1800000
    s_add_u32 s80, s80, 0x1800000
    s_add_u32 s81, s81, 0x1800000
    s_mov_b32 s22, 1
    s_branch c_loop
c_final:
    s_nop 1
    v_and_b32 v12, 31, v0
    v_lshlrev_b32 v12, 10, v12
    v_lshrrev_b32 v13, 5, v0
    v_lshl_add_u32 v12, v13, 4, v12
    v_permlane32_swap_b32 v112, v114
    v_permlane32_swap_b32 v113, v115
    buffer_store_dwordx4 v[112:115], v12, s[12:15], s42 offen offset:0
    v_permlane32_swap_b32 v116, v118
    v_permlane32_swap_b32 v117, v119
    buffer_store_dwordx4 v[116:119], v12, s[12:15], s42 offen offset:32
    s_endpgm
h0_start:
    v_lshlrev_b32 v24, 7, v0
    s_lshl_b32 s56, s2, 11
    s_mov_b64 exec, 0xffff
    buffer_load_dword v191, v24, s[88:91], s56 offen
    s_mov_b64 exec, -1
    s_lshl_b32 s27, s18, 11
    s_add_u32 s27, s27, 0x1500000
    s_lshl_b32 s56, s19, 7
    s_add_u32 s26, s27, s56
    s_lshl2_add_u32 s27, s19, s27
    s_lshl_b32 s29, s20, 11
    s_add_u32 s29, s29, 0x1500000
    s_lshl_b32 s56, s21, 7
    s_add_u32 s28, s29, s56
    s_lshl2_add_u32 s29, s21, s29
    s_lshl_b32 s25, s16, 11
    s_add_u32 s25, s25, 0x1500000
    s_lshl2_add_u32 s25, s17, s25
    v_lshlrev_b32 v11, 7, v0
    v_mul_u32_u24 v7, 2052, v0
    v_subrev_u32 v7, 4, v7
    s_cmp_lt_u32 s16, 14
    s_cselect_b32 s54, 6, 2
    s_mov_b32 s55, 0
    v_lshlrev_b32 v5, 11, v0
    s_lshl_b32 s30, s17, 7
    s_lshl2_add_u32 s30, s16, s30
    s_add_u32 s30, s30, 0x1500000
    s_lshl_b32 s31, s21, 7
    s_lshl2_add_u32 s31, s20, s31
    s_add_u32 s31, s31, 0x1500000
    s_barrier
    s_barrier
    s_waitcnt lgkmcnt(0)
    s_add_u32 s86, s86, 0x9e3779b9
    s_mov_b32 s87, s86
    v_mov_b32 v10, s86
    s_lshl_b32 s56, s23, 10
    s_add_u32 s56, s56, 159616
    v_add_u32 v8, s56, v1
    s_add_u32 s58, s80, 0x0
    s_mov_b32 s59, 100000
poll13:
    s_sub_u32 s59, s59, 1
    s_cbranch_scc1 poll13_done
    s_buffer_load_dwordx16 s[64:79], s[8:11], s58 glc
    s_waitcnt lgkmcnt(0)
    s_cmp_lg_u64 s[64:65], s[86:87]
    s_cbranch_scc1 poll13
    s_cmp_lg_u64 s[66:67], s[86:87]
    s_cbranch_scc1 poll13
    s_cmp_lg_u64 s[68:69], s[86:87]
    s_cbranch_scc1 poll13
    s_cmp_lg_u64 s[70:71], s[86:87]
    s_cbranch_scc1 poll13
    s_cmp_lg_u64 s[72:73], s[86:87]
    s_cbranch_scc1 poll13
    s_cmp_lg_u64 s[74:75], s[86:87]
    s_cbranch_scc1 poll13
    s_cmp_lg_u64 s[76:77], s[86:87]
    s_cbranch_scc1 poll13
    s_cmp_lg_u64 s[78:79], s[86:87]
    s_cbranch_scc1 poll13
poll13_done:
    s_barrier
    v_and_b32 v13, 31, v0
    v_lshrrev_b32 v56, 5, v0
    v_lshlrev_b32 v56, 2, v56
    v_sub_u32 v13, v13, v56
    v_mov_b32 v56, 0xff800000
    s_cmp_ge_u32 s4, 8
    s_cselect_b32 s60, 0, 0xff800000
    v_mov_b32 v57, s60
    v_cmp_le_i32 vcc, 0, v13
    v_cmp_le_i32 s[62:63], 1, v13
    s_nop 0
    v_cndmask_b32 v64, v56, 0, vcc
    v_cndmask_b32 v96, v57, v56, vcc
    v_cndmask_b32 v65, v56, 0, s[62:63]
    v_cndmask_b32 v97, v57, v56, s[62:63]
    v_cmp_le_i32 vcc, 2, v13
    v_cmp_le_i32 s[62:63], 3, v13
    s_nop 0
    v_cndmask_b32 v66, v56, 0, vcc
    v_cndmask_b32 v98, v57, v56, vcc
    v_cndmask_b32 v67, v56, 0, s[62:63]
    v_cndmask_b32 v99, v57, v56, s[62:63]
    v_cmp_le_i32 vcc, 8, v13
    v_cmp_le_i32 s[62:63], 9, v13
    s_nop 0
    v_cndmask_b32 v68, v56, 0, vcc
    v_cndmask_b32 v100, v57, v56, vcc
    v_cndmask_b32 v69, v56, 0, s[62:63]
    v_cndmask_b32 v101, v57, v56, s[62:63]
    v_cmp_le_i32 vcc, 10, v13
    v_cmp_le_i32 s[62:63], 11, v13
    s_nop 0
    v_cndmask_b32 v70, v56, 0, vcc
    v_cndmask_b32 v102, v57, v56, vcc
    v_cndmask_b32 v71, v56, 0, s[62:63]
    v_cndmask_b32 v103, v57, v56, s[62:63]
    v_cmp_le_i32 vcc, 16, v13
    v_cmp_le_i32 s[62:63], 17, v13
    s_nop 0
    v_cndmask_b32 v72, v56, 0, vcc
    v_cndmask_b32 v104, v57, v56, vcc
    v_cndmask_b32 v73, v56, 0, s[62:63]
    v_cndmask_b32 v105, v57, v56, s[62:63]
    v_cmp_le_i32 vcc, 18, v13
    v_cmp_le_i32 s[62:63], 19, v13
    s_nop 0
    v_cndmask_b32 v74, v56, 0, vcc
    v_cndmask_b32 v106, v57, v56, vcc
    v_cndmask_b32 v75, v56, 0, s[62:63]
    v_cndmask_b32 v107, v57, v56, s[62:63]
    v_cmp_le_i32 vcc, 24, v13
    v_cmp_le_i32 s[62:63], 25, v13
    s_nop 0
    v_cndmask_b32 v76, v56, 0, vcc
    v_cndmask_b32 v108, v57, v56, vcc
    v_cndmask_b32 v77, v56, 0, s[62:63]
    v_cndmask_b32 v109, v57, v56, s[62:63]
    v_cmp_le_i32 vcc, 26, v13
    v_cmp_le_i32 s[62:63], 27, v13
    s_nop 0
    v_cndmask_b32 v78, v56, 0, vcc
    v_cndmask_b32 v110, v57, v56, vcc
    v_cndmask_b32 v79, v56, 0, s[62:63]
    v_cndmask_b32 v111, v57, v56, s[62:63]
    s_lshr_b32 s61, s3, 2
    s_mul_i32 s61, s61, 12
    s_add_u32 s61, s61, s5
    s_lshl_b32 s60, s61, 10
    s_add_u32 s60, s60, 106496
    v_add_u32 v20, s60, v1
    v_lshrrev_b32 v21, 5, v0
    v_lshlrev_b32 v21, 8, v21
    v_and_b32 v12, 15, v0
    v_lshl_add_u32 v21, v12, 4, v21
    v_add_u32 v22, 0x200, v21
    v_and_b32 v12, 16, v0
    v_cmp_ne_u32 vcc, 0, v12
    v_mov_b32 v12, 0x400
    s_nop 0
    v_cndmask_b32 v21, v21, v12, vcc
    v_cndmask_b32 v22, v22, v12, vcc
    s_mul_i32 s60, s61, 1040
    s_add_u32 s60, s60, 131072
    v_add_u32 v21, s60, v21
    v_add_u32 v22, s60, v22
    s_lshl_b32 s60, s16, 12
    s_sub_u32 s60, s60, 8192
    v_add_u32 v12, s60, v1
    v_min_u32 v14, 0x80000000, v12
    v_add_u32 v12, 0x1000, v12
    v_min_u32 v15, 0x80000000, v12
    s_barrier
    s_barrier
    s_barrier
    s_add_u32 s56, s30, 0x40000
    s_mov_b64 exec, 0xffff
    buffer_atomic_swap v10, v5, s[8:11], s56 offen sc1
    s_mov_b64 exec, -1
    s_lshl_b32 s56, s23, 11
    v_add_u32 v24, s56, v1
    v_add_u32 v25, 0x10000, v24
    ds_read_b128 v[192:195], v24 offset:32768
    ds_read_b128 v[196:199], v24 offset:33792
    ds_read_b128 v[200:203], v24 offset:40960
    ds_read_b128 v[204:207], v24 offset:41984
    ds_read_b128 v[208:211], v24 offset:49152
    ds_read_b128 v[212:215], v24 offset:50176
    ds_read_b128 v[216:219], v24 offset:57344
    ds_read_b128 v[220:223], v24 offset:58368
    ds_read_b128 v[224:227], v25 offset:0
    ds_read_b128 v[228:231], v25 offset:1024
    ds_read_b128 v[232:235], v25 offset:8192
    ds_read_b128 v[236:239], v25 offset:9216
    ds_read_b128 v[240:243], v25 offset:16384
    ds_read_b128 v[244:247], v25 offset:17408
    ds_read_b128 v[248:251], v25 offset:24576
    ds_read_b128 v[252:255], v25 offset:25600
    s_waitcnt lgkmcnt(0)
    s_waitcnt vmcnt(0)
    s_barrier
    s_barrier
    s_barrier
    s_cmp_ge_u32 s16, 15
    s_cbranch_scc1 h0_qk_14
    s_add_u32 s56, s80, 0x8000
    s_mov_b64 exec, s[54:55]
    buffer_atomic_swap v10, v7, s[8:11], s56 offen sc1
    s_mov_b64 exec, -1
h0_qk_14:
    s_add_u32 s56, s31, 0x48000
    s_mov_b64 exec, 0xffff
    buffer_atomic_swap v10, v5, s[8:11], s56 offen sc1
    s_mov_b64 exec, -1
    s_barrier
    ds_read_b128 v[16:19], v8
    s_branch attn
h0_post:
    s_add_u32 s56, s25, 0x38000
    s_mov_b64 exec, 0xffff
    buffer_atomic_swap v10, v11, s[8:11], s56 offen sc1
    s_mov_b64 exec, -1
    s_add_u32 s58, s26, 0x38000
    s_mov_b32 s59, 100000
poll4:
    s_sub_u32 s59, s59, 1
    s_cbranch_scc1 poll4_done
    s_buffer_load_dwordx16 s[64:79], s[8:11], s58 glc
    s_waitcnt lgkmcnt(0)
    s_cmp_lg_u64 s[64:65], s[86:87]
    s_cbranch_scc1 poll4
    s_cmp_lg_u64 s[66:67], s[86:87]
    s_cbranch_scc1 poll4
    s_cmp_lg_u64 s[68:69], s[86:87]
    s_cbranch_scc1 poll4
    s_cmp_lg_u64 s[70:71], s[86:87]
    s_cbranch_scc1 poll4
    s_cmp_lg_u64 s[72:73], s[86:87]
    s_cbranch_scc1 poll4
    s_cmp_lg_u64 s[74:75], s[86:87]
    s_cbranch_scc1 poll4
    s_cmp_lg_u64 s[76:77], s[86:87]
    s_cbranch_scc1 poll4
    s_cmp_lg_u64 s[78:79], s[86:87]
    s_cbranch_scc1 poll4
poll4_done:
    s_barrier
    s_barrier
    s_barrier
    s_add_u32 s56, s27, 0x18000
    s_mov_b64 exec, 0xffff
    buffer_atomic_swap v10, v11, s[8:11], s56 offen sc1
    s_mov_b64 exec, -1
    s_waitcnt lgkmcnt(0)
    s_add_u32 s58, s28, 0x18000
    s_mov_b32 s59, 100000
poll6:
    s_sub_u32 s59, s59, 1
    s_cbranch_scc1 poll6_done
    s_buffer_load_dwordx16 s[64:79], s[8:11], s58 glc
    s_waitcnt lgkmcnt(0)
    s_cmp_lg_u64 s[64:65], s[86:87]
    s_cbranch_scc1 poll6
    s_cmp_lg_u64 s[66:67], s[86:87]
    s_cbranch_scc1 poll6
    s_cmp_lg_u64 s[68:69], s[86:87]
    s_cbranch_scc1 poll6
    s_cmp_lg_u64 s[70:71], s[86:87]
    s_cbranch_scc1 poll6
    s_cmp_lg_u64 s[72:73], s[86:87]
    s_cbranch_scc1 poll6
    s_cmp_lg_u64 s[74:75], s[86:87]
    s_cbranch_scc1 poll6
    s_cmp_lg_u64 s[76:77], s[86:87]
    s_cbranch_scc1 poll6
    s_cmp_lg_u64 s[78:79], s[86:87]
    s_cbranch_scc1 poll6
poll6_done:
    s_barrier
    s_barrier
    s_cmp_lg_u32 s22, 0
    s_cbranch_scc1 h0_np8
    s_add_u32 s58, s80, 0x40000
    s_mov_b32 s59, 100000
poll5:
    s_sub_u32 s59, s59, 1
    s_cbranch_scc1 poll5_done
    s_buffer_load_dwordx16 s[64:79], s[8:11], s58 glc
    s_waitcnt lgkmcnt(0)
    s_cmp_lg_u64 s[64:65], s[86:87]
    s_cbranch_scc1 poll5
    s_cmp_lg_u64 s[66:67], s[86:87]
    s_cbranch_scc1 poll5
    s_cmp_lg_u64 s[68:69], s[86:87]
    s_cbranch_scc1 poll5
    s_cmp_lg_u64 s[70:71], s[86:87]
    s_cbranch_scc1 poll5
    s_cmp_lg_u64 s[72:73], s[86:87]
    s_cbranch_scc1 poll5
    s_cmp_lg_u64 s[74:75], s[86:87]
    s_cbranch_scc1 poll5
    s_cmp_lg_u64 s[76:77], s[86:87]
    s_cbranch_scc1 poll5
    s_cmp_lg_u64 s[78:79], s[86:87]
    s_cbranch_scc1 poll5
poll5_done:
h0_np8:
    s_barrier
    s_barrier
    s_barrier
    s_barrier
    s_barrier
    s_barrier
    s_barrier
    s_barrier
    s_add_u32 s56, s29, 0x20000
    s_mov_b64 exec, 0xffff
    buffer_atomic_swap v10, v11, s[8:11], s56 offen sc1
    s_mov_b64 exec, -1
    s_barrier
    s_add_u32 s58, s26, 0x20000
    s_waitcnt lgkmcnt(0)
    s_buffer_load_dwordx16 s[64:79], s[8:11], s58 glc
    s_barrier
    s_add_u32 s58, s26, 0x20000
    s_mov_b32 s59, 100000
    s_branch poll10_chk
poll10:
    s_sub_u32 s59, s59, 1
    s_cbranch_scc1 poll10_done
    s_buffer_load_dwordx16 s[64:79], s[8:11], s58 glc
poll10_chk:
    s_waitcnt lgkmcnt(0)
    s_cmp_lg_u64 s[64:65], s[86:87]
    s_cbranch_scc1 poll10
    s_cmp_lg_u64 s[66:67], s[86:87]
    s_cbranch_scc1 poll10
    s_cmp_lg_u64 s[68:69], s[86:87]
    s_cbranch_scc1 poll10
    s_cmp_lg_u64 s[70:71], s[86:87]
    s_cbranch_scc1 poll10
    s_cmp_lg_u64 s[72:73], s[86:87]
    s_cbranch_scc1 poll10
    s_cmp_lg_u64 s[74:75], s[86:87]
    s_cbranch_scc1 poll10
    s_cmp_lg_u64 s[76:77], s[86:87]
    s_cbranch_scc1 poll10
    s_cmp_lg_u64 s[78:79], s[86:87]
    s_cbranch_scc1 poll10
poll10_done:
    s_barrier
    s_add_u32 s56, s29, 0x28000
    s_mov_b64 exec, 0xffff
    buffer_atomic_swap v10, v11, s[8:11], s56 offen sc1
    s_mov_b64 exec, -1
    s_lshl_b32 s62, s23, 11
    v_add_u32 v28, s62, v1
    v_add_u32 v29, 0x10000, v28
    v_add_u32 v30, 0x20000, v28
    s_barrier
    s_barrier
    s_add_u32 s56, s29, 0x30000
    s_mov_b64 exec, 0xffff
    buffer_atomic_swap v10, v11, s[8:11], s56 offen sc1
    s_mov_b64 exec, -1
    s_cmp_eq_u32 s22, 0
    s_cbranch_scc1 kd_15
    ds_write_b128 v28, v[192:195] offset:32768
    ds_write_b128 v28, v[196:199] offset:33792
kd_15:
    s_add_u32 s58, s26, 0x28000
    s_waitcnt lgkmcnt(0)
    s_buffer_load_dwordx16 s[64:79], s[8:11], s58 glc
    s_barrier
    s_cmp_eq_u32 s22, 0
    s_cbranch_scc1 kd_16
    ds_write_b128 v28, v[200:203] offset:49152
    ds_write_b128 v28, v[204:207] offset:50176
kd_16:
    s_add_u32 s58, s26, 0x28000
    s_mov_b32 s59, 100000
    s_branch poll11_chk
poll11:
    s_sub_u32 s59, s59, 1
    s_cbranch_scc1 poll11_done
    s_buffer_load_dwordx16 s[64:79], s[8:11], s58 glc
poll11_chk:
    s_waitcnt lgkmcnt(0)
    s_cmp_lg_u64 s[64:65], s[86:87]
    s_cbranch_scc1 poll11
    s_cmp_lg_u64 s[66:67], s[86:87]
    s_cbranch_scc1 poll11
    s_cmp_lg_u64 s[68:69], s[86:87]
    s_cbranch_scc1 poll11
    s_cmp_lg_u64 s[70:71], s[86:87]
    s_cbranch_scc1 poll11
    s_cmp_lg_u64 s[72:73], s[86:87]
    s_cbranch_scc1 poll11
    s_cmp_lg_u64 s[74:75], s[86:87]
    s_cbranch_scc1 poll11
    s_cmp_lg_u64 s[76:77], s[86:87]
    s_cbranch_scc1 poll11
    s_cmp_lg_u64 s[78:79], s[86:87]
    s_cbranch_scc1 poll11
poll11_done:
    s_barrier
    s_cmp_eq_u32 s22, 0
    s_cbranch_scc1 kd_17
    ds_write_b128 v29, v[208:211] offset:49152
    ds_write_b128 v29, v[212:215] offset:50176
kd_17:
    s_barrier
    s_cmp_eq_u32 s22, 0
    s_cbranch_scc1 kd_18
    ds_write_b128 v30, v[216:219] offset:0
    ds_write_b128 v30, v[220:223] offset:1024
kd_18:
    s_barrier
    s_cmp_eq_u32 s22, 0
    s_cbranch_scc1 kd_19
    ds_write_b128 v30, v[224:227] offset:8192
    ds_write_b128 v30, v[228:231] offset:9216
kd_19:
    s_add_u32 s58, s26, 0x30000
    s_waitcnt lgkmcnt(0)
    s_buffer_load_dwordx16 s[64:79], s[8:11], s58 glc
    s_barrier
    s_cmp_eq_u32 s22, 0
    s_cbranch_scc1 kd_20
    ds_write_b128 v30, v[232:235] offset:16384
    ds_write_b128 v30, v[236:239] offset:17408
kd_20:
    s_add_u32 s58, s26, 0x30000
    s_mov_b32 s59, 100000
    s_branch poll12_chk
poll12:
    s_sub_u32 s59, s59, 1
    s_cbranch_scc1 poll12_done
    s_buffer_load_dwordx16 s[64:79], s[8:11], s58 glc
poll12_chk:
    s_waitcnt lgkmcnt(0)
    s_cmp_lg_u64 s[64:65], s[86:87]
    s_cbranch_scc1 poll12
    s_cmp_lg_u64 s[66:67], s[86:87]
    s_cbranch_scc1 poll12
    s_cmp_lg_u64 s[68:69], s[86:87]
    s_cbranch_scc1 poll12
    s_cmp_lg_u64 s[70:71], s[86:87]
    s_cbranch_scc1 poll12
    s_cmp_lg_u64 s[72:73], s[86:87]
    s_cbranch_scc1 poll12
    s_cmp_lg_u64 s[74:75], s[86:87]
    s_cbranch_scc1 poll12
    s_cmp_lg_u64 s[76:77], s[86:87]
    s_cbranch_scc1 poll12
    s_cmp_lg_u64 s[78:79], s[86:87]
    s_cbranch_scc1 poll12
poll12_done:
    s_barrier
    s_cmp_eq_u32 s22, 0
    s_cbranch_scc1 kd_21
    ds_write_b128 v29, v[240:243] offset:57344
    ds_write_b128 v29, v[244:247] offset:58368
kd_21:
    s_barrier
    s_cmp_eq_u32 s22, 0
    s_cbranch_scc1 kd_22
    ds_write_b128 v29, v[248:251] offset:32768
    ds_write_b128 v29, v[252:255] offset:33792
kd_22:
    s_waitcnt lgkmcnt(0)
    s_barrier
    s_cmp_lg_u32 s22, 0
    s_cbranch_scc1 kd_23
    ds_read_b128 v[32:35], v28 offset:32768
    ds_read_b128 v[36:39], v28 offset:33792
    ds_read_b128 v[40:43], v28 offset:49152
    ds_read_b128 v[44:47], v28 offset:50176
kd_23:
    s_barrier
    s_cmp_lg_u32 s22, 0
    s_cbranch_scc1 kd_24
    ds_read_b128 v[48:51], v29 offset:49152
    ds_read_b128 v[52:55], v29 offset:50176
    ds_read_b128 v[56:59], v30 offset:0
    ds_read_b128 v[60:63], v30 offset:1024
kd_24:
    s_barrier
    s_cmp_lg_u32 s22, 0
    s_cbranch_scc1 kd_25
    ds_read_b128 v[64:67], v30 offset:8192
    ds_read_b128 v[68:71], v30 offset:9216
    ds_read_b128 v[72:75], v30 offset:16384
    ds_read_b128 v[76:79], v30 offset:17408
kd_25:
    s_barrier
    s_cmp_lg_u32 s22, 0
    s_cbranch_scc1 kd_26
    ds_read_b128 v[80:83], v29 offset:57344
    ds_read_b128 v[84:87], v29 offset:58368
    ds_read_b128 v[88:91], v29 offset:32768
    ds_read_b128 v[92:95], v29 offset:33792
kd_26:
    s_waitcnt lgkmcnt(0)
    s_barrier
    s_cmp_lg_u32 s22, 0
    s_cbranch_scc1 h_end
    s_barrier
    s_add_u32 s56, s27, 0x1800000
    s_mov_b64 exec, 0xffff
    buffer_atomic_swap v10, v11, s[8:11], s56 offen sc1
    s_mov_b64 exec, -1
    s_add_u32 s24, s24, 0x1800000
    s_add_u32 s25, s25, 0x1800000
    s_add_u32 s26, s26, 0x1800000
    s_add_u32 s27, s27, 0x1800000
    s_add_u32 s28, s28, 0x1800000
    s_add_u32 s29, s29, 0x1800000
    s_add_u32 s80, s80, 0x1800000
    s_add_u32 s81, s81, 0x1800000
    s_mov_b32 s22, 1
    s_add_u32 s58, s80, 0x0
    s_mov_b32 s59, 100000
poll27:
    s_sub_u32 s59, s59, 1
    s_cbranch_scc1 poll27_done
    s_buffer_load_dwordx16 s[64:79], s[8:11], s58 glc
    s_waitcnt lgkmcnt(0)
    s_cmp_lg_u64 s[64:65], s[86:87]
    s_cbranch_scc1 poll27
    s_cmp_lg_u64 s[66:67], s[86:87]
    s_cbranch_scc1 poll27
    s_cmp_lg_u64 s[68:69], s[86:87]
    s_cbranch_scc1 poll27
    s_cmp_lg_u64 s[70:71], s[86:87]
    s_cbranch_scc1 poll27
    s_cmp_lg_u64 s[72:73], s[86:87]
    s_cbranch_scc1 poll27
    s_cmp_lg_u64 s[74:75], s[86:87]
    s_cbranch_scc1 poll27
    s_cmp_lg_u64 s[76:77], s[86:87]
    s_cbranch_scc1 poll27
    s_cmp_lg_u64 s[78:79], s[86:87]
    s_cbranch_scc1 poll27
poll27_done:
    s_barrier
    s_waitcnt lgkmcnt(0)
    s_lshl_b32 s56, s23, 11
    v_add_u32 v24, s56, v1
    v_add_u32 v25, 0x10000, v24
    ds_write_b128 v24, v[192:195] offset:32768
    ds_write_b128 v24, v[196:199] offset:33792
    ds_write_b128 v24, v[200:203] offset:40960
    ds_write_b128 v24, v[204:207] offset:41984
    ds_write_b128 v24, v[208:211] offset:49152
    ds_write_b128 v24, v[212:215] offset:50176
    ds_write_b128 v24, v[216:219] offset:57344
    ds_write_b128 v24, v[220:223] offset:58368
    ds_write_b128 v25, v[224:227] offset:0
    ds_write_b128 v25, v[228:231] offset:1024
    ds_write_b128 v25, v[232:235] offset:8192
    ds_write_b128 v25, v[236:239] offset:9216
    ds_write_b128 v25, v[240:243] offset:16384
    ds_write_b128 v25, v[244:247] offset:17408
    ds_write_b128 v25, v[248:251] offset:24576
    ds_write_b128 v25, v[252:255] offset:25600
    s_waitcnt lgkmcnt(0)
    v_mov_b64 v[192:193], v[32:33]
    v_mov_b64 v[194:195], v[34:35]
    v_mov_b64 v[196:197], v[36:37]
    v_mov_b64 v[198:199], v[38:39]
    v_mov_b64 v[200:201], v[40:41]
    v_mov_b64 v[202:203], v[42:43]
    v_mov_b64 v[204:205], v[44:45]
    v_mov_b64 v[206:207], v[46:47]
    v_mov_b64 v[208:209], v[48:49]
    v_mov_b64 v[210:211], v[50:51]
    v_mov_b64 v[212:213], v[52:53]
    v_mov_b64 v[214:215], v[54:55]
    v_mov_b64 v[216:217], v[56:57]
    v_mov_b64 v[218:219], v[58:59]
    v_mov_b64 v[220:221], v[60:61]
    v_mov_b64 v[222:223], v[62:63]
    v_mov_b64 v[224:225], v[64:65]
    v_mov_b64 v[226:227], v[66:67]
    v_mov_b64 v[228:229], v[68:69]
    v_mov_b64 v[230:231], v[70:71]
    v_mov_b64 v[232:233], v[72:73]
    v_mov_b64 v[234:235], v[74:75]
    v_mov_b64 v[236:237], v[76:77]
    v_mov_b64 v[238:239], v[78:79]
    v_mov_b64 v[240:241], v[80:81]
    v_mov_b64 v[242:243], v[82:83]
    v_mov_b64 v[244:245], v[84:85]
    v_mov_b64 v[246:247], v[86:87]
    v_mov_b64 v[248:249], v[88:89]
    v_mov_b64 v[250:251], v[90:91]
    v_mov_b64 v[252:253], v[92:93]
    v_mov_b64 v[254:255], v[94:95]
    s_barrier
    s_barrier
    s_barrier
    s_barrier
    s_barrier
    v_and_b32 v13, 31, v0
    v_lshrrev_b32 v56, 5, v0
    v_lshlrev_b32 v56, 2, v56
    v_sub_u32 v13, v13, v56
    v_mov_b32 v56, 0xff800000
    s_cmp_ge_u32 s4, 8
    s_cselect_b32 s60, 0, 0xff800000
    v_mov_b32 v57, s60
    v_cmp_le_i32 vcc, 0, v13
    v_cmp_le_i32 s[62:63], 1, v13
    s_nop 0
    v_cndmask_b32 v64, v56, 0, vcc
    v_cndmask_b32 v96, v57, v56, vcc
    v_cndmask_b32 v65, v56, 0, s[62:63]
    v_cndmask_b32 v97, v57, v56, s[62:63]
    v_cmp_le_i32 vcc, 2, v13
    v_cmp_le_i32 s[62:63], 3, v13
    s_nop 0
    v_cndmask_b32 v66, v56, 0, vcc
    v_cndmask_b32 v98, v57, v56, vcc
    v_cndmask_b32 v67, v56, 0, s[62:63]
    v_cndmask_b32 v99, v57, v56, s[62:63]
    v_cmp_le_i32 vcc, 8, v13
    v_cmp_le_i32 s[62:63], 9, v13
    s_nop 0
    v_cndmask_b32 v68, v56, 0, vcc
    v_cndmask_b32 v100, v57, v56, vcc
    v_cndmask_b32 v69, v56, 0, s[62:63]
    v_cndmask_b32 v101, v57, v56, s[62:63]
    v_cmp_le_i32 vcc, 10, v13
    v_cmp_le_i32 s[62:63], 11, v13
    s_nop 0
    v_cndmask_b32 v70, v56, 0, vcc
    v_cndmask_b32 v102, v57, v56, vcc
    v_cndmask_b32 v71, v56, 0, s[62:63]
    v_cndmask_b32 v103, v57, v56, s[62:63]
    v_cmp_le_i32 vcc, 16, v13
    v_cmp_le_i32 s[62:63], 17, v13
    s_nop 0
    v_cndmask_b32 v72, v56, 0, vcc
    v_cndmask_b32 v104, v57, v56, vcc
    v_cndmask_b32 v73, v56, 0, s[62:63]
    v_cndmask_b32 v105, v57, v56, s[62:63]
    v_cmp_le_i32 vcc, 18, v13
    v_cmp_le_i32 s[62:63], 19, v13
    s_nop 0
    v_cndmask_b32 v74, v56, 0, vcc
    v_cndmask_b32 v106, v57, v56, vcc
    v_cndmask_b32 v75, v56, 0, s[62:63]
    v_cndmask_b32 v107, v57, v56, s[62:63]
    v_cmp_le_i32 vcc, 24, v13
    v_cmp_le_i32 s[62:63], 25, v13
    s_nop 0
    v_cndmask_b32 v76, v56, 0, vcc
    v_cndmask_b32 v108, v57, v56, vcc
    v_cndmask_b32 v77, v56, 0, s[62:63]
    v_cndmask_b32 v109, v57, v56, s[62:63]
    v_cmp_le_i32 vcc, 26, v13
    v_cmp_le_i32 s[62:63], 27, v13
    s_nop 0
    v_cndmask_b32 v78, v56, 0, vcc
    v_cndmask_b32 v110, v57, v56, vcc
    v_cndmask_b32 v79, v56, 0, s[62:63]
    v_cndmask_b32 v111, v57, v56, s[62:63]
    s_lshr_b32 s61, s3, 2
    s_mul_i32 s61, s61, 12
    s_add_u32 s61, s61, s5
    s_lshl_b32 s60, s61, 10
    s_add_u32 s60, s60, 106496
    v_add_u32 v20, s60, v1
    v_lshrrev_b32 v21, 5, v0
    v_lshlrev_b32 v21, 8, v21
    v_and_b32 v12, 15, v0
    v_lshl_add_u32 v21, v12, 4, v21
    v_add_u32 v22, 0x200, v21
    v_and_b32 v12, 16, v0
    v_cmp_ne_u32 vcc, 0, v12
    v_mov_b32 v12, 0x400
    s_nop 0
    v_cndmask_b32 v21, v21, v12, vcc
    v_cndmask_b32 v22, v22, v12, vcc
    s_mul_i32 s60, s61, 1040
    s_add_u32 s60, s60, 131072
    v_add_u32 v21, s60, v21
    v_add_u32 v22, s60, v22
    s_lshl_b32 s60, s16, 12
    s_sub_u32 s60, s60, 8192
    v_add_u32 v12, s60, v1
    v_min_u32 v14, 0x80000000, v12
    v_add_u32 v12, 0x1000, v12
    v_min_u32 v15, 0x80000000, v12
    s_barrier
    s_cmp_ge_u32 s16, 15
    s_cbranch_scc1 h0_qk_28
    s_add_u32 s56, s80, 0x8000
    s_mov_b64 exec, s[54:55]
    buffer_atomic_swap v10, v7, s[8:11], s56 offen sc1
    s_mov_b64 exec, -1
h0_qk_28:
    s_barrier
    ds_read_b128 v[16:19], v8
    s_branch attn
h1_start:
    v_subrev_u32 v31, 12, v0
    v_min_u32 v31, v31, v0
    s_lshl_b32 s56, s16, 2
    v_add_u32 v31, s56, v31
    v_cmp_le_u32 vcc, 8, v31
    v_mov_b32 v31, 0x3f803f80
    s_nop 0
    v_cndmask_b32 v11, 0, v31, vcc
    v_mul_u32_u24 v10, 1040, v0
    v_add_u32 v10, 132096, v10
    s_mul_i32 s31, s21, 14336
    s_add_u32 s31, s31, 0x3c20000
    s_mov_b32 s54, -1
    s_mov_b32 s55, 0xffffff
    s_lshl_b32 s27, s18, 11
    s_add_u32 s27, s27, 0x1500000
    s_lshl_b32 s56, s19, 7
    s_add_u32 s26, s27, s56
    s_lshl2_add_u32 s27, s19, s27
    s_lshl_b32 s29, s20, 11
    s_add_u32 s29, s29, 0x1500000
    s_lshl_b32 s56, s21, 7
    s_add_u32 s28, s29, s56
    s_lshl2_add_u32 s29, s21, s29
    s_lshl_b32 s25, s16, 11
    s_add_u32 s25, s25, 0x1500000
    s_lshl2_add_u32 s25, s17, s25
    s_load_dwordx2 s[64:65], s[0:1], 32
    s_mov_b32 s66, 1835008
    s_mov_b32 s67, 0x00020000
    s_load_dwordx2 s[68:69], s[0:1], 40
    s_mov_b32 s70, 1835008
    s_mov_b32 s71, 0x00020000
    v_lshrrev_b32 v21, 2, v0
    v_mul_u32_u24 v21, 3584, v21
    v_and_b32 v31, 3, v0
    v_lshl_add_u32 v21, v31, 4, v21
    s_mul_i32 s37, s21, 229376
    s_lshl_b32 s7, s20, 11
    s_add_u32 s37, s37, s7
    s_add_u32 s37, s37, 0x3600000
    s_mul_i32 s38, s21, 14336
    s_mul_i32 s7, s20, 896
    s_add_u32 s38, s38, s7
    s_add_u32 s38, s38, 0x3c20000
    v_lshlrev_b32 v30, 2, v0
    s_add_u32 s56, s3, 8
    s_lshl_b32 s56, s56, 13
    v_add_u32 v28, s56, v1
    v_lshrrev_b32 v29, 5, v0
    v_lshlrev_b32 v29, 8, v29
    v_bfe_u32 v31, v0, 2, 2
    v_lshl_add_u32 v29, v31, 6, v29
    v_bfe_u32 v31, v0, 4, 1
    v_lshl_add_u32 v29, v31, 5, v29
    v_and_b32 v31, 3, v0
    v_lshl_add_u32 v29, v31, 3, v29
    v_add_u32 v29, s56, v29
    s_lshr_b32 s6, s21, 1
    s_mul_i32 s6, s6, 7
    s_and_b32 s7, s21, 1
    s_lshl2_add_u32 s58, s7, s6
    s_lshl1_add_u32 s59, s6, s7
    s_add_u32 s59, s59, 6
    s_mul_i32 s62, s20, 114688
    s_lshl_b32 s58, s58, 6
    s_add_u32 s58, s58, s62
    s_add_u32 s60, s58, 57344
    s_lshl_b32 s59, s59, 5
    s_add_u32 s59, s59, s62
    s_add_u32 s61, s59, 57344
    s_sub_u32 s62, s59, 32
    s_sub_u32 s63, s61, 32
    s_waitcnt lgkmcnt(0)
    s_barrier
    s_barrier
    s_waitcnt vmcnt(0)
    s_mov_b32 exec_lo, 0xcccccccc
    s_mov_b32 exec_hi, 0xcccccccc
    buffer_load_dwordx4 v[128:131], v21, s[68:71], s62 offen
    buffer_load_dwordx4 v[132:135], v21, s[68:71], s63 offen
    s_mov_b32 exec_lo, 0x33333333
    s_mov_b32 exec_hi, 0x33333333
    buffer_load_dwordx4 v[128:131], v21, s[64:67], s59 offen
    buffer_load_dwordx4 v[132:135], v21, s[64:67], s61 offen
    s_mov_b64 exec, -1
    s_waitcnt lgkmcnt(0)
    s_add_u32 s86, s86, 0x9e3779b9
    s_mov_b32 s87, s86
    s_lshl_b32 s56, s23, 10
    s_add_u32 s56, s56, 159616
    v_add_u32 v8, s56, v1
    s_barrier
    v_and_b32 v13, 31, v0
    v_lshrrev_b32 v56, 5, v0
    v_lshlrev_b32 v56, 2, v56
    v_sub_u32 v13, v13, v56
    v_mov_b32 v56, 0xff800000
    s_cmp_ge_u32 s4, 8
    s_cselect_b32 s60, 0, 0xff800000
    v_mov_b32 v57, s60
    v_cmp_le_i32 vcc, 0, v13
    v_cmp_le_i32 s[62:63], 1, v13
    s_nop 0
    v_cndmask_b32 v64, v56, 0, vcc
    v_cndmask_b32 v96, v57, v56, vcc
    v_cndmask_b32 v65, v56, 0, s[62:63]
    v_cndmask_b32 v97, v57, v56, s[62:63]
    v_cmp_le_i32 vcc, 2, v13
    v_cmp_le_i32 s[62:63], 3, v13
    s_nop 0
    v_cndmask_b32 v66, v56, 0, vcc
    v_cndmask_b32 v98, v57, v56, vcc
    v_cndmask_b32 v67, v56, 0, s[62:63]
    v_cndmask_b32 v99, v57, v56, s[62:63]
    v_cmp_le_i32 vcc, 8, v13
    v_cmp_le_i32 s[62:63], 9, v13
    s_nop 0
    v_cndmask_b32 v68, v56, 0, vcc
    v_cndmask_b32 v100, v57, v56, vcc
    v_cndmask_b32 v69, v56, 0, s[62:63]
    v_cndmask_b32 v101, v57, v56, s[62:63]
    v_cmp_le_i32 vcc, 10, v13
    v_cmp_le_i32 s[62:63], 11, v13
    s_nop 0
    v_cndmask_b32 v70, v56, 0, vcc
    v_cndmask_b32 v102, v57, v56, vcc
    v_cndmask_b32 v71, v56, 0, s[62:63]
    v_cndmask_b32 v103, v57, v56, s[62:63]
    v_cmp_le_i32 vcc, 16, v13
    v_cmp_le_i32 s[62:63], 17, v13
    s_nop 0
    v_cndmask_b32 v72, v56, 0, vcc
    v_cndmask_b32 v104, v57, v56, vcc
    v_cndmask_b32 v73, v56, 0, s[62:63]
    v_cndmask_b32 v105, v57, v56, s[62:63]
    v_cmp_le_i32 vcc, 18, v13
    v_cmp_le_i32 s[62:63], 19, v13
    s_nop 0
    v_cndmask_b32 v74, v56, 0, vcc
    v_cndmask_b32 v106, v57, v56, vcc
    v_cndmask_b32 v75, v56, 0, s[62:63]
    v_cndmask_b32 v107, v57, v56, s[62:63]
    v_cmp_le_i32 vcc, 24, v13
    v_cmp_le_i32 s[62:63], 25, v13
    s_nop 0
    v_cndmask_b32 v76, v56, 0, vcc
    v_cndmask_b32 v108, v57, v56, vcc
    v_cndmask_b32 v77, v56, 0, s[62:63]
    v_cndmask_b32 v109, v57, v56, s[62:63]
    v_cmp_le_i32 vcc, 26, v13
    v_cmp_le_i32 s[62:63], 27, v13
    s_nop 0
    v_cndmask_b32 v78, v56, 0, vcc
    v_cndmask_b32 v110, v57, v56, vcc
    v_cndmask_b32 v79, v56, 0, s[62:63]
    v_cndmask_b32 v111, v57, v56, s[62:63]
    s_lshr_b32 s61, s3, 2
    s_mul_i32 s61, s61, 12
    s_add_u32 s61, s61, s5
    s_lshl_b32 s60, s61, 10
    s_add_u32 s60, s60, 106496
    v_add_u32 v20, s60, v1
    v_lshrrev_b32 v21, 5, v0
    v_lshlrev_b32 v21, 8, v21
    v_and_b32 v12, 15, v0
    v_lshl_add_u32 v21, v12, 4, v21
    v_add_u32 v22, 0x200, v21
    v_and_b32 v12, 16, v0
    v_cmp_ne_u32 vcc, 0, v12
    v_mov_b32 v12, 0x400
    s_nop 0
    v_cndmask_b32 v21, v21, v12, vcc
    v_cndmask_b32 v22, v22, v12, vcc
    s_mul_i32 s60, s61, 1040
    s_add_u32 s60, s60, 131072
    v_add_u32 v21, s60, v21
    v_add_u32 v22, s60, v22
    s_lshl_b32 s60, s16, 12
    s_sub_u32 s60, s60, 8192
    v_add_u32 v12, s60, v1
    v_min_u32 v14, 0x80000000, v12
    v_add_u32 v12, 0x1000, v12
    v_min_u32 v15, 0x80000000, v12
    s_barrier
    s_barrier
    s_barrier
    s_waitcnt vmcnt(1)
    ds_write_b128 v28, v[128:131] offset:0
    ds_read_b64_tr_b16 v[160:161], v29 offset:0
    ds_read_b64_tr_b16 v[162:163], v29 offset:512
    s_waitcnt vmcnt(0)
    ds_write_b128 v28, v[132:135] offset:1024
    ds_read_b64_tr_b16 v[164:165], v29 offset:1024
    ds_read_b64_tr_b16 v[166:167], v29 offset:1536
    s_add_u32 s39, s37, 65536
    s_waitcnt lgkmcnt(3)
    buffer_store_dwordx4 v[160:163], v1, s[8:11], s39 offen offset:0 sc1
    s_waitcnt lgkmcnt(0)
    buffer_store_dwordx4 v[164:167], v1, s[8:11], s39 offen offset:1024 sc1
    v_mov_b32 v24, 0
    v_dot2c_f32_bf16 v24, 0x3f803f80, v160
    v_dot2c_f32_bf16 v24, 0x3f803f80, v161
    v_dot2c_f32_bf16 v24, 0x3f803f80, v162
    v_dot2c_f32_bf16 v24, 0x3f803f80, v163
    v_dot2c_f32_bf16 v24, 0x3f803f80, v164
    v_dot2c_f32_bf16 v24, 0x3f803f80, v165
    v_dot2c_f32_bf16 v24, 0x3f803f80, v166
    v_dot2c_f32_bf16 v24, 0x3f803f80, v167
    s_nop 2
    v_mov_b32 v25, v24
    s_nop 1
    v_permlane32_swap_b32 v24, v25
    v_add_f32 v24, v24, v25
    s_mov_b64 exec, 0xffffffff
    buffer_store_dword v24, v30, s[8:11], s38 offen offset:256 sc1
    s_mov_b64 exec, -1
    s_lshl_b32 s56, s23, 11
    v_add_u32 v24, s56, v1
    v_add_u32 v25, 0x10000, v24
    ds_read_b128 v[192:195], v24 offset:32768
    ds_read_b128 v[196:199], v24 offset:33792
    ds_read_b128 v[200:203], v24 offset:40960
    ds_read_b128 v[204:207], v24 offset:41984
    ds_read_b128 v[208:211], v24 offset:49152
    ds_read_b128 v[212:215], v24 offset:50176
    ds_read_b128 v[216:219], v24 offset:57344
    ds_read_b128 v[220:223], v24 offset:58368
    ds_read_b128 v[224:227], v25 offset:0
    ds_read_b128 v[228:231], v25 offset:1024
    ds_read_b128 v[232:235], v25 offset:8192
    ds_read_b128 v[236:239], v25 offset:9216
    ds_read_b128 v[240:243], v25 offset:16384
    ds_read_b128 v[244:247], v25 offset:17408
    ds_read_b128 v[248:251], v25 offset:24576
    ds_read_b128 v[252:255], v25 offset:25600
    s_waitcnt lgkmcnt(0)
    s_barrier
    v_mov_b32 v32, v11
    v_mov_b32 v33, v11
    v_mov_b32 v34, v11
    v_mov_b32 v35, v11
    s_mov_b64 exec, 0xffffff
    ds_write_b128 v10, v[32:35]
    s_mov_b64 exec, -1
    s_waitcnt lgkmcnt(0)
    s_barrier
    s_lshl4_add_u32 s6, s16, s17
    s_lshl_b32 s6, s6, 8
    v_mov_b32 v24, 0
    v_lshlrev_b32 v25, 2, v0
    s_add_u32 s7, s6, 0x1410000
    buffer_store_dword v24, v25, s[8:11], s7 offen sc1
    s_add_u32 s7, s6, 0x2c00000
    buffer_store_dword v24, v25, s[8:11], s7 offen sc1
    s_add_u32 s7, s6, 0x2c10000
    buffer_store_dword v24, v25, s[8:11], s7 offen sc1
    s_waitcnt vmcnt(3)
    s_barrier
    s_waitcnt vmcnt(0)
    s_barrier
    s_add_u32 s58, s80, 0x8000
    s_mov_b32 s59, 100000
    s_cmp_eq_u32 s82, 0
    s_cbranch_scc1 poll29_done
poll29:
    s_sub_u32 s59, s59, 1
    s_cbranch_scc1 poll29_done
    s_buffer_load_dwordx2 s[64:65], s[8:11], s58 glc
    s_waitcnt lgkmcnt(0)
    s_cmp_eq_u32 s82, 1
    s_cselect_b32 s65, s86, s65
    s_cmp_lg_u64 s[64:65], s[86:87]
    s_cbranch_scc1 poll29
poll29_done:
    s_add_u32 s56, s81, 0x400000
    s_mov_b32 m0, 106496
    s_nop 0
    buffer_load_dwordx4 v14, s[8:11], s56 offen offset:0 sc1 lds
    buffer_load_dwordx4 v14, s[8:11], s56 offen offset:1024 sc1 lds
    buffer_load_dwordx4 v14, s[8:11], s56 offen offset:2048 sc1 lds
    buffer_load_dwordx4 v14, s[8:11], s56 offen offset:3072 sc1 lds
    s_mov_b32 m0, 110592
    s_nop 0
    buffer_load_dwordx4 v15, s[8:11], s56 offen offset:0 sc1 lds
    buffer_load_dwordx4 v15, s[8:11], s56 offen offset:1024 sc1 lds
    buffer_load_dwordx4 v15, s[8:11], s56 offen offset:2048 sc1 lds
    buffer_load_dwordx4 v15, s[8:11], s56 offen offset:3072 sc1 lds
    s_add_u32 s56, s81, 0x410000
    s_mov_b32 m0, 118784
    s_nop 0
    buffer_load_dwordx4 v14, s[8:11], s56 offen offset:0 sc1 lds
    buffer_load_dwordx4 v14, s[8:11], s56 offen offset:1024 sc1 lds
    buffer_load_dwordx4 v14, s[8:11], s56 offen offset:2048 sc1 lds
    buffer_load_dwordx4 v14, s[8:11], s56 offen offset:3072 sc1 lds
    s_mov_b32 m0, 122880
    s_nop 0
    buffer_load_dwordx4 v15, s[8:11], s56 offen offset:0 sc1 lds
    buffer_load_dwordx4 v15, s[8:11], s56 offen offset:1024 sc1 lds
    buffer_load_dwordx4 v15, s[8:11], s56 offen offset:2048 sc1 lds
    buffer_load_dwordx4 v15, s[8:11], s56 offen offset:3072 sc1 lds
    s_barrier
    ds_read_b128 v[16:19], v8
    s_branch attn
h1_post:
    s_cmp_lg_u32 s22, 0
    s_cbranch_scc1 h1_nocs
    s_mov_b64 exec, s[54:55]
    s_add_u32 s56, s31, 0
    buffer_load_dwordx4 v[128:131], v1, s[8:11], s56 offen offset:0 sc1
    s_add_u32 s56, s31, 896
    buffer_load_dwordx4 v[132:135], v1, s[8:11], s56 offen offset:0 sc1
    s_add_u32 s56, s31, 1792
    buffer_load_dwordx4 v[136:139], v1, s[8:11], s56 offen offset:0 sc1
    s_add_u32 s56, s31, 2688
    buffer_load_dwordx4 v[140:143], v1, s[8:11], s56 offen offset:0 sc1
    s_add_u32 s56, s31, 3584
    buffer_load_dwordx4 v[144:147], v1, s[8:11], s56 offen offset:0 sc1
    s_add_u32 s56, s31, 4480
    buffer_load_dwordx4 v[148:151], v1, s[8:11], s56 offen offset:0 sc1
    s_add_u32 s56, s31, 5376
    buffer_load_dwordx4 v[152:155], v1, s[8:11], s56 offen offset:0 sc1
    s_add_u32 s56, s31, 6272
    buffer_load_dwordx4 v[156:159], v1, s[8:11], s56 offen offset:0 sc1
    s_add_u32 s56, s31, 7168
    buffer_load_dwordx4 v[160:163], v1, s[8:11], s56 offen offset:0 sc1
    s_add_u32 s56, s31, 8064
    buffer_load_dwordx4 v[164:167], v1, s[8:11], s56 offen offset:0 sc1
    s_add_u32 s56, s31, 8960
    buffer_load_dwordx4 v[168:171], v1, s[8:11], s56 offen offset:0 sc1
    s_add_u32 s56, s31, 9856
    buffer_load_dwordx4 v[172:175], v1, s[8:11], s56 offen offset:0 sc1
    s_add_u32 s56, s31, 10752
    buffer_load_dwordx4 v[176:179], v1, s[8:11], s56 offen offset:0 sc1
    s_add_u32 s56, s31, 11648
    buffer_load_dwordx4 v[180:183], v1, s[8:11], s56 offen offset:0 sc1
    s_add_u32 s56, s31, 12544
    buffer_load_dwordx4 v[184:187], v1, s[8:11], s56 offen offset:0 sc1
    s_add_u32 s56, s31, 13440
    buffer_load_dwordx4 v[188:191], v1, s[8:11], s56 offen offset:0 sc1
    s_mov_b64 exec, -1
h1_nocs:
    s_barrier
    s_barrier
    s_barrier
    s_cmp_lg_u32 s22, 0
    s_cbranch_scc1 h1_nocs2
    s_waitcnt vmcnt(0)
    s_mov_b64 exec, s[54:55]
    v_pk_add_f32 v[128:129], v[128:129], v[160:161]
    v_pk_add_f32 v[130:131], v[130:131], v[162:163]
    v_pk_add_f32 v[132:133], v[132:133], v[164:165]
    v_pk_add_f32 v[134:135], v[134:135], v[166:167]
    v_pk_add_f32 v[136:137], v[136:137], v[168:169]
    v_pk_add_f32 v[138:139], v[138:139], v[170:171]
    v_pk_add_f32 v[140:141], v[140:141], v[172:173]
    v_pk_add_f32 v[142:143], v[142:143], v[174:175]
    v_pk_add_f32 v[144:145], v[144:145], v[176:177]
    v_pk_add_f32 v[146:147], v[146:147], v[178:179]
    v_pk_add_f32 v[148:149], v[148:149], v[180:181]
    v_pk_add_f32 v[150:151], v[150:151], v[182:183]
    v_pk_add_f32 v[152:153], v[152:153], v[184:185]
    v_pk_add_f32 v[154:155], v[154:155], v[186:187]
    v_pk_add_f32 v[156:157], v[156:157], v[188:189]
    v_pk_add_f32 v[158:159], v[158:159], v[190:191]
    v_pk_add_f32 v[128:129], v[128:129], v[144:145]
    v_pk_add_f32 v[130:131], v[130:131], v[146:147]
    v_pk_add_f32 v[132:133], v[132:133], v[148:149]
    v_pk_add_f32 v[134:135], v[134:135], v[150:151]
    v_pk_add_f32 v[136:137], v[136:137], v[152:153]
    v_pk_add_f32 v[138:139], v[138:139], v[154:155]
    v_pk_add_f32 v[140:141], v[140:141], v[156:157]
    v_pk_add_f32 v[142:143], v[142:143], v[158:159]
    v_pk_add_f32 v[128:129], v[128:129], v[136:137]
    v_pk_add_f32 v[130:131], v[130:131], v[138:139]
    v_pk_add_f32 v[132:133], v[132:133], v[140:141]
    v_pk_add_f32 v[134:135], v[134:135], v[142:143]
    v_pk_add_f32 v[128:129], v[128:129], v[132:133]
    v_pk_add_f32 v[130:131], v[130:131], v[134:135]
    v_cvt_pk_bf16_f32 v160, v128, v128
    v_lshlrev_b32 v24, 16, v160
    v_sub_f32 v24, v128, v24
    v_cvt_pk_bf16_f32 v161, v24, 0
    v_cvt_pk_bf16_f32 v162, v129, v129
    v_lshlrev_b32 v24, 16, v162
    v_sub_f32 v24, v129, v24
    v_cvt_pk_bf16_f32 v163, v24, 0
    v_cvt_pk_bf16_f32 v164, v130, v130
    v_lshlrev_b32 v24, 16, v164
    v_sub_f32 v24, v130, v24
    v_cvt_pk_bf16_f32 v165, v24, 0
    v_cvt_pk_bf16_f32 v166, v131, v131
    v_lshlrev_b32 v24, 16, v166
    v_sub_f32 v24, v131, v24
    v_cvt_pk_bf16_f32 v167, v24, 0
    v_lshlrev_b32 v25, 5, v0
    v_add_u32 v25, 157824, v25
    ds_write_b128 v25, v[160:163]
    ds_write_b128 v25, v[164:167] offset:16
    s_mov_b64 exec, -1
    s_waitcnt lgkmcnt(0)
h1_nocs2:
    s_waitcnt lgkmcnt(0)
    s_barrier
    s_barrier
    s_barrier
    s_barrier
    s_barrier
    s_barrier
    s_barrier
    s_barrier
    s_barrier
    s_barrier
    s_barrier
    s_barrier
    s_barrier
    s_lshl_b32 s62, s23, 11
    v_add_u32 v28, s62, v1
    v_add_u32 v29, 0x10000, v28
    v_add_u32 v30, 0x20000, v28
    s_barrier
    s_barrier
    s_cmp_eq_u32 s22, 0
    s_cbranch_scc1 kd_30
    ds_write_b128 v28, v[192:195] offset:32768
    ds_write_b128 v28, v[196:199] offset:33792
kd_30:
    s_barrier
    s_cmp_eq_u32 s22, 0
    s_cbranch_scc1 kd_31
    ds_write_b128 v28, v[200:203] offset:49152
    ds_write_b128 v28, v[204:207] offset:50176
kd_31:
    s_barrier
    s_cmp_eq_u32 s22, 0
    s_cbranch_scc1 kd_32
    ds_write_b128 v29, v[208:211] offset:49152
    ds_write_b128 v29, v[212:215] offset:50176
kd_32:
    s_barrier
    s_cmp_eq_u32 s22, 0
    s_cbranch_scc1 kd_33
    ds_write_b128 v30, v[216:219] offset:0
    ds_write_b128 v30, v[220:223] offset:1024
kd_33:
    s_barrier
    s_cmp_eq_u32 s22, 0
    s_cbranch_scc1 kd_34
    ds_write_b128 v30, v[224:227] offset:8192
    ds_write_b128 v30, v[228:231] offset:9216
kd_34:
    s_barrier
    s_cmp_eq_u32 s22, 0
    s_cbranch_scc1 kd_35
    ds_write_b128 v30, v[232:235] offset:16384
    ds_write_b128 v30, v[236:239] offset:17408
kd_35:
    s_barrier
    s_cmp_eq_u32 s22, 0
    s_cbranch_scc1 kd_36
    ds_write_b128 v29, v[240:243] offset:57344
    ds_write_b128 v29, v[244:247] offset:58368
kd_36:
    s_barrier
    s_cmp_eq_u32 s22, 0
    s_cbranch_scc1 kd_37
    ds_write_b128 v29, v[248:251] offset:32768
    ds_write_b128 v29, v[252:255] offset:33792
kd_37:
    s_waitcnt lgkmcnt(0)
    s_barrier
    s_cmp_lg_u32 s22, 0
    s_cbranch_scc1 kd_38
    ds_read_b128 v[32:35], v28 offset:32768
    ds_read_b128 v[36:39], v28 offset:33792
    ds_read_b128 v[40:43], v28 offset:49152
    ds_read_b128 v[44:47], v28 offset:50176
kd_38:
    s_barrier
    s_cmp_lg_u32 s22, 0
    s_cbranch_scc1 kd_39
    ds_read_b128 v[48:51], v29 offset:49152
    ds_read_b128 v[52:55], v29 offset:50176
    ds_read_b128 v[56:59], v30 offset:0
    ds_read_b128 v[60:63], v30 offset:1024
kd_39:
    s_barrier
    s_cmp_lg_u32 s22, 0
    s_cbranch_scc1 kd_40
    ds_read_b128 v[64:67], v30 offset:8192
    ds_read_b128 v[68:71], v30 offset:9216
    ds_read_b128 v[72:75], v30 offset:16384
    ds_read_b128 v[76:79], v30 offset:17408
kd_40:
    s_barrier
    s_cmp_lg_u32 s22, 0
    s_cbranch_scc1 kd_41
    ds_read_b128 v[80:83], v29 offset:57344
    ds_read_b128 v[84:87], v29 offset:58368
    ds_read_b128 v[88:91], v29 offset:32768
    ds_read_b128 v[92:95], v29 offset:33792
kd_41:
    s_waitcnt lgkmcnt(0)
    s_barrier
    s_cmp_lg_u32 s22, 0
    s_cbranch_scc1 h1_end
    s_barrier
    s_waitcnt lgkmcnt(0)
    s_lshl_b32 s56, s23, 11
    v_add_u32 v24, s56, v1
    v_add_u32 v25, 0x10000, v24
    ds_write_b128 v24, v[192:195] offset:32768
    ds_write_b128 v24, v[196:199] offset:33792
    ds_write_b128 v24, v[200:203] offset:40960
    ds_write_b128 v24, v[204:207] offset:41984
    ds_write_b128 v24, v[208:211] offset:49152
    ds_write_b128 v24, v[212:215] offset:50176
    ds_write_b128 v24, v[216:219] offset:57344
    ds_write_b128 v24, v[220:223] offset:58368
    ds_write_b128 v25, v[224:227] offset:0
    ds_write_b128 v25, v[228:231] offset:1024
    ds_write_b128 v25, v[232:235] offset:8192
    ds_write_b128 v25, v[236:239] offset:9216
    ds_write_b128 v25, v[240:243] offset:16384
    ds_write_b128 v25, v[244:247] offset:17408
    ds_write_b128 v25, v[248:251] offset:24576
    ds_write_b128 v25, v[252:255] offset:25600
    s_waitcnt lgkmcnt(0)
    v_mov_b64 v[192:193], v[32:33]
    v_mov_b64 v[194:195], v[34:35]
    v_mov_b64 v[196:197], v[36:37]
    v_mov_b64 v[198:199], v[38:39]
    v_mov_b64 v[200:201], v[40:41]
    v_mov_b64 v[202:203], v[42:43]
    v_mov_b64 v[204:205], v[44:45]
    v_mov_b64 v[206:207], v[46:47]
    v_mov_b64 v[208:209], v[48:49]
    v_mov_b64 v[210:211], v[50:51]
    v_mov_b64 v[212:213], v[52:53]
    v_mov_b64 v[214:215], v[54:55]
    v_mov_b64 v[216:217], v[56:57]
    v_mov_b64 v[218:219], v[58:59]
    v_mov_b64 v[220:221], v[60:61]
    v_mov_b64 v[222:223], v[62:63]
    v_mov_b64 v[224:225], v[64:65]
    v_mov_b64 v[226:227], v[66:67]
    v_mov_b64 v[228:229], v[68:69]
    v_mov_b64 v[230:231], v[70:71]
    v_mov_b64 v[232:233], v[72:73]
    v_mov_b64 v[234:235], v[74:75]
    v_mov_b64 v[236:237], v[76:77]
    v_mov_b64 v[238:239], v[78:79]
    v_mov_b64 v[240:241], v[80:81]
    v_mov_b64 v[242:243], v[82:83]
    v_mov_b64 v[244:245], v[84:85]
    v_mov_b64 v[246:247], v[86:87]
    v_mov_b64 v[248:249], v[88:89]
    v_mov_b64 v[250:251], v[90:91]
    v_mov_b64 v[252:253], v[92:93]
    v_mov_b64 v[254:255], v[94:95]
    s_add_u32 s24, s24, 0x1800000
    s_add_u32 s25, s25, 0x1800000
    s_add_u32 s26, s26, 0x1800000
    s_add_u32 s27, s27, 0x1800000
    s_add_u32 s28, s28, 0x1800000
    s_add_u32 s29, s29, 0x1800000
    s_add_u32 s80, s80, 0x1800000
    s_add_u32 s81, s81, 0x1800000
    s_mov_b32 s22, 1
    s_barrier
    s_barrier
    s_barrier
    s_barrier
    s_barrier
    v_mov_b32 v32, v11
    v_mov_b32 v33, v11
    v_mov_b32 v34, v11
    v_mov_b32 v35, v11
    s_mov_b64 exec, 0xffffff
    ds_write_b128 v10, v[32:35]
    s_mov_b64 exec, -1
    s_waitcnt lgkmcnt(0)
    s_barrier
    v_and_b32 v13, 31, v0
    v_lshrrev_b32 v56, 5, v0
    v_lshlrev_b32 v56, 2, v56
    v_sub_u32 v13, v13, v56
    v_mov_b32 v56, 0xff800000
    s_cmp_ge_u32 s4, 8
    s_cselect_b32 s60, 0, 0xff800000
    v_mov_b32 v57, s60
    v_cmp_le_i32 vcc, 0, v13
    v_cmp_le_i32 s[62:63], 1, v13
    s_nop 0
    v_cndmask_b32 v64, v56, 0, vcc
    v_cndmask_b32 v96, v57, v56, vcc
    v_cndmask_b32 v65, v56, 0, s[62:63]
    v_cndmask_b32 v97, v57, v56, s[62:63]
    v_cmp_le_i32 vcc, 2, v13
    v_cmp_le_i32 s[62:63], 3, v13
    s_nop 0
    v_cndmask_b32 v66, v56, 0, vcc
    v_cndmask_b32 v98, v57, v56, vcc
    v_cndmask_b32 v67, v56, 0, s[62:63]
    v_cndmask_b32 v99, v57, v56, s[62:63]
    v_cmp_le_i32 vcc, 8, v13
    v_cmp_le_i32 s[62:63], 9, v13
    s_nop 0
    v_cndmask_b32 v68, v56, 0, vcc
    v_cndmask_b32 v100, v57, v56, vcc
    v_cndmask_b32 v69, v56, 0, s[62:63]
    v_cndmask_b32 v101, v57, v56, s[62:63]
    v_cmp_le_i32 vcc, 10, v13
    v_cmp_le_i32 s[62:63], 11, v13
    s_nop 0
    v_cndmask_b32 v70, v56, 0, vcc
    v_cndmask_b32 v102, v57, v56, vcc
    v_cndmask_b32 v71, v56, 0, s[62:63]
    v_cndmask_b32 v103, v57, v56, s[62:63]
    v_cmp_le_i32 vcc, 16, v13
    v_cmp_le_i32 s[62:63], 17, v13
    s_nop 0
    v_cndmask_b32 v72, v56, 0, vcc
    v_cndmask_b32 v104, v57, v56, vcc
    v_cndmask_b32 v73, v56, 0, s[62:63]
    v_cndmask_b32 v105, v57, v56, s[62:63]
    v_cmp_le_i32 vcc, 18, v13
    v_cmp_le_i32 s[62:63], 19, v13
    s_nop 0
    v_cndmask_b32 v74, v56, 0, vcc
    v_cndmask_b32 v106, v57, v56, vcc
    v_cndmask_b32 v75, v56, 0, s[62:63]
    v_cndmask_b32 v107, v57, v56, s[62:63]
    v_cmp_le_i32 vcc, 24, v13
    v_cmp_le_i32 s[62:63], 25, v13
    s_nop 0
    v_cndmask_b32 v76, v56, 0, vcc
    v_cndmask_b32 v108, v57, v56, vcc
    v_cndmask_b32 v77, v56, 0, s[62:63]
    v_cndmask_b32 v109, v57, v56, s[62:63]
    v_cmp_le_i32 vcc, 26, v13
    v_cmp_le_i32 s[62:63], 27, v13
    s_nop 0
    v_cndmask_b32 v78, v56, 0, vcc
    v_cndmask_b32 v110, v57, v56, vcc
    v_cndmask_b32 v79, v56, 0, s[62:63]
    v_cndmask_b32 v111, v57, v56, s[62:63]
    s_lshr_b32 s61, s3, 2
    s_mul_i32 s61, s61, 12
    s_add_u32 s61, s61, s5
    s_lshl_b32 s60, s61, 10
    s_add_u32 s60, s60, 106496
    v_add_u32 v20, s60, v1
    v_lshrrev_b32 v21, 5, v0
    v_lshlrev_b32 v21, 8, v21
    v_and_b32 v12, 15, v0
    v_lshl_add_u32 v21, v12, 4, v21
    v_add_u32 v22, 0x200, v21
    v_and_b32 v12, 16, v0
    v_cmp_ne_u32 vcc, 0, v12
    v_mov_b32 v12, 0x400
    s_nop 0
    v_cndmask_b32 v21, v21, v12, vcc
    v_cndmask_b32 v22, v22, v12, vcc
    s_mul_i32 s60, s61, 1040
    s_add_u32 s60, s60, 131072
    v_add_u32 v21, s60, v21
    v_add_u32 v22, s60, v22
    s_lshl_b32 s60, s16, 12
    s_sub_u32 s60, s60, 8192
    v_add_u32 v12, s60, v1
    v_min_u32 v14, 0x80000000, v12
    v_add_u32 v12, 0x1000, v12
    v_min_u32 v15, 0x80000000, v12
    s_barrier
    s_barrier
    s_add_u32 s58, s80, 0x8000
    s_mov_b32 s59, 100000
    s_cmp_eq_u32 s82, 0
    s_cbranch_scc1 poll42_done
poll42:
    s_sub_u32 s59, s59, 1
    s_cbranch_scc1 poll42_done
    s_buffer_load_dwordx2 s[64:65], s[8:11], s58 glc
    s_waitcnt lgkmcnt(0)
    s_cmp_eq_u32 s82, 1
    s_cselect_b32 s65, s86, s65
    s_cmp_lg_u64 s[64:65], s[86:87]
    s_cbranch_scc1 poll42
poll42_done:
    s_add_u32 s56, s81, 0x400000
    s_mov_b32 m0, 106496
    s_nop 0
    buffer_load_dwordx4 v14, s[8:11], s56 offen offset:0 sc1 lds
    buffer_load_dwordx4 v14, s[8:11], s56 offen offset:1024 sc1 lds
    buffer_load_dwordx4 v14, s[8:11], s56 offen offset:2048 sc1 lds
    buffer_load_dwordx4 v14, s[8:11], s56 offen offset:3072 sc1 lds
    s_mov_b32 m0, 110592
    s_nop 0
    buffer_load_dwordx4 v15, s[8:11], s56 offen offset:0 sc1 lds
    buffer_load_dwordx4 v15, s[8:11], s56 offen offset:1024 sc1 lds
    buffer_load_dwordx4 v15, s[8:11], s56 offen offset:2048 sc1 lds
    buffer_load_dwordx4 v15, s[8:11], s56 offen offset:3072 sc1 lds
    s_add_u32 s56, s81, 0x410000
    s_mov_b32 m0, 118784
    s_nop 0
    buffer_load_dwordx4 v14, s[8:11], s56 offen offset:0 sc1 lds
    buffer_load_dwordx4 v14, s[8:11], s56 offen offset:1024 sc1 lds
    buffer_load_dwordx4 v14, s[8:11], s56 offen offset:2048 sc1 lds
    buffer_load_dwordx4 v14, s[8:11], s56 offen offset:3072 sc1 lds
    s_mov_b32 m0, 122880
    s_nop 0
    buffer_load_dwordx4 v15, s[8:11], s56 offen offset:0 sc1 lds
    buffer_load_dwordx4 v15, s[8:11], s56 offen offset:1024 sc1 lds
    buffer_load_dwordx4 v15, s[8:11], s56 offen offset:2048 sc1 lds
    buffer_load_dwordx4 v15, s[8:11], s56 offen offset:3072 sc1 lds
    s_barrier
    ds_read_b128 v[16:19], v8
    s_branch attn
h1_end:
    s_endpgm
h2_start:
    s_sub_u32 s57, s23, 2
    s_lshl_b32 s36, s57, 12
    s_mul_i32 s32, s17, 98304
    s_add_u32 s32, s32, s36
    s_add_u32 s32, s32, 0x3400000
    s_sub_u32 s57, s23, 2
    s_mul_i32 s33, s21, 229376
    s_add_u32 s33, s33, s36
    s_add_u32 s33, s33, 0x3600000
    s_and_b32 s58, s19, 3
    s_lshr_b32 s59, s19, 3
    s_lshl2_add_u32 s58, s59, s58
    s_lshl_b32 s58, s58, 7
    s_mul_i32 s34, s57, 262144
    s_add_u32 s34, s34, s58
    s_mul_i32 s35, s57, 917504
    s_add_u32 s35, s35, s58
    v_lshrrev_b32 v5, 3, v0
    v_lshlrev_b32 v5, 10, v5
    v_bfe_u32 v6, v0, 2, 1
    v_bfe_u32 v7, v0, 4, 1
    v_xor_b32 v6, v6, v7
    v_lshl_add_u32 v5, v6, 6, v5
    v_and_b32 v6, 3, v0
    v_lshl_add_u32 v5, v6, 4, v5
    v_add_u32 v6, 7168, v5
    v_add_u32 v2, s36, v1
    v_add_u32 v3, 0x10000, v2
    v_add_u32 v4, 0x20000, v2
    s_add_u32 s56, s16, s17
    s_add_u32 s66, s56, 0
    s_and_b32 s66, s66, 3
    s_lshl_b32 s66, s66, 13
    s_add_u32 s67, s56, 1
    s_and_b32 s67, s67, 3
    s_lshl_b32 s67, s67, 13
    s_add_u32 s68, s56, 2
    s_and_b32 s68, s68, 3
    s_lshl_b32 s68, s68, 13
    s_add_u32 s69, s56, 3
    s_and_b32 s69, s69, 3
    s_lshl_b32 s69, s69, 13
    s_add_u32 s56, s20, s21
    s_add_u32 s70, s56, 0
    s_and_b32 s70, s70, 3
    s_lshl_b32 s70, s70, 13
    s_add_u32 s71, s56, 1
    s_and_b32 s71, s71, 3
    s_lshl_b32 s71, s71, 13
    s_add_u32 s72, s56, 2
    s_and_b32 s72, s72, 3
    s_lshl_b32 s72, s72, 13
    s_add_u32 s73, s56, 3
    s_and_b32 s73, s73, 3
    s_lshl_b32 s73, s73, 13
    s_lshr_b32 s56, s19, 2
    s_add_u32 s56, s56, s19
    s_lshl1_add_u32 s56, s18, s56
    s_add_u32 s74, s56, 0
    s_and_b32 s74, s74, 3
    s_lshl_b32 s74, s74, 10
    s_add_u32 s75, s56, 1
    s_and_b32 s75, s75, 3
    s_lshl_b32 s75, s75, 10
    s_add_u32 s76, s56, 2
    s_and_b32 s76, s76, 3
    s_lshl_b32 s76, s76, 10
    s_add_u32 s77, s56, 3
    s_and_b32 s77, s77, 3
    s_lshl_b32 s77, s77, 10
    s_lshl_b32 s27, s18, 11
    s_add_u32 s27, s27, 0x1500000
    s_lshl_b32 s56, s19, 7
    s_add_u32 s26, s27, s56
    s_lshl2_add_u32 s27, s19, s27
    s_lshl_b32 s29, s20, 11
    s_add_u32 s29, s29, 0x1500000
    s_lshl_b32 s56, s21, 7
    s_add_u32 s28, s29, s56
    s_lshl2_add_u32 s29, s21, s29
    s_lshl_b32 s25, s16, 11
    s_add_u32 s25, s25, 0x1500000
    s_lshl2_add_u32 s25, s17, s25
    s_lshl_b32 s56, s23, 10
    s_add_u32 s56, s56, 159616
    v_add_u32 v8, s56, v1
    s_lshl_b32 s56, s3, 3
    s_add_u32 s56, s56, 0
    s_load_dwordx2 s[44:45], s[0:1], s56
    s_mov_b32 s46, 1835008
    v_lshrrev_b32 v21, 2, v0
    v_mul_u32_u24 v21, 3584, v21
    v_and_b32 v31, 3, v0
    v_lshl_add_u32 v21, v31, 4, v21
    s_mul_i32 s37, s21, 229376
    s_lshl_b32 s7, s20, 11
    s_add_u32 s37, s37, s7
    s_add_u32 s37, s37, 0x3600000
    s_mul_i32 s38, s21, 14336
    s_mul_i32 s7, s20, 896
    s_add_u32 s38, s38, s7
    s_add_u32 s38, s38, 0x3c20000
    v_lshlrev_b32 v30, 2, v0
    s_add_u32 s56, s3, 8
    s_lshl_b32 s56, s56, 13
    v_add_u32 v28, s56, v1
    v_lshrrev_b32 v29, 5, v0
    v_lshlrev_b32 v29, 8, v29
    v_bfe_u32 v31, v0, 2, 2
    v_lshl_add_u32 v29, v31, 6, v29
    v_bfe_u32 v31, v0, 4, 1
    v_lshl_add_u32 v29, v31, 5, v29
    v_and_b32 v31, 3, v0
    v_lshl_add_u32 v29, v31, 3, v29
    v_add_u32 v29, s56, v29
    s_lshr_b32 s6, s21, 1
    s_mul_i32 s6, s6, 7
    s_and_b32 s7, s21, 1
    s_lshl2_add_u32 s58, s7, s6
    s_lshl1_add_u32 s59, s6, s7
    s_add_u32 s59, s59, 6
    s_mul_i32 s62, s20, 114688
    s_lshl_b32 s58, s58, 6
    s_add_u32 s58, s58, s62
    s_add_u32 s60, s58, 57344
    s_lshl_b32 s59, s59, 5
    s_add_u32 s59, s59, s62
    s_add_u32 s61, s59, 57344
    s_sub_u32 s62, s59, 32
    s_sub_u32 s63, s61, 32
    s_and_b32 s6, s3, 1
    s_lshl_b32 s7, s6, 15
    s_add_u32 s37, s37, s7
    s_lshl_b32 s7, s6, 7
    s_add_u32 s38, s38, s7
    s_waitcnt lgkmcnt(0)
    s_barrier
    s_barrier
    buffer_load_dwordx4 v[128:131], v21, s[44:47], s58 offen offset:0
    buffer_load_dwordx4 v[132:135], v21, s[44:47], s60 offen offset:0
    buffer_load_dwordx4 v[136:139], v21, s[44:47], s58 offen offset:64
    buffer_load_dwordx4 v[140:143], v21, s[44:47], s60 offen offset:64
    buffer_load_dwordx4 v[144:147], v21, s[44:47], s58 offen offset:128
    buffer_load_dwordx4 v[148:151], v21, s[44:47], s60 offen offset:128
    s_waitcnt lgkmcnt(0)
    s_add_u32 s86, s86, 0x9e3779b9
    s_mov_b32 s87, s86
    s_barrier
    v_and_b32 v13, 31, v0
    v_lshrrev_b32 v56, 5, v0
    v_lshlrev_b32 v56, 2, v56
    v_sub_u32 v13, v13, v56
    v_mov_b32 v56, 0xff800000
    s_cmp_ge_u32 s4, 8
    s_cselect_b32 s60, 0, 0xff800000
    v_mov_b32 v57, s60
    v_cmp_le_i32 vcc, 0, v13
    v_cmp_le_i32 s[62:63], 1, v13
    s_nop 0
    v_cndmask_b32 v64, v56, 0, vcc
    v_cndmask_b32 v96, v57, v56, vcc
    v_cndmask_b32 v65, v56, 0, s[62:63]
    v_cndmask_b32 v97, v57, v56, s[62:63]
    v_cmp_le_i32 vcc, 2, v13
    v_cmp_le_i32 s[62:63], 3, v13
    s_nop 0
    v_cndmask_b32 v66, v56, 0, vcc
    v_cndmask_b32 v98, v57, v56, vcc
    v_cndmask_b32 v67, v56, 0, s[62:63]
    v_cndmask_b32 v99, v57, v56, s[62:63]
    v_cmp_le_i32 vcc, 8, v13
    v_cmp_le_i32 s[62:63], 9, v13
    s_nop 0
    v_cndmask_b32 v68, v56, 0, vcc
    v_cndmask_b32 v100, v57, v56, vcc
    v_cndmask_b32 v69, v56, 0, s[62:63]
    v_cndmask_b32 v101, v57, v56, s[62:63]
    v_cmp_le_i32 vcc, 10, v13
    v_cmp_le_i32 s[62:63], 11, v13
    s_nop 0
    v_cndmask_b32 v70, v56, 0, vcc
    v_cndmask_b32 v102, v57, v56, vcc
    v_cndmask_b32 v71, v56, 0, s[62:63]
    v_cndmask_b32 v103, v57, v56, s[62:63]
    v_cmp_le_i32 vcc, 16, v13
    v_cmp_le_i32 s[62:63], 17, v13
    s_nop 0
    v_cndmask_b32 v72, v56, 0, vcc
    v_cndmask_b32 v104, v57, v56, vcc
    v_cndmask_b32 v73, v56, 0, s[62:63]
    v_cndmask_b32 v105, v57, v56, s[62:63]
    v_cmp_le_i32 vcc, 18, v13
    v_cmp_le_i32 s[62:63], 19, v13
    s_nop 0
    v_cndmask_b32 v74, v56, 0, vcc
    v_cndmask_b32 v106, v57, v56, vcc
    v_cndmask_b32 v75, v56, 0, s[62:63]
    v_cndmask_b32 v107, v57, v56, s[62:63]
    v_cmp_le_i32 vcc, 24, v13
    v_cmp_le_i32 s[62:63], 25, v13
    s_nop 0
    v_cndmask_b32 v76, v56, 0, vcc
    v_cndmask_b32 v108, v57, v56, vcc
    v_cndmask_b32 v77, v56, 0, s[62:63]
    v_cndmask_b32 v109, v57, v56, s[62:63]
    v_cmp_le_i32 vcc, 26, v13
    v_cmp_le_i32 s[62:63], 27, v13
    s_nop 0
    v_cndmask_b32 v78, v56, 0, vcc
    v_cndmask_b32 v110, v57, v56, vcc
    v_cndmask_b32 v79, v56, 0, s[62:63]
    v_cndmask_b32 v111, v57, v56, s[62:63]
    s_lshr_b32 s61, s3, 2
    s_mul_i32 s61, s61, 12
    s_add_u32 s61, s61, s5
    s_lshl_b32 s60, s61, 10
    s_add_u32 s60, s60, 106496
    v_add_u32 v20, s60, v1
    v_lshrrev_b32 v21, 5, v0
    v_lshlrev_b32 v21, 8, v21
    v_and_b32 v12, 15, v0
    v_lshl_add_u32 v21, v12, 4, v21
    v_add_u32 v22, 0x200, v21
    v_and_b32 v12, 16, v0
    v_cmp_ne_u32 vcc, 0, v12
    v_mov_b32 v12, 0x400
    s_nop 0
    v_cndmask_b32 v21, v21, v12, vcc
    v_cndmask_b32 v22, v22, v12, vcc
    s_mul_i32 s60, s61, 1040
    s_add_u32 s60, s60, 131072
    v_add_u32 v21, s60, v21
    v_add_u32 v22, s60, v22
    s_lshl_b32 s60, s16, 12
    s_sub_u32 s60, s60, 8192
    v_add_u32 v12, s60, v1
    v_min_u32 v14, 0x80000000, v12
    v_add_u32 v12, 0x1000, v12
    v_min_u32 v15, 0x80000000, v12
    s_barrier
    s_barrier
    s_waitcnt vmcnt(5)
    ds_write_b128 v28, v[128:131] offset:0
    ds_read_b64_tr_b16 v[160:161], v29 offset:0
    ds_read_b64_tr_b16 v[162:163], v29 offset:512
    s_waitcnt vmcnt(4)
    ds_write_b128 v28, v[132:135] offset:1024
    ds_read_b64_tr_b16 v[164:165], v29 offset:1024
    ds_read_b64_tr_b16 v[166:167], v29 offset:1536
    s_add_u32 s39, s37, 0
    s_waitcnt lgkmcnt(3)
    buffer_store_dwordx4 v[160:163], v1, s[8:11], s39 offen offset:0 sc1
    s_waitcnt lgkmcnt(0)
    buffer_store_dwordx4 v[164:167], v1, s[8:11], s39 offen offset:1024 sc1
    v_mov_b32 v24, 0
    v_dot2c_f32_bf16 v24, 0x3f803f80, v160
    v_dot2c_f32_bf16 v24, 0x3f803f80, v161
    v_dot2c_f32_bf16 v24, 0x3f803f80, v162
    v_dot2c_f32_bf16 v24, 0x3f803f80, v163
    v_dot2c_f32_bf16 v24, 0x3f803f80, v164
    v_dot2c_f32_bf16 v24, 0x3f803f80, v165
    v_dot2c_f32_bf16 v24, 0x3f803f80, v166
    v_dot2c_f32_bf16 v24, 0x3f803f80, v167
    s_nop 2
    v_mov_b32 v25, v24
    s_nop 1
    v_permlane32_swap_b32 v24, v25
    v_add_f32 v24, v24, v25
    s_mov_b64 exec, 0xffffffff
    buffer_store_dword v24, v30, s[8:11], s38 offen offset:0 sc1
    s_mov_b64 exec, -1
    s_barrier
    s_waitcnt vmcnt(6)
    ds_write_b128 v28, v[136:139] offset:2048
    ds_read_b64_tr_b16 v[168:169], v29 offset:2048
    ds_read_b64_tr_b16 v[170:171], v29 offset:2560
    s_waitcnt vmcnt(5)
    ds_write_b128 v28, v[140:143] offset:3072
    ds_read_b64_tr_b16 v[172:173], v29 offset:3072
    ds_read_b64_tr_b16 v[174:175], v29 offset:3584
    s_add_u32 s39, s37, 98304
    s_waitcnt lgkmcnt(3)
    buffer_store_dwordx4 v[168:171], v1, s[8:11], s39 offen offset:0 sc1
    s_waitcnt lgkmcnt(0)
    buffer_store_dwordx4 v[172:175], v1, s[8:11], s39 offen offset:1024 sc1
    v_mov_b32 v24, 0
    v_dot2c_f32_bf16 v24, 0x3f803f80, v168
    v_dot2c_f32_bf16 v24, 0x3f803f80, v169
    v_dot2c_f32_bf16 v24, 0x3f803f80, v170
    v_dot2c_f32_bf16 v24, 0x3f803f80, v171
    v_dot2c_f32_bf16 v24, 0x3f803f80, v172
    v_dot2c_f32_bf16 v24, 0x3f803f80, v173
    v_dot2c_f32_bf16 v24, 0x3f803f80, v174
    v_dot2c_f32_bf16 v24, 0x3f803f80, v175
    s_nop 2
    v_mov_b32 v25, v24
    s_nop 1
    v_permlane32_swap_b32 v24, v25
    v_add_f32 v24, v24, v25
    s_mov_b64 exec, 0xffffffff
    buffer_store_dword v24, v30, s[8:11], s38 offen offset:384 sc1
    s_mov_b64 exec, -1
    s_lshl_b32 s56, s23, 11
    v_add_u32 v24, s56, v1
    v_add_u32 v25, 0x10000, v24
    ds_read_b128 v[192:195], v24 offset:32768
    ds_read_b128 v[196:199], v24 offset:33792
    ds_read_b128 v[200:203], v24 offset:40960
    ds_read_b128 v[204:207], v24 offset:41984
    ds_read_b128 v[208:211], v24 offset:49152
    ds_read_b128 v[212:215], v24 offset:50176
    ds_read_b128 v[216:219], v24 offset:57344
    ds_read_b128 v[220:223], v24 offset:58368
    ds_read_b128 v[224:227], v25 offset:0
    ds_read_b128 v[228:231], v25 offset:1024
    ds_read_b128 v[232:235], v25 offset:8192
    ds_read_b128 v[236:239], v25 offset:9216
    ds_read_b128 v[240:243], v25 offset:16384
    ds_read_b128 v[244:247], v25 offset:17408
    ds_read_b128 v[248:251], v25 offset:24576
    ds_read_b128 v[252:255], v25 offset:25600
    s_waitcnt lgkmcnt(0)
    s_barrier
    s_waitcnt vmcnt(7)
    ds_write_b128 v28, v[144:147] offset:4096
    ds_read_b64_tr_b16 v[176:177], v29 offset:4096
    ds_read_b64_tr_b16 v[178:179], v29 offset:4608
    s_waitcnt vmcnt(6)
    ds_write_b128 v28, v[148:151] offset:5120
    ds_read_b64_tr_b16 v[180:181], v29 offset:5120
    ds_read_b64_tr_b16 v[182:183], v29 offset:5632
    s_add_u32 s39, s37, 163840
    s_waitcnt lgkmcnt(3)
    buffer_store_dwordx4 v[176:179], v1, s[8:11], s39 offen offset:0 sc1
    s_waitcnt lgkmcnt(0)
    buffer_store_dwordx4 v[180:183], v1, s[8:11], s39 offen offset:1024 sc1
    v_mov_b32 v24, 0
    v_dot2c_f32_bf16 v24, 0x3f803f80, v176
    v_dot2c_f32_bf16 v24, 0x3f803f80, v177
    v_dot2c_f32_bf16 v24, 0x3f803f80, v178
    v_dot2c_f32_bf16 v24, 0x3f803f80, v179
    v_dot2c_f32_bf16 v24, 0x3f803f80, v180
    v_dot2c_f32_bf16 v24, 0x3f803f80, v181
    v_dot2c_f32_bf16 v24, 0x3f803f80, v182
    v_dot2c_f32_bf16 v24, 0x3f803f80, v183
    s_nop 2
    v_mov_b32 v25, v24
    s_nop 1
    v_permlane32_swap_b32 v24, v25
    v_add_f32 v24, v24, v25
    s_mov_b64 exec, 0xffffffff
    buffer_store_dword v24, v30, s[8:11], s38 offen offset:640 sc1
    s_mov_b64 exec, -1
    s_barrier
    s_waitcnt vmcnt(0)
    s_branch h2_mid
h2_mid:
    s_barrier
    s_add_u32 m0, s36, 0
    s_mul_i32 s56, s74, 64
    s_add_u32 s56, s56, s34
    s_add_u32 s56, s56, 0
    buffer_load_dwordx4 v5, s[88:91], s56 offen offset:0  lds
    buffer_load_dwordx4 v6, s[88:91], s56 offen offset:1024  lds
    s_mul_i32 s56, s74, 64
    s_add_u32 s56, s56, s34
    s_add_u32 s56, s56, 14336
    buffer_load_dwordx4 v5, s[88:91], s56 offen offset:2048  lds
    buffer_load_dwordx4 v6, s[88:91], s56 offen offset:3072  lds
    s_add_u32 m0, s36, 8192
    s_mul_i32 s56, s74, 64
    s_add_u32 s56, s56, s34
    s_add_u32 s56, s56, 32768
    buffer_load_dwordx4 v5, s[88:91], s56 offen offset:0  lds
    buffer_load_dwordx4 v6, s[88:91], s56 offen offset:1024  lds
    s_mul_i32 s56, s74, 64
    s_add_u32 s56, s56, s34
    s_add_u32 s56, s56, 47104
    buffer_load_dwordx4 v5, s[88:91], s56 offen offset:2048  lds
    buffer_load_dwordx4 v6, s[88:91], s56 offen offset:3072  lds
    s_add_u32 m0, s36, 16384
    s_mul_i32 s56, s75, 64
    s_add_u32 s56, s56, s34
    s_add_u32 s56, s56, 0
    buffer_load_dwordx4 v5, s[88:91], s56 offen offset:0  lds
    buffer_load_dwordx4 v6, s[88:91], s56 offen offset:1024  lds
    s_mul_i32 s56, s75, 64
    s_add_u32 s56, s56, s34
    s_add_u32 s56, s56, 14336
    buffer_load_dwordx4 v5, s[88:91], s56 offen offset:2048  lds
    buffer_load_dwordx4 v6, s[88:91], s56 offen offset:3072  lds
    s_barrier
    ds_read_b128 v[16:19], v8
    s_branch attn
h2_post:
    s_waitcnt vmcnt(14)
    s_add_u32 m0, s36, 106496
    s_add_u32 s56, s33, s71
    s_add_u32 s56, s56, 65536
    buffer_load_dwordx4 v1, s[8:11], s56 offen offset:0 sc1 lds
    buffer_load_dwordx4 v1, s[8:11], s56 offen offset:1024 sc1 lds
    buffer_load_dwordx4 v1, s[8:11], s56 offen offset:2048 sc1 lds
    buffer_load_dwordx4 v1, s[8:11], s56 offen offset:3072 sc1 lds
    s_waitcnt vmcnt(14)
    s_add_u32 m0, s36, 114688
    s_add_u32 s56, s33, s72
    s_add_u32 s56, s56, 0
    buffer_load_dwordx4 v1, s[8:11], s56 offen offset:0 sc1 lds
    buffer_load_dwordx4 v1, s[8:11], s56 offen offset:1024 sc1 lds
    buffer_load_dwordx4 v1, s[8:11], s56 offen offset:2048 sc1 lds
    buffer_load_dwordx4 v1, s[8:11], s56 offen offset:3072 sc1 lds
    s_waitcnt vmcnt(14)
    s_add_u32 m0, s36, 122880
    s_add_u32 s56, s33, s72
    s_add_u32 s56, s56, 32768
    buffer_load_dwordx4 v1, s[8:11], s56 offen offset:0 sc1 lds
    buffer_load_dwordx4 v1, s[8:11], s56 offen offset:1024 sc1 lds
    buffer_load_dwordx4 v1, s[8:11], s56 offen offset:2048 sc1 lds
    buffer_load_dwordx4 v1, s[8:11], s56 offen offset:3072 sc1 lds
    s_waitcnt vmcnt(14)
    s_add_u32 m0, s36, 131072
    s_add_u32 s56, s33, s72
    s_add_u32 s56, s56, 65536
    buffer_load_dwordx4 v1, s[8:11], s56 offen offset:0 sc1 lds
    buffer_load_dwordx4 v1, s[8:11], s56 offen offset:1024 sc1 lds
    buffer_load_dwordx4 v1, s[8:11], s56 offen offset:2048 sc1 lds
    buffer_load_dwordx4 v1, s[8:11], s56 offen offset:3072 sc1 lds
    s_waitcnt vmcnt(14)
    s_add_u32 s56, s33, s73
    s_add_u32 s56, s56, 0
    buffer_load_dwordx4 v[32:35], v1, s[8:11], s56 offen offset:0 sc1
    buffer_load_dwordx4 v[36:39], v1, s[8:11], s56 offen offset:1024 sc1
    buffer_load_dwordx4 v[40:43], v1, s[8:11], s56 offen offset:2048 sc1
    buffer_load_dwordx4 v[44:47], v1, s[8:11], s56 offen offset:3072 sc1
    s_waitcnt vmcnt(14)
    s_add_u32 s56, s33, s73
    s_add_u32 s56, s56, 32768
    buffer_load_dwordx4 v[48:51], v1, s[8:11], s56 offen offset:0 sc1
    buffer_load_dwordx4 v[52:55], v1, s[8:11], s56 offen offset:1024 sc1
    buffer_load_dwordx4 v[56:59], v1, s[8:11], s56 offen offset:2048 sc1
    buffer_load_dwordx4 v[60:63], v1, s[8:11], s56 offen offset:3072 sc1
    s_barrier
    s_barrier
    s_waitcnt vmcnt(7)
    ds_write_b128 v2, v[32:35] offset:0
    s_waitcnt vmcnt(6)
    ds_write_b128 v2, v[36:39] offset:1024
    s_waitcnt vmcnt(5)
    ds_write_b128 v2, v[40:43] offset:2048
    s_waitcnt vmcnt(4)
    ds_write_b128 v2, v[44:47] offset:3072
    s_waitcnt vmcnt(3)
    ds_write_b128 v2, v[48:51] offset:8192
    s_waitcnt vmcnt(2)
    ds_write_b128 v2, v[52:55] offset:9216
    s_waitcnt vmcnt(1)
    ds_write_b128 v2, v[56:59] offset:10240
    s_waitcnt vmcnt(0)
    ds_write_b128 v2, v[60:63] offset:11264
    s_barrier
    s_waitcnt vmcnt(14)
    s_add_u32 m0, s36, 16384
    s_add_u32 s56, s33, s73
    s_add_u32 s56, s56, 65536
    buffer_load_dwordx4 v1, s[8:11], s56 offen offset:0 sc1 lds
    buffer_load_dwordx4 v1, s[8:11], s56 offen offset:1024 sc1 lds
    buffer_load_dwordx4 v1, s[8:11], s56 offen offset:2048 sc1 lds
    buffer_load_dwordx4 v1, s[8:11], s56 offen offset:3072 sc1 lds
    s_waitcnt vmcnt(14)
    s_add_u32 m0, s36, 24576
    s_add_u32 s56, s33, s70
    s_add_u32 s56, s56, 98304
    buffer_load_dwordx4 v1, s[8:11], s56 offen offset:0 sc1 lds
    buffer_load_dwordx4 v1, s[8:11], s56 offen offset:1024 sc1 lds
    buffer_load_dwordx4 v1, s[8:11], s56 offen offset:2048 sc1 lds
    buffer_load_dwordx4 v1, s[8:11], s56 offen offset:3072 sc1 lds
    s_waitcnt vmcnt(14)
    s_add_u32 m0, s36, 32768
    s_add_u32 s56, s33, s70
    s_add_u32 s56, s56, 131072
    buffer_load_dwordx4 v1, s[8:11], s56 offen offset:0 sc1 lds
    buffer_load_dwordx4 v1, s[8:11], s56 offen offset:1024 sc1 lds
    buffer_load_dwordx4 v1, s[8:11], s56 offen offset:2048 sc1 lds
    buffer_load_dwordx4 v1, s[8:11], s56 offen offset:3072 sc1 lds
    s_waitcnt vmcnt(14)
    s_add_u32 m0, s36, 40960
    s_add_u32 s56, s33, s71
    s_add_u32 s56, s56, 98304
    buffer_load_dwordx4 v1, s[8:11], s56 offen offset:0 sc1 lds
    buffer_load_dwordx4 v1, s[8:11], s56 offen offset:1024 sc1 lds
    buffer_load_dwordx4 v1, s[8:11], s56 offen offset:2048 sc1 lds
    buffer_load_dwordx4 v1, s[8:11], s56 offen offset:3072 sc1 lds
    s_waitcnt vmcnt(14)
    s_add_u32 m0, s36, 49152
    s_add_u32 s56, s33, s71
    s_add_u32 s56, s56, 131072
    buffer_load_dwordx4 v1, s[8:11], s56 offen offset:0 sc1 lds
    buffer_load_dwordx4 v1, s[8:11], s56 offen offset:1024 sc1 lds
    buffer_load_dwordx4 v1, s[8:11], s56 offen offset:2048 sc1 lds
    buffer_load_dwordx4 v1, s[8:11], s56 offen offset:3072 sc1 lds
    s_waitcnt vmcnt(14)
    s_add_u32 m0, s36, 57344
    s_add_u32 s56, s33, s72
    s_add_u32 s56, s56, 98304
    buffer_load_dwordx4 v1, s[8:11], s56 offen offset:0 sc1 lds
    buffer_load_dwordx4 v1, s[8:11], s56 offen offset:1024 sc1 lds
    buffer_load_dwordx4 v1, s[8:11], s56 offen offset:2048 sc1 lds
    buffer_load_dwordx4 v1, s[8:11], s56 offen offset:3072 sc1 lds
    s_waitcnt lgkmcnt(0)
    s_barrier
    s_waitcnt vmcnt(14)
    s_add_u32 m0, s36, 139264
    s_add_u32 s56, s33, s72
    s_add_u32 s56, s56, 131072
    buffer_load_dwordx4 v1, s[8:11], s56 offen offset:0 sc1 lds
    buffer_load_dwordx4 v1, s[8:11], s56 offen offset:1024 sc1 lds
    buffer_load_dwordx4 v1, s[8:11], s56 offen offset:2048 sc1 lds
    buffer_load_dwordx4 v1, s[8:11], s56 offen offset:3072 sc1 lds
    s_barrier
    s_waitcnt vmcnt(14)
    s_add_u32 m0, s36, 147456
    s_add_u32 s56, s33, s73
    s_add_u32 s56, s56, 98304
    buffer_load_dwordx4 v1, s[8:11], s56 offen offset:0 sc1 lds
    buffer_load_dwordx4 v1, s[8:11], s56 offen offset:1024 sc1 lds
    buffer_load_dwordx4 v1, s[8:11], s56 offen offset:2048 sc1 lds
    buffer_load_dwordx4 v1, s[8:11], s56 offen offset:3072 sc1 lds
    s_barrier
    s_waitcnt vmcnt(14)
    s_add_u32 m0, s36, 65536
    s_add_u32 s56, s33, s73
    s_add_u32 s56, s56, 131072
    buffer_load_dwordx4 v1, s[8:11], s56 offen offset:0 sc1 lds
    buffer_load_dwordx4 v1, s[8:11], s56 offen offset:1024 sc1 lds
    buffer_load_dwordx4 v1, s[8:11], s56 offen offset:2048 sc1 lds
    buffer_load_dwordx4 v1, s[8:11], s56 offen offset:3072 sc1 lds
    s_barrier
    s_waitcnt vmcnt(14)
    s_add_u32 m0, s36, 73728
    s_add_u32 s56, s33, s70
    s_add_u32 s56, s56, 163840
    buffer_load_dwordx4 v1, s[8:11], s56 offen offset:0 sc1 lds
    buffer_load_dwordx4 v1, s[8:11], s56 offen offset:1024 sc1 lds
    buffer_load_dwordx4 v1, s[8:11], s56 offen offset:2048 sc1 lds
    buffer_load_dwordx4 v1, s[8:11], s56 offen offset:3072 sc1 lds
    s_barrier
    s_waitcnt vmcnt(14)
    s_add_u32 m0, s36, 81920
    s_add_u32 s56, s33, s70
    s_add_u32 s56, s56, 196608
    buffer_load_dwordx4 v1, s[8:11], s56 offen offset:0 sc1 lds
    buffer_load_dwordx4 v1, s[8:11], s56 offen offset:1024 sc1 lds
    buffer_load_dwordx4 v1, s[8:11], s56 offen offset:2048 sc1 lds
    buffer_load_dwordx4 v1, s[8:11], s56 offen offset:3072 sc1 lds
    s_waitcnt vmcnt(14)
    s_add_u32 m0, s36, 90112
    s_add_u32 s56, s33, s71
    s_add_u32 s56, s56, 163840
    buffer_load_dwordx4 v1, s[8:11], s56 offen offset:0 sc1 lds
    buffer_load_dwordx4 v1, s[8:11], s56 offen offset:1024 sc1 lds
    buffer_load_dwordx4 v1, s[8:11], s56 offen offset:2048 sc1 lds
    buffer_load_dwordx4 v1, s[8:11], s56 offen offset:3072 sc1 lds
    s_waitcnt vmcnt(14)
    s_add_u32 m0, s36, 98304
    s_add_u32 s56, s33, s71
    s_add_u32 s56, s56, 196608
    buffer_load_dwordx4 v1, s[8:11], s56 offen offset:0 sc1 lds
    buffer_load_dwordx4 v1, s[8:11], s56 offen offset:1024 sc1 lds
    buffer_load_dwordx4 v1, s[8:11], s56 offen offset:2048 sc1 lds
    buffer_load_dwordx4 v1, s[8:11], s56 offen offset:3072 sc1 lds
    s_barrier
    s_waitcnt vmcnt(14)
    s_add_u32 m0, s36, 0
    s_add_u32 s56, s33, s72
    s_add_u32 s56, s56, 163840
    buffer_load_dwordx4 v1, s[8:11], s56 offen offset:0 sc1 lds
    buffer_load_dwordx4 v1, s[8:11], s56 offen offset:1024 sc1 lds
    buffer_load_dwordx4 v1, s[8:11], s56 offen offset:2048 sc1 lds
    buffer_load_dwordx4 v1, s[8:11], s56 offen offset:3072 sc1 lds
    s_waitcnt vmcnt(14)
    s_add_u32 m0, s36, 8192
    s_add_u32 s56, s33, s72
    s_add_u32 s56, s56, 196608
    buffer_load_dwordx4 v1, s[8:11], s56 offen offset:0 sc1 lds
    buffer_load_dwordx4 v1, s[8:11], s56 offen offset:1024 sc1 lds
    buffer_load_dwordx4 v1, s[8:11], s56 offen offset:2048 sc1 lds
    buffer_load_dwordx4 v1, s[8:11], s56 offen offset:3072 sc1 lds
    s_waitcnt vmcnt(14)
    s_add_u32 m0, s36, 16384
    s_add_u32 s56, s33, s73
    s_add_u32 s56, s56, 163840
    buffer_load_dwordx4 v1, s[8:11], s56 offen offset:0 sc1 lds
    buffer_load_dwordx4 v1, s[8:11], s56 offen offset:1024 sc1 lds
    buffer_load_dwordx4 v1, s[8:11], s56 offen offset:2048 sc1 lds
    buffer_load_dwordx4 v1, s[8:11], s56 offen offset:3072 sc1 lds
    s_barrier
    s_waitcnt vmcnt(14)
    s_add_u32 m0, s36, 24576
    s_add_u32 s56, s33, s73
    s_add_u32 s56, s56, 196608
    buffer_load_dwordx4 v1, s[8:11], s56 offen offset:0 sc1 lds
    buffer_load_dwordx4 v1, s[8:11], s56 offen offset:1024 sc1 lds
    buffer_load_dwordx4 v1, s[8:11], s56 offen offset:2048 sc1 lds
    buffer_load_dwordx4 v1, s[8:11], s56 offen offset:3072 sc1 lds
    s_waitcnt vmcnt(14)
    s_add_u32 m0, s36, 32768
    s_mul_i32 s56, s74, 224
    s_add_u32 s56, s56, s35
    s_add_u32 s56, s56, 0
    buffer_load_dwordx4 v5, s[92:95], s56 offen offset:0  lds
    buffer_load_dwordx4 v6, s[92:95], s56 offen offset:1024  lds
    s_mul_i32 s56, s74, 224
    s_add_u32 s56, s56, s35
    s_add_u32 s56, s56, 14336
    buffer_load_dwordx4 v5, s[92:95], s56 offen offset:2048  lds
    buffer_load_dwordx4 v6, s[92:95], s56 offen offset:3072  lds
    s_waitcnt vmcnt(14)
    s_add_u32 m0, s36, 106496
    s_mul_i32 s56, s74, 224
    s_add_u32 s56, s56, s35
    s_add_u32 s56, s56, 98304
    buffer_load_dwordx4 v5, s[92:95], s56 offen offset:0  lds
    buffer_load_dwordx4 v6, s[92:95], s56 offen offset:1024  lds
    s_mul_i32 s56, s74, 224
    s_add_u32 s56, s56, s35
    s_add_u32 s56, s56, 112640
    buffer_load_dwordx4 v5, s[92:95], s56 offen offset:2048  lds
    buffer_load_dwordx4 v6, s[92:95], s56 offen offset:3072  lds
    s_barrier
    s_waitcnt vmcnt(14)
    s_add_u32 m0, s36, 40960
    s_mul_i32 s56, s74, 224
    s_add_u32 s56, s56, s35
    s_add_u32 s56, s56, 131072
    buffer_load_dwordx4 v5, s[92:95], s56 offen offset:0  lds
    buffer_load_dwordx4 v6, s[92:95], s56 offen offset:1024  lds
    s_mul_i32 s56, s74, 224
    s_add_u32 s56, s56, s35
    s_add_u32 s56, s56, 145408
    buffer_load_dwordx4 v5, s[92:95], s56 offen offset:2048  lds
    buffer_load_dwordx4 v6, s[92:95], s56 offen offset:3072  lds
    s_waitcnt vmcnt(14)
    s_add_u32 m0, s36, 49152
    s_mul_i32 s56, s75, 224
    s_add_u32 s56, s56, s35
    s_add_u32 s56, s56, 0
    buffer_load_dwordx4 v5, s[92:95], s56 offen offset:0  lds
    buffer_load_dwordx4 v6, s[92:95], s56 offen offset:1024  lds
    s_mul_i32 s56, s75, 224
    s_add_u32 s56, s56, s35
    s_add_u32 s56, s56, 14336
    buffer_load_dwordx4 v5, s[92:95], s56 offen offset:2048  lds
    buffer_load_dwordx4 v6, s[92:95], s56 offen offset:3072  lds
    s_waitcnt vmcnt(14)
    s_add_u32 m0, s36, 114688
    s_mul_i32 s56, s75, 224
    s_add_u32 s56, s56, s35
    s_add_u32 s56, s56, 98304
    buffer_load_dwordx4 v5, s[92:95], s56 offen offset:0  lds
    buffer_load_dwordx4 v6, s[92:95], s56 offen offset:1024  lds
    s_mul_i32 s56, s75, 224
    s_add_u32 s56, s56, s35
    s_add_u32 s56, s56, 112640
    buffer_load_dwordx4 v5, s[92:95], s56 offen offset:2048  lds
    buffer_load_dwordx4 v6, s[92:95], s56 offen offset:3072  lds
    s_barrier
    s_waitcnt vmcnt(14)
    s_add_u32 m0, s36, 57344
    s_mul_i32 s56, s75, 224
    s_add_u32 s56, s56, s35
    s_add_u32 s56, s56, 131072
    buffer_load_dwordx4 v5, s[92:95], s56 offen offset:0  lds
    buffer_load_dwordx4 v6, s[92:95], s56 offen offset:1024  lds
    s_mul_i32 s56, s75, 224
    s_add_u32 s56, s56, s35
    s_add_u32 s56, s56, 145408
    buffer_load_dwordx4 v5, s[92:95], s56 offen offset:2048  lds
    buffer_load_dwordx4 v6, s[92:95], s56 offen offset:3072  lds
    s_waitcnt vmcnt(14)
    s_add_u32 m0, s36, 122880
    s_mul_i32 s56, s76, 224
    s_add_u32 s56, s56, s35
    s_add_u32 s56, s56, 0
    buffer_load_dwordx4 v5, s[92:95], s56 offen offset:0  lds
    buffer_load_dwordx4 v6, s[92:95], s56 offen offset:1024  lds
    s_mul_i32 s56, s76, 224
    s_add_u32 s56, s56, s35
    s_add_u32 s56, s56, 14336
    buffer_load_dwordx4 v5, s[92:95], s56 offen offset:2048  lds
    buffer_load_dwordx4 v6, s[92:95], s56 offen offset:3072  lds
    s_waitcnt vmcnt(14)
    s_add_u32 m0, s36, 131072
    s_mul_i32 s56, s76, 224
    s_add_u32 s56, s56, s35
    s_add_u32 s56, s56, 98304
    buffer_load_dwordx4 v5, s[92:95], s56 offen offset:0  lds
    buffer_load_dwordx4 v6, s[92:95], s56 offen offset:1024  lds
    s_mul_i32 s56, s76, 224
    s_add_u32 s56, s56, s35
    s_add_u32 s56, s56, 112640
    buffer_load_dwordx4 v5, s[92:95], s56 offen offset:2048  lds
    buffer_load_dwordx4 v6, s[92:95], s56 offen offset:3072  lds
    s_barrier
    s_waitcnt vmcnt(14)
    s_add_u32 m0, s36, 65536
    s_mul_i32 s56, s76, 224
    s_add_u32 s56, s56, s35
    s_add_u32 s56, s56, 131072
    buffer_load_dwordx4 v5, s[92:95], s56 offen offset:0  lds
    buffer_load_dwordx4 v6, s[92:95], s56 offen offset:1024  lds
    s_mul_i32 s56, s76, 224
    s_add_u32 s56, s56, s35
    s_add_u32 s56, s56, 145408
    buffer_load_dwordx4 v5, s[92:95], s56 offen offset:2048  lds
    buffer_load_dwordx4 v6, s[92:95], s56 offen offset:3072  lds
    s_waitcnt vmcnt(14)
    s_add_u32 m0, s36, 139264
    s_mul_i32 s56, s77, 224
    s_add_u32 s56, s56, s35
    s_add_u32 s56, s56, 0
    buffer_load_dwordx4 v5, s[92:95], s56 offen offset:0  lds
    buffer_load_dwordx4 v6, s[92:95], s56 offen offset:1024  lds
    s_mul_i32 s56, s77, 224
    s_add_u32 s56, s56, s35
    s_add_u32 s56, s56, 14336
    buffer_load_dwordx4 v5, s[92:95], s56 offen offset:2048  lds
    buffer_load_dwordx4 v6, s[92:95], s56 offen offset:3072  lds
    s_waitcnt vmcnt(14)
    s_add_u32 m0, s36, 147456
    s_mul_i32 s56, s77, 224
    s_add_u32 s56, s56, s35
    s_add_u32 s56, s56, 98304
    buffer_load_dwordx4 v5, s[92:95], s56 offen offset:0  lds
    buffer_load_dwordx4 v6, s[92:95], s56 offen offset:1024  lds
    s_mul_i32 s56, s77, 224
    s_add_u32 s56, s56, s35
    s_add_u32 s56, s56, 112640
    buffer_load_dwordx4 v5, s[92:95], s56 offen offset:2048  lds
    buffer_load_dwordx4 v6, s[92:95], s56 offen offset:3072  lds
    s_barrier
    s_waitcnt vmcnt(14)
    s_add_u32 m0, s36, 73728
    s_mul_i32 s56, s77, 224
    s_add_u32 s56, s56, s35
    s_add_u32 s56, s56, 131072
    buffer_load_dwordx4 v5, s[92:95], s56 offen offset:0  lds
    buffer_load_dwordx4 v6, s[92:95], s56 offen offset:1024  lds
    s_mul_i32 s56, s77, 224
    s_add_u32 s56, s56, s35
    s_add_u32 s56, s56, 145408
    buffer_load_dwordx4 v5, s[92:95], s56 offen offset:2048  lds
    buffer_load_dwordx4 v6, s[92:95], s56 offen offset:3072  lds
    s_waitcnt vmcnt(14)
    s_add_u32 m0, s36, 81920
    s_mul_i32 s56, s74, 224
    s_add_u32 s56, s56, s35
    s_add_u32 s56, s56, 32768
    buffer_load_dwordx4 v5, s[92:95], s56 offen offset:0  lds
    buffer_load_dwordx4 v6, s[92:95], s56 offen offset:1024  lds
    s_mul_i32 s56, s74, 224
    s_add_u32 s56, s56, s35
    s_add_u32 s56, s56, 47104
    buffer_load_dwordx4 v5, s[92:95], s56 offen offset:2048  lds
    buffer_load_dwordx4 v6, s[92:95], s56 offen offset:3072  lds
    s_waitcnt vmcnt(14)
    s_mul_i32 s56, s74, 224
    s_add_u32 s56, s56, s35
    s_add_u32 s56, s56, 163840
    buffer_load_dwordx4 v[64:67], v5, s[92:95], s56 offen offset:0
    buffer_load_dwordx4 v[68:71], v6, s[92:95], s56 offen offset:1024
    s_mul_i32 s56, s74, 224
    s_add_u32 s56, s56, s35
    s_add_u32 s56, s56, 178176
    buffer_load_dwordx4 v[72:75], v5, s[92:95], s56 offen offset:2048
    buffer_load_dwordx4 v[76:79], v6, s[92:95], s56 offen offset:3072
    s_barrier
    s_waitcnt vmcnt(3)
    ds_write_b128 v3, v[64:67] offset:24576
    s_waitcnt vmcnt(2)
    ds_write_b128 v3, v[68:71] offset:25600
    s_waitcnt vmcnt(1)
    ds_write_b128 v3, v[72:75] offset:26624
    s_waitcnt vmcnt(0)
    ds_write_b128 v3, v[76:79] offset:27648
    s_waitcnt vmcnt(14)
    s_add_u32 m0, s36, 98304
    s_mul_i32 s56, s75, 224
    s_add_u32 s56, s56, s35
    s_add_u32 s56, s56, 32768
    buffer_load_dwordx4 v5, s[92:95], s56 offen offset:0  lds
    buffer_load_dwordx4 v6, s[92:95], s56 offen offset:1024  lds
    s_mul_i32 s56, s75, 224
    s_add_u32 s56, s56, s35
    s_add_u32 s56, s56, 47104
    buffer_load_dwordx4 v5, s[92:95], s56 offen offset:2048  lds
    buffer_load_dwordx4 v6, s[92:95], s56 offen offset:3072  lds
    s_waitcnt vmcnt(14)
    s_mul_i32 s56, s75, 224
    s_add_u32 s56, s56, s35
    s_add_u32 s56, s56, 163840
    buffer_load_dwordx4 v[80:83], v5, s[92:95], s56 offen offset:0
    buffer_load_dwordx4 v[84:87], v6, s[92:95], s56 offen offset:1024
    s_mul_i32 s56, s75, 224
    s_add_u32 s56, s56, s35
    s_add_u32 s56, s56, 178176
    buffer_load_dwordx4 v[88:91], v5, s[92:95], s56 offen offset:2048
    buffer_load_dwordx4 v[92:95], v6, s[92:95], s56 offen offset:3072
    s_waitcnt vmcnt(14)
    s_mul_i32 s56, s76, 224
    s_add_u32 s56, s56, s35
    s_add_u32 s56, s56, 32768
    buffer_load_dwordx4 v[96:99], v5, s[92:95], s56 offen offset:0
    buffer_load_dwordx4 v[100:103], v6, s[92:95], s56 offen offset:1024
    s_mul_i32 s56, s76, 224
    s_add_u32 s56, s56, s35
    s_add_u32 s56, s56, 47104
    buffer_load_dwordx4 v[104:107], v5, s[92:95], s56 offen offset:2048
    buffer_load_dwordx4 v[108:111], v6, s[92:95], s56 offen offset:3072
    s_barrier
    s_waitcnt vmcnt(7)
    ds_write_b128 v2, v[80:83] offset:0
    s_waitcnt vmcnt(6)
    ds_write_b128 v2, v[84:87] offset:1024
    s_waitcnt vmcnt(5)
    ds_write_b128 v2, v[88:91] offset:2048
    s_waitcnt vmcnt(4)
    ds_write_b128 v2, v[92:95] offset:3072
    s_waitcnt vmcnt(3)
    ds_write_b128 v2, v[96:99] offset:8192
    s_waitcnt vmcnt(2)
    ds_write_b128 v2, v[100:103] offset:9216
    s_waitcnt vmcnt(1)
    ds_write_b128 v2, v[104:107] offset:10240
    s_waitcnt vmcnt(0)
    ds_write_b128 v2, v[108:111] offset:11264
    s_waitcnt vmcnt(14)
    s_mul_i32 s56, s76, 224
    s_add_u32 s56, s56, s35
    s_add_u32 s56, s56, 163840
    buffer_load_dwordx4 v[112:115], v5, s[92:95], s56 offen offset:0
    buffer_load_dwordx4 v[116:119], v6, s[92:95], s56 offen offset:1024
    s_mul_i32 s56, s76, 224
    s_add_u32 s56, s56, s35
    s_add_u32 s56, s56, 178176
    buffer_load_dwordx4 v[120:123], v5, s[92:95], s56 offen offset:2048
    buffer_load_dwordx4 v[124:127], v6, s[92:95], s56 offen offset:3072
    s_waitcnt vmcnt(14)
    s_mul_i32 s56, s77, 224
    s_add_u32 s56, s56, s35
    s_add_u32 s56, s56, 32768
    buffer_load_dwordx4 v[128:131], v5, s[92:95], s56 offen offset:0
    buffer_load_dwordx4 v[132:135], v6, s[92:95], s56 offen offset:1024
    s_mul_i32 s56, s77, 224
    s_add_u32 s56, s56, s35
    s_add_u32 s56, s56, 47104
    buffer_load_dwordx4 v[136:139], v5, s[92:95], s56 offen offset:2048
    buffer_load_dwordx4 v[140:143], v6, s[92:95], s56 offen offset:3072
    s_lshl_b32 s62, s23, 11
    v_add_u32 v28, s62, v1
    v_add_u32 v29, 0x10000, v28
    v_add_u32 v30, 0x20000, v28
    s_barrier
    s_waitcnt vmcnt(7)
    ds_write_b128 v2, v[112:115] offset:16384
    s_waitcnt vmcnt(6)
    ds_write_b128 v2, v[116:119] offset:17408
    s_waitcnt vmcnt(5)
    ds_write_b128 v2, v[120:123] offset:18432
    s_waitcnt vmcnt(4)
    ds_write_b128 v2, v[124:127] offset:19456
    s_waitcnt vmcnt(3)
    ds_write_b128 v2, v[128:131] offset:24576
    s_waitcnt vmcnt(2)
    ds_write_b128 v2, v[132:135] offset:25600
    s_waitcnt vmcnt(1)
    ds_write_b128 v2, v[136:139] offset:26624
    s_waitcnt vmcnt(0)
    ds_write_b128 v2, v[140:143] offset:27648
    s_waitcnt vmcnt(14)
    s_mul_i32 s56, s77, 224
    s_add_u32 s56, s56, s35
    s_add_u32 s56, s56, 163840
    buffer_load_dwordx4 v[144:147], v5, s[92:95], s56 offen offset:0
    buffer_load_dwordx4 v[148:151], v6, s[92:95], s56 offen offset:1024
    s_mul_i32 s56, s77, 224
    s_add_u32 s56, s56, s35
    s_add_u32 s56, s56, 178176
    buffer_load_dwordx4 v[152:155], v5, s[92:95], s56 offen offset:2048
    buffer_load_dwordx4 v[156:159], v6, s[92:95], s56 offen offset:3072
    s_cmp_lg_u32 s22, 0
    s_cbranch_scc1 h2_l1
    s_barrier
    s_waitcnt vmcnt(3)
    ds_write_b128 v3, v[144:147] offset:40960
    s_waitcnt vmcnt(2)
    ds_write_b128 v3, v[148:151] offset:41984
    s_waitcnt vmcnt(1)
    ds_write_b128 v3, v[152:155] offset:43008
    s_waitcnt vmcnt(0)
    ds_write_b128 v3, v[156:159] offset:44032
    s_waitcnt vmcnt(14)
    s_add_u32 m0, s36, 32768
    s_mul_i32 s56, s74, 224
    s_add_u32 s56, s56, s35
    s_add_u32 s56, s56, 65536
    buffer_load_dwordx4 v5, s[92:95], s56 offen offset:0  lds
    buffer_load_dwordx4 v6, s[92:95], s56 offen offset:1024  lds
    s_mul_i32 s56, s74, 224
    s_add_u32 s56, s56, s35
    s_add_u32 s56, s56, 79872
    buffer_load_dwordx4 v5, s[92:95], s56 offen offset:2048  lds
    buffer_load_dwordx4 v6, s[92:95], s56 offen offset:3072  lds
    s_barrier
    s_waitcnt vmcnt(14)
    s_add_u32 m0, s36, 49152
    s_mul_i32 s56, s74, 224
    s_add_u32 s56, s56, s35
    s_add_u32 s56, s56, 196608
    buffer_load_dwordx4 v5, s[92:95], s56 offen offset:0  lds
    buffer_load_dwordx4 v6, s[92:95], s56 offen offset:1024  lds
    s_mul_i32 s56, s74, 224
    s_add_u32 s56, s56, s35
    s_add_u32 s56, s56, 210944
    buffer_load_dwordx4 v5, s[92:95], s56 offen offset:2048  lds
    buffer_load_dwordx4 v6, s[92:95], s56 offen offset:3072  lds
    s_barrier
    s_waitcnt vmcnt(14)
    s_add_u32 m0, s36, 114688
    s_mul_i32 s56, s75, 224
    s_add_u32 s56, s56, s35
    s_add_u32 s56, s56, 65536
    buffer_load_dwordx4 v5, s[92:95], s56 offen offset:0  lds
    buffer_load_dwordx4 v6, s[92:95], s56 offen offset:1024  lds
    s_mul_i32 s56, s75, 224
    s_add_u32 s56, s56, s35
    s_add_u32 s56, s56, 79872
    buffer_load_dwordx4 v5, s[92:95], s56 offen offset:2048  lds
    buffer_load_dwordx4 v6, s[92:95], s56 offen offset:3072  lds
    s_barrier
    s_waitcnt vmcnt(14)
    s_add_u32 m0, s36, 131072
    s_mul_i32 s56, s75, 224
    s_add_u32 s56, s56, s35
    s_add_u32 s56, s56, 196608
    buffer_load_dwordx4 v5, s[92:95], s56 offen offset:0  lds
    buffer_load_dwordx4 v6, s[92:95], s56 offen offset:1024  lds
    s_mul_i32 s56, s75, 224
    s_add_u32 s56, s56, s35
    s_add_u32 s56, s56, 210944
    buffer_load_dwordx4 v5, s[92:95], s56 offen offset:2048  lds
    buffer_load_dwordx4 v6, s[92:95], s56 offen offset:3072  lds
    s_waitcnt lgkmcnt(15)
    s_barrier
    s_waitcnt vmcnt(14)
    s_add_u32 m0, s36, 139264
    s_mul_i32 s56, s76, 224
    s_add_u32 s56, s56, s35
    s_add_u32 s56, s56, 65536
    buffer_load_dwordx4 v5, s[92:95], s56 offen offset:0  lds
    buffer_load_dwordx4 v6, s[92:95], s56 offen offset:1024  lds
    s_mul_i32 s56, s76, 224
    s_add_u32 s56, s56, s35
    s_add_u32 s56, s56, 79872
    buffer_load_dwordx4 v5, s[92:95], s56 offen offset:2048  lds
    buffer_load_dwordx4 v6, s[92:95], s56 offen offset:3072  lds
    s_barrier
    s_waitcnt vmcnt(14)
    s_add_u32 m0, s36, 147456
    s_mul_i32 s56, s76, 224
    s_add_u32 s56, s56, s35
    s_add_u32 s56, s56, 196608
    buffer_load_dwordx4 v5, s[92:95], s56 offen offset:0  lds
    buffer_load_dwordx4 v6, s[92:95], s56 offen offset:1024  lds
    s_mul_i32 s56, s76, 224
    s_add_u32 s56, s56, s35
    s_add_u32 s56, s56, 210944
    buffer_load_dwordx4 v5, s[92:95], s56 offen offset:2048  lds
    buffer_load_dwordx4 v6, s[92:95], s56 offen offset:3072  lds
    s_waitcnt lgkmcnt(8)
    s_barrier
    s_waitcnt vmcnt(14)
    s_add_u32 m0, s36, 122880
    s_mul_i32 s56, s77, 224
    s_add_u32 s56, s56, s35
    s_add_u32 s56, s56, 65536
    buffer_load_dwordx4 v5, s[92:95], s56 offen offset:0  lds
    buffer_load_dwordx4 v6, s[92:95], s56 offen offset:1024  lds
    s_mul_i32 s56, s77, 224
    s_add_u32 s56, s56, s35
    s_add_u32 s56, s56, 79872
    buffer_load_dwordx4 v5, s[92:95], s56 offen offset:2048  lds
    buffer_load_dwordx4 v6, s[92:95], s56 offen offset:3072  lds
    s_waitcnt lgkmcnt(0)
    s_barrier
    s_waitcnt vmcnt(14)
    s_add_u32 m0, s36, 98304
    s_mul_i32 s56, s77, 224
    s_add_u32 s56, s56, s35
    s_add_u32 s56, s56, 196608
    buffer_load_dwordx4 v5, s[92:95], s56 offen offset:0  lds
    buffer_load_dwordx4 v6, s[92:95], s56 offen offset:1024  lds
    s_mul_i32 s56, s77, 224
    s_add_u32 s56, s56, s35
    s_add_u32 s56, s56, 210944
    buffer_load_dwordx4 v5, s[92:95], s56 offen offset:2048  lds
    buffer_load_dwordx4 v6, s[92:95], s56 offen offset:3072  lds
    s_waitcnt lgkmcnt(0)
    s_barrier
    ds_read_b128 v[32:35], v28 offset:32768
    ds_read_b128 v[36:39], v28 offset:33792
    ds_read_b128 v[40:43], v28 offset:49152
    ds_read_b128 v[44:47], v28 offset:50176
    s_waitcnt vmcnt(16)
    s_barrier
    ds_read_b128 v[48:51], v29 offset:49152
    ds_read_b128 v[52:55], v29 offset:50176
    ds_read_b128 v[56:59], v30 offset:0
    ds_read_b128 v[60:63], v30 offset:1024
    s_waitcnt vmcnt(8)
    s_barrier
    ds_read_b128 v[64:67], v30 offset:8192
    ds_read_b128 v[68:71], v30 offset:9216
    ds_read_b128 v[72:75], v30 offset:16384
    ds_read_b128 v[76:79], v30 offset:17408
    s_waitcnt vmcnt(0)
    s_barrier
    ds_read_b128 v[80:83], v29 offset:57344
    ds_read_b128 v[84:87], v29 offset:58368
    ds_read_b128 v[88:91], v29 offset:32768
    ds_read_b128 v[92:95], v29 offset:33792
    s_waitcnt lgkmcnt(0)
    s_barrier
    s_cmp_lg_u32 s22, 0
    s_cbranch_scc1 h_end
    s_barrier
    s_waitcnt vmcnt(14)
    s_add_u32 m0, s36, 0
    s_add_u32 s56, s32, s66
    s_add_u32 s56, s56, 0
    buffer_load_dwordx4 v1, s[8:11], s56 offen offset:0 sc1 lds
    buffer_load_dwordx4 v1, s[8:11], s56 offen offset:1024 sc1 lds
    buffer_load_dwordx4 v1, s[8:11], s56 offen offset:2048 sc1 lds
    buffer_load_dwordx4 v1, s[8:11], s56 offen offset:3072 sc1 lds
    s_waitcnt vmcnt(14)
    s_add_u32 m0, s36, 8192
    s_add_u32 s56, s32, s66
    s_add_u32 s56, s56, 65536
    buffer_load_dwordx4 v1, s[8:11], s56 offen offset:0 sc1 lds
    buffer_load_dwordx4 v1, s[8:11], s56 offen offset:1024 sc1 lds
    buffer_load_dwordx4 v1, s[8:11], s56 offen offset:2048 sc1 lds
    buffer_load_dwordx4 v1, s[8:11], s56 offen offset:3072 sc1 lds
    s_waitcnt vmcnt(14)
    s_add_u32 m0, s36, 16384
    s_add_u32 s56, s32, s67
    s_add_u32 s56, s56, 0
    buffer_load_dwordx4 v1, s[8:11], s56 offen offset:0 sc1 lds
    buffer_load_dwordx4 v1, s[8:11], s56 offen offset:1024 sc1 lds
    buffer_load_dwordx4 v1, s[8:11], s56 offen offset:2048 sc1 lds
    buffer_load_dwordx4 v1, s[8:11], s56 offen offset:3072 sc1 lds
    s_waitcnt vmcnt(14)
    s_add_u32 m0, s36, 24576
    s_add_u32 s56, s32, s67
    s_add_u32 s56, s56, 65536
    buffer_load_dwordx4 v1, s[8:11], s56 offen offset:0 sc1 lds
    buffer_load_dwordx4 v1, s[8:11], s56 offen offset:1024 sc1 lds
    buffer_load_dwordx4 v1, s[8:11], s56 offen offset:2048 sc1 lds
    buffer_load_dwordx4 v1, s[8:11], s56 offen offset:3072 sc1 lds
    s_waitcnt lgkmcnt(0)
    s_lshl_b32 s56, s23, 11
    v_add_u32 v24, s56, v1
    v_add_u32 v25, 0x10000, v24
    ds_write_b128 v24, v[192:195] offset:32768
    ds_write_b128 v24, v[196:199] offset:33792
    ds_write_b128 v24, v[200:203] offset:40960
    ds_write_b128 v24, v[204:207] offset:41984
    ds_write_b128 v24, v[208:211] offset:49152
    ds_write_b128 v24, v[212:215] offset:50176
    ds_write_b128 v24, v[216:219] offset:57344
    ds_write_b128 v24, v[220:223] offset:58368
    ds_write_b128 v25, v[224:227] offset:0
    ds_write_b128 v25, v[228:231] offset:1024
    ds_write_b128 v25, v[232:235] offset:8192
    ds_write_b128 v25, v[236:239] offset:9216
    ds_write_b128 v25, v[240:243] offset:16384
    ds_write_b128 v25, v[244:247] offset:17408
    ds_write_b128 v25, v[248:251] offset:24576
    ds_write_b128 v25, v[252:255] offset:25600
    s_waitcnt lgkmcnt(0)
    v_mov_b64 v[192:193], v[32:33]
    v_mov_b64 v[194:195], v[34:35]
    v_mov_b64 v[196:197], v[36:37]
    v_mov_b64 v[198:199], v[38:39]
    v_mov_b64 v[200:201], v[40:41]
    v_mov_b64 v[202:203], v[42:43]
    v_mov_b64 v[204:205], v[44:45]
    v_mov_b64 v[206:207], v[46:47]
    v_mov_b64 v[208:209], v[48:49]
    v_mov_b64 v[210:211], v[50:51]
    v_mov_b64 v[212:213], v[52:53]
    v_mov_b64 v[214:215], v[54:55]
    v_mov_b64 v[216:217], v[56:57]
    v_mov_b64 v[218:219], v[58:59]
    v_mov_b64 v[220:221], v[60:61]
    v_mov_b64 v[222:223], v[62:63]
    v_mov_b64 v[224:225], v[64:65]
    v_mov_b64 v[226:227], v[66:67]
    v_mov_b64 v[228:229], v[68:69]
    v_mov_b64 v[230:231], v[70:71]
    v_mov_b64 v[232:233], v[72:73]
    v_mov_b64 v[234:235], v[74:75]
    v_mov_b64 v[236:237], v[76:77]
    v_mov_b64 v[238:239], v[78:79]
    v_mov_b64 v[240:241], v[80:81]
    v_mov_b64 v[242:243], v[82:83]
    v_mov_b64 v[244:245], v[84:85]
    v_mov_b64 v[246:247], v[86:87]
    v_mov_b64 v[248:249], v[88:89]
    v_mov_b64 v[250:251], v[90:91]
    v_mov_b64 v[252:253], v[92:93]
    v_mov_b64 v[254:255], v[94:95]
    s_add_u32 s24, s24, 0x1800000
    s_add_u32 s80, s80, 0x1800000
    s_add_u32 s81, s81, 0x1800000
    s_mov_b32 s22, 1
    s_barrier
    s_waitcnt vmcnt(8)
    s_barrier
    s_waitcnt vmcnt(0)
    s_barrier
    s_barrier
    s_barrier
    s_barrier
    v_and_b32 v13, 31, v0
    v_lshrrev_b32 v56, 5, v0
    v_lshlrev_b32 v56, 2, v56
    v_sub_u32 v13, v13, v56
    v_mov_b32 v56, 0xff800000
    s_cmp_ge_u32 s4, 8
    s_cselect_b32 s60, 0, 0xff800000
    v_mov_b32 v57, s60
    v_cmp_le_i32 vcc, 0, v13
    v_cmp_le_i32 s[62:63], 1, v13
    s_nop 0
    v_cndmask_b32 v64, v56, 0, vcc
    v_cndmask_b32 v96, v57, v56, vcc
    v_cndmask_b32 v65, v56, 0, s[62:63]
    v_cndmask_b32 v97, v57, v56, s[62:63]
    v_cmp_le_i32 vcc, 2, v13
    v_cmp_le_i32 s[62:63], 3, v13
    s_nop 0
    v_cndmask_b32 v66, v56, 0, vcc
    v_cndmask_b32 v98, v57, v56, vcc
    v_cndmask_b32 v67, v56, 0, s[62:63]
    v_cndmask_b32 v99, v57, v56, s[62:63]
    v_cmp_le_i32 vcc, 8, v13
    v_cmp_le_i32 s[62:63], 9, v13
    s_nop 0
    v_cndmask_b32 v68, v56, 0, vcc
    v_cndmask_b32 v100, v57, v56, vcc
    v_cndmask_b32 v69, v56, 0, s[62:63]
    v_cndmask_b32 v101, v57, v56, s[62:63]
    v_cmp_le_i32 vcc, 10, v13
    v_cmp_le_i32 s[62:63], 11, v13
    s_nop 0
    v_cndmask_b32 v70, v56, 0, vcc
    v_cndmask_b32 v102, v57, v56, vcc
    v_cndmask_b32 v71, v56, 0, s[62:63]
    v_cndmask_b32 v103, v57, v56, s[62:63]
    v_cmp_le_i32 vcc, 16, v13
    v_cmp_le_i32 s[62:63], 17, v13
    s_nop 0
    v_cndmask_b32 v72, v56, 0, vcc
    v_cndmask_b32 v104, v57, v56, vcc
    v_cndmask_b32 v73, v56, 0, s[62:63]
    v_cndmask_b32 v105, v57, v56, s[62:63]
    v_cmp_le_i32 vcc, 18, v13
    v_cmp_le_i32 s[62:63], 19, v13
    s_nop 0
    v_cndmask_b32 v74, v56, 0, vcc
    v_cndmask_b32 v106, v57, v56, vcc
    v_cndmask_b32 v75, v56, 0, s[62:63]
    v_cndmask_b32 v107, v57, v56, s[62:63]
    v_cmp_le_i32 vcc, 24, v13
    v_cmp_le_i32 s[62:63], 25, v13
    s_nop 0
    v_cndmask_b32 v76, v56, 0, vcc
    v_cndmask_b32 v108, v57, v56, vcc
    v_cndmask_b32 v77, v56, 0, s[62:63]
    v_cndmask_b32 v109, v57, v56, s[62:63]
    v_cmp_le_i32 vcc, 26, v13
    v_cmp_le_i32 s[62:63], 27, v13
    s_nop 0
    v_cndmask_b32 v78, v56, 0, vcc
    v_cndmask_b32 v110, v57, v56, vcc
    v_cndmask_b32 v79, v56, 0, s[62:63]
    v_cndmask_b32 v111, v57, v56, s[62:63]
    s_lshr_b32 s61, s3, 2
    s_mul_i32 s61, s61, 12
    s_add_u32 s61, s61, s5
    s_lshl_b32 s60, s61, 10
    s_add_u32 s60, s60, 106496
    v_add_u32 v20, s60, v1
    v_lshrrev_b32 v21, 5, v0
    v_lshlrev_b32 v21, 8, v21
    v_and_b32 v12, 15, v0
    v_lshl_add_u32 v21, v12, 4, v21
    v_add_u32 v22, 0x200, v21
    v_and_b32 v12, 16, v0
    v_cmp_ne_u32 vcc, 0, v12
    v_mov_b32 v12, 0x400
    s_nop 0
    v_cndmask_b32 v21, v21, v12, vcc
    v_cndmask_b32 v22, v22, v12, vcc
    s_mul_i32 s60, s61, 1040
    s_add_u32 s60, s60, 131072
    v_add_u32 v21, s60, v21
    v_add_u32 v22, s60, v22
    s_lshl_b32 s60, s16, 12
    s_sub_u32 s60, s60, 8192
    v_add_u32 v12, s60, v1
    v_min_u32 v14, 0x80000000, v12
    v_add_u32 v12, 0x1000, v12
    v_min_u32 v15, 0x80000000, v12
    s_branch h2_mid
h2_l1:
    s_barrier
    s_waitcnt vmcnt(3)
    ds_write_b128 v3, v[144:147] offset:40960
    s_waitcnt vmcnt(2)
    ds_write_b128 v3, v[148:151] offset:41984
    s_waitcnt vmcnt(1)
    ds_write_b128 v3, v[152:155] offset:43008
    s_waitcnt vmcnt(0)
    ds_write_b128 v3, v[156:159] offset:44032
    ds_write_b128 v28, v[192:195] offset:32768
    ds_write_b128 v28, v[196:199] offset:33792
    s_barrier
    ds_write_b128 v28, v[200:203] offset:49152
    ds_write_b128 v28, v[204:207] offset:50176
    s_barrier
    ds_write_b128 v29, v[208:211] offset:49152
    ds_write_b128 v29, v[212:215] offset:50176
    s_barrier
    ds_write_b128 v30, v[216:219] offset:0
    ds_write_b128 v30, v[220:223] offset:1024
    s_waitcnt lgkmcnt(15)
    s_barrier
    ds_write_b128 v30, v[224:227] offset:8192
    ds_write_b128 v30, v[228:231] offset:9216
    s_barrier
    ds_write_b128 v30, v[232:235] offset:16384
    ds_write_b128 v30, v[236:239] offset:17408
    s_barrier
    ds_write_b128 v29, v[240:243] offset:57344
    ds_write_b128 v29, v[244:247] offset:58368
    s_waitcnt lgkmcnt(14)
    s_barrier
    ds_write_b128 v29, v[248:251] offset:32768
    ds_write_b128 v29, v[252:255] offset:33792
    s_waitcnt lgkmcnt(0)
    s_barrier
    s_barrier
    s_barrier
    s_barrier
    s_waitcnt lgkmcnt(0)
    s_barrier
    s_endpgm
h_end:
    s_cmp_lg_u32 s2, 0
    s_cbranch_scc1 h_end2
    s_cmp_lg_u32 s3, 7
    s_cbranch_scc1 h_end2
    v_mov_b32 v24, 0
    s_mov_b32 s6, 0x1578000
    s_mov_b64 exec, 1
    buffer_store_dword v10, v24, s[8:11], s6 offen sc1
h_end2:
    s_waitcnt vmcnt(0)
mega_end:
    s_endpgm
code_end:
attn_exact:
    s_nop 7
    s_nop 7
    s_mov_b32 s7, 0x7f800000
    s_cmp_ge_u32 s4, 7
    s_cselect_b32 s44, s7, 0xff800000
    s_cmp_ge_u32 s4, 6
    s_cselect_b32 s45, s7, 0xff800000
    s_cmp_ge_u32 s4, 5
    s_cselect_b32 s46, s7, 0xff800000
    s_cmp_ge_u32 s4, 4
    s_cselect_b32 s47, s7, 0xff800000
    s_cmp_ge_u32 s4, 3
    s_cselect_b32 s48, s7, 0xff800000
    s_cmp_ge_u32 s4, 2
    s_cselect_b32 s49, s7, 0xff800000
    s_cmp_ge_u32 s4, 1
    s_cselect_b32 s50, s7, 0xff800000
    ds_read_b128 v[128:131], v20 offset:0
    ds_read_b128 v[132:135], v20 offset:1024
    ds_read_b128 v[136:139], v20 offset:2048
    ds_read_b128 v[140:143], v20 offset:3072
    ds_read_b128 v[144:147], v20 offset:4096
    ds_read_b128 v[148:151], v20 offset:5120
    ds_read_b128 v[152:155], v20 offset:6144
    ds_read_b128 v[156:159], v20 offset:7168
    ds_read_b128 v[160:163], v20 offset:8192
    v_mov_b32 v12, 0xff800000
    v_mov_b32 v13, 0xff800000
    s_waitcnt lgkmcnt(8)
    v_mfma_f32_32x32x16_bf16 v[80:95], v[128:131], v[16:19], v[96:111]
    s_nop 11
    v_max3_f32 v12, v12, v80, v81
    v_max3_f32 v12, v12, v82, v83
    v_max3_f32 v12, v12, v84, v85
    v_max3_f32 v12, v12, v86, v87
    v_max3_f32 v12, v12, v88, v89
    v_max3_f32 v12, v12, v90, v91
    v_max3_f32 v12, v12, v92, v93
    v_max3_f32 v12, v12, v94, v95
    s_waitcnt lgkmcnt(7)
    v_mfma_f32_32x32x16_bf16 v[80:95], v[132:135], v[16:19], 0
    s_nop 11
    v_max3_f32 v13, v13, v80, v81
    v_max3_f32 v13, v13, v82, v83
    v_max3_f32 v13, v13, v84, v85
    v_max3_f32 v13, v13, v86, v87
    v_max3_f32 v13, v13, v88, v89
    v_max3_f32 v13, v13, v90, v91
    v_max3_f32 v13, v13, v92, v93
    v_max3_f32 v13, v13, v94, v95
    v_min_f32 v13, s44, v13
    s_waitcnt lgkmcnt(6)
    v_mfma_f32_32x32x16_bf16 v[80:95], v[136:139], v[16:19], 0
    s_nop 11
    v_max3_f32 v13, v13, v80, v81
    v_max3_f32 v13, v13, v82, v83
    v_max3_f32 v13, v13, v84, v85
    v_max3_f32 v13, v13, v86, v87
    v_max3_f32 v13, v13, v88, v89
    v_max3_f32 v13, v13, v90, v91
    v_max3_f32 v13, v13, v92, v93
    v_max3_f32 v13, v13, v94, v95
    v_min_f32 v13, s45, v13
    s_waitcnt lgkmcnt(5)
    v_mfma_f32_32x32x16_bf16 v[80:95], v[140:143], v[16:19], 0
    s_nop 11
    v_max3_f32 v13, v13, v80, v81
    v_max3_f32 v13, v13, v82, v83
    v_max3_f32 v13, v13, v84, v85
    v_max3_f32 v13, v13, v86, v87
    v_max3_f32 v13, v13, v88, v89
    v_max3_f32 v13, v13, v90, v91
    v_max3_f32 v13, v13, v92, v93
    v_max3_f32 v13, v13, v94, v95
    v_min_f32 v13, s46, v13
    s_waitcnt lgkmcnt(4)
    v_mfma_f32_32x32x16_bf16 v[80:95], v[144:147], v[16:19], 0
    s_nop 11
    v_max3_f32 v13, v13, v80, v81
    v_max3_f32 v13, v13, v82, v83
    v_max3_f32 v13, v13, v84, v85
    v_max3_f32 v13, v13, v86, v87
    v_max3_f32 v13, v13, v88, v89
    v_max3_f32 v13, v13, v90, v91
    v_max3_f32 v13, v13, v92, v93
    v_max3_f32 v13, v13, v94, v95
    v_min_f32 v13, s47, v13
    s_waitcnt lgkmcnt(3)
    v_mfma_f32_32x32x16_bf16 v[80:95], v[148:151], v[16:19], 0
    s_nop 11
    v_max3_f32 v13, v13, v80, v81
    v_max3_f32 v13, v13, v82, v83
    v_max3_f32 v13, v13, v84, v85
    v_max3_f32 v13, v13, v86, v87
    v_max3_f32 v13, v13, v88, v89
    v_max3_f32 v13, v13, v90, v91
    v_max3_f32 v13, v13, v92, v93
    v_max3_f32 v13, v13, v94, v95
    v_min_f32 v13, s48, v13
    s_waitcnt lgkmcnt(2)
    v_mfma_f32_32x32x16_bf16 v[80:95], v[152:155], v[16:19], 0
    s_nop 11
    v_max3_f32 v13, v13, v80, v81
    v_max3_f32 v13, v13, v82, v83
    v_max3_f32 v13, v13, v84, v85
    v_max3_f32 v13, v13, v86, v87
    v_max3_f32 v13, v13, v88, v89
    v_max3_f32 v13, v13, v90, v91
    v_max3_f32 v13, v13, v92, v93
    v_max3_f32 v13, v13, v94, v95
    v_min_f32 v13, s49, v13
    s_waitcnt lgkmcnt(1)
    v_mfma_f32_32x32x16_bf16 v[80:95], v[156:159], v[16:19], 0
    s_nop 11
    v_max3_f32 v13, v13, v80, v81
    v_max3_f32 v13, v13, v82, v83
    v_max3_f32 v13, v13, v84, v85
    v_max3_f32 v13, v13, v86, v87
    v_max3_f32 v13, v13, v88, v89
    v_max3_f32 v13, v13, v90, v91
    v_max3_f32 v13, v13, v92, v93
    v_max3_f32 v13, v13, v94, v95
    v_min_f32 v13, s50, v13
    s_waitcnt lgkmcnt(0)
    v_mfma_f32_32x32x16_bf16 v[80:95], v[160:163], v[16:19], v[64:79]
    s_nop 11
    v_max3_f32 v12, v12, v80, v81
    v_max3_f32 v12, v12, v82, v83
    v_max3_f32 v12, v12, v84, v85
    v_max3_f32 v12, v12, v86, v87
    v_max3_f32 v12, v12, v88, v89
    v_max3_f32 v12, v12, v90, v91
    v_max3_f32 v12, v12, v92, v93
    v_max3_f32 v12, v12, v94, v95
    v_max_f32 v12, v12, v13
    v_mov_b32 v13, v12
    s_nop 1
    v_permlane32_swap_b32 v12, v13
    v_max_f32 v12, v12, v13
    v_mfma_f32_32x32x16_bf16 v[80:95], v[128:131], v[16:19], v[96:111]
    ds_read_b128 v[40:43], v21 offset:0
    ds_read_b128 v[44:47], v22 offset:0
    s_nop 9
    v_sub_f32 v80, v80, v12
    v_sub_f32 v81, v81, v12
    v_sub_f32 v82, v82, v12
    v_sub_f32 v83, v83, v12
    v_sub_f32 v84, v84, v12
    v_sub_f32 v85, v85, v12
    v_sub_f32 v86, v86, v12
    v_sub_f32 v87, v87, v12
    v_sub_f32 v88, v88, v12
    v_sub_f32 v89, v89, v12
    v_sub_f32 v90, v90, v12
    v_sub_f32 v91, v91, v12
    v_sub_f32 v92, v92, v12
    v_sub_f32 v93, v93, v12
    v_sub_f32 v94, v94, v12
    v_sub_f32 v95, v95, v12
    v_exp_f32_e64 v80, v80 clamp
    v_exp_f32_e64 v81, v81 clamp
    v_exp_f32_e64 v82, v82 clamp
    v_exp_f32_e64 v83, v83 clamp
    v_exp_f32_e64 v84, v84 clamp
    v_exp_f32_e64 v85, v85 clamp
    v_exp_f32_e64 v86, v86 clamp
    v_exp_f32_e64 v87, v87 clamp
    v_exp_f32_e64 v88, v88 clamp
    v_exp_f32_e64 v89, v89 clamp
    v_exp_f32_e64 v90, v90 clamp
    v_exp_f32_e64 v91, v91 clamp
    v_exp_f32_e64 v92, v92 clamp
    v_exp_f32_e64 v93, v93 clamp
    v_exp_f32_e64 v94, v94 clamp
    v_exp_f32_e64 v95, v95 clamp
    v_cvt_pk_bf16_f32 v112, v80, v81
    v_cvt_pk_bf16_f32 v113, v82, v83
    v_cvt_pk_bf16_f32 v114, v84, v85
    v_cvt_pk_bf16_f32 v115, v86, v87
    v_cvt_pk_bf16_f32 v116, v88, v89
    v_cvt_pk_bf16_f32 v117, v90, v91
    v_cvt_pk_bf16_f32 v118, v92, v93
    v_cvt_pk_bf16_f32 v119, v94, v95
    s_waitcnt lgkmcnt(1)
    v_mfma_f32_32x32x16_bf16 v[176:191], v[40:43], v[112:115], 0
    s_waitcnt lgkmcnt(0)
    v_mfma_f32_32x32x16_bf16 v[176:191], v[44:47], v[116:119], v[176:191]
    v_mfma_f32_32x32x16_bf16 v[80:95], v[132:135], v[16:19], 0
    ds_read_b128 v[40:43], v21 offset:1040
    ds_read_b128 v[44:47], v22 offset:1040
    s_nop 9
    v_sub_f32 v80, v80, v12
    v_sub_f32 v81, v81, v12
    v_sub_f32 v82, v82, v12
    v_sub_f32 v83, v83, v12
    v_sub_f32 v84, v84, v12
    v_sub_f32 v85, v85, v12
    v_sub_f32 v86, v86, v12
    v_sub_f32 v87, v87, v12
    v_sub_f32 v88, v88, v12
    v_sub_f32 v89, v89, v12
    v_sub_f32 v90, v90, v12
    v_sub_f32 v91, v91, v12
    v_sub_f32 v92, v92, v12
    v_sub_f32 v93, v93, v12
    v_sub_f32 v94, v94, v12
    v_sub_f32 v95, v95, v12
    v_exp_f32_e64 v80, v80 clamp
    v_exp_f32_e64 v81, v81 clamp
    v_exp_f32_e64 v82, v82 clamp
    v_exp_f32_e64 v83, v83 clamp
    v_exp_f32_e64 v84, v84 clamp
    v_exp_f32_e64 v85, v85 clamp
    v_exp_f32_e64 v86, v86 clamp
    v_exp_f32_e64 v87, v87 clamp
    v_exp_f32_e64 v88, v88 clamp
    v_exp_f32_e64 v89, v89 clamp
    v_exp_f32_e64 v90, v90 clamp
    v_exp_f32_e64 v91, v91 clamp
    v_exp_f32_e64 v92, v92 clamp
    v_exp_f32_e64 v93, v93 clamp
    v_exp_f32_e64 v94, v94 clamp
    v_exp_f32_e64 v95, v95 clamp
    v_cvt_pk_bf16_f32 v112, v80, v81
    v_cvt_pk_bf16_f32 v113, v82, v83
    v_cvt_pk_bf16_f32 v114, v84, v85
    v_cvt_pk_bf16_f32 v115, v86, v87
    v_cvt_pk_bf16_f32 v116, v88, v89
    v_cvt_pk_bf16_f32 v117, v90, v91
    v_cvt_pk_bf16_f32 v118, v92, v93
    v_cvt_pk_bf16_f32 v119, v94, v95
    s_waitcnt lgkmcnt(1)
    v_mfma_f32_32x32x16_bf16 v[176:191], v[40:43], v[112:115], v[176:191]
    s_waitcnt lgkmcnt(0)
    v_mfma_f32_32x32x16_bf16 v[176:191], v[44:47], v[116:119], v[176:191]
    v_mfma_f32_32x32x16_bf16 v[80:95], v[136:139], v[16:19], 0
    ds_read_b128 v[40:43], v21 offset:2080
    ds_read_b128 v[44:47], v22 offset:2080
    s_nop 9
    v_sub_f32 v80, v80, v12
    v_sub_f32 v81, v81, v12
    v_sub_f32 v82, v82, v12
    v_sub_f32 v83, v83, v12
    v_sub_f32 v84, v84, v12
    v_sub_f32 v85, v85, v12
    v_sub_f32 v86, v86, v12
    v_sub_f32 v87, v87, v12
    v_sub_f32 v88, v88, v12
    v_sub_f32 v89, v89, v12
    v_sub_f32 v90, v90, v12
    v_sub_f32 v91, v91, v12
    v_sub_f32 v92, v92, v12
    v_sub_f32 v93, v93, v12
    v_sub_f32 v94, v94, v12
    v_sub_f32 v95, v95, v12
    v_exp_f32_e64 v80, v80 clamp
    v_exp_f32_e64 v81, v81 clamp
    v_exp_f32_e64 v82, v82 clamp
    v_exp_f32_e64 v83, v83 clamp
    v_exp_f32_e64 v84, v84 clamp
    v_exp_f32_e64 v85, v85 clamp
    v_exp_f32_e64 v86, v86 clamp
    v_exp_f32_e64 v87, v87 clamp
    v_exp_f32_e64 v88, v88 clamp
    v_exp_f32_e64 v89, v89 clamp
    v_exp_f32_e64 v90, v90 clamp
    v_exp_f32_e64 v91, v91 clamp
    v_exp_f32_e64 v92, v92 clamp
    v_exp_f32_e64 v93, v93 clamp
    v_exp_f32_e64 v94, v94 clamp
    v_exp_f32_e64 v95, v95 clamp
    v_cvt_pk_bf16_f32 v112, v80, v81
    v_cvt_pk_bf16_f32 v113, v82, v83
    v_cvt_pk_bf16_f32 v114, v84, v85
    v_cvt_pk_bf16_f32 v115, v86, v87
    v_cvt_pk_bf16_f32 v116, v88, v89
    v_cvt_pk_bf16_f32 v117, v90, v91
    v_cvt_pk_bf16_f32 v118, v92, v93
    v_cvt_pk_bf16_f32 v119, v94, v95
    s_waitcnt lgkmcnt(1)
    v_mfma_f32_32x32x16_bf16 v[176:191], v[40:43], v[112:115], v[176:191]
    s_waitcnt lgkmcnt(0)
    v_mfma_f32_32x32x16_bf16 v[176:191], v[44:47], v[116:119], v[176:191]
    v_mfma_f32_32x32x16_bf16 v[80:95], v[140:143], v[16:19], 0
    ds_read_b128 v[40:43], v21 offset:3120
    ds_read_b128 v[44:47], v22 offset:3120
    s_nop 9
    v_sub_f32 v80, v80, v12
    v_sub_f32 v81, v81, v12
    v_sub_f32 v82, v82, v12
    v_sub_f32 v83, v83, v12
    v_sub_f32 v84, v84, v12
    v_sub_f32 v85, v85, v12
    v_sub_f32 v86, v86, v12
    v_sub_f32 v87, v87, v12
    v_sub_f32 v88, v88, v12
    v_sub_f32 v89, v89, v12
    v_sub_f32 v90, v90, v12
    v_sub_f32 v91, v91, v12
    v_sub_f32 v92, v92, v12
    v_sub_f32 v93, v93, v12
    v_sub_f32 v94, v94, v12
    v_sub_f32 v95, v95, v12
    v_exp_f32_e64 v80, v80 clamp
    v_exp_f32_e64 v81, v81 clamp
    v_exp_f32_e64 v82, v82 clamp
    v_exp_f32_e64 v83, v83 clamp
    v_exp_f32_e64 v84, v84 clamp
    v_exp_f32_e64 v85, v85 clamp
    v_exp_f32_e64 v86, v86 clamp
    v_exp_f32_e64 v87, v87 clamp
    v_exp_f32_e64 v88, v88 clamp
    v_exp_f32_e64 v89, v89 clamp
    v_exp_f32_e64 v90, v90 clamp
    v_exp_f32_e64 v91, v91 clamp
    v_exp_f32_e64 v92, v92 clamp
    v_exp_f32_e64 v93, v93 clamp
    v_exp_f32_e64 v94, v94 clamp
    v_exp_f32_e64 v95, v95 clamp
    v_cvt_pk_bf16_f32 v112, v80, v81
    v_cvt_pk_bf16_f32 v113, v82, v83
    v_cvt_pk_bf16_f32 v114, v84, v85
    v_cvt_pk_bf16_f32 v115, v86, v87
    v_cvt_pk_bf16_f32 v116, v88, v89
    v_cvt_pk_bf16_f32 v117, v90, v91
    v_cvt_pk_bf16_f32 v118, v92, v93
    v_cvt_pk_bf16_f32 v119, v94, v95
    s_waitcnt lgkmcnt(1)
    v_mfma_f32_32x32x16_bf16 v[176:191], v[40:43], v[112:115], v[176:191]
    s_waitcnt lgkmcnt(0)
    v_mfma_f32_32x32x16_bf16 v[176:191], v[44:47], v[116:119], v[176:191]
    v_mfma_f32_32x32x16_bf16 v[80:95], v[144:147], v[16:19], 0
    ds_read_b128 v[40:43], v21 offset:4160
    ds_read_b128 v[44:47], v22 offset:4160
    s_nop 9
    v_sub_f32 v80, v80, v12
    v_sub_f32 v81, v81, v12
    v_sub_f32 v82, v82, v12
    v_sub_f32 v83, v83, v12
    v_sub_f32 v84, v84, v12
    v_sub_f32 v85, v85, v12
    v_sub_f32 v86, v86, v12
    v_sub_f32 v87, v87, v12
    v_sub_f32 v88, v88, v12
    v_sub_f32 v89, v89, v12
    v_sub_f32 v90, v90, v12
    v_sub_f32 v91, v91, v12
    v_sub_f32 v92, v92, v12
    v_sub_f32 v93, v93, v12
    v_sub_f32 v94, v94, v12
    v_sub_f32 v95, v95, v12
    v_exp_f32_e64 v80, v80 clamp
    v_exp_f32_e64 v81, v81 clamp
    v_exp_f32_e64 v82, v82 clamp
    v_exp_f32_e64 v83, v83 clamp
    v_exp_f32_e64 v84, v84 clamp
    v_exp_f32_e64 v85, v85 clamp
    v_exp_f32_e64 v86, v86 clamp
    v_exp_f32_e64 v87, v87 clamp
    v_exp_f32_e64 v88, v88 clamp
    v_exp_f32_e64 v89, v89 clamp
    v_exp_f32_e64 v90, v90 clamp
    v_exp_f32_e64 v91, v91 clamp
    v_exp_f32_e64 v92, v92 clamp
    v_exp_f32_e64 v93, v93 clamp
    v_exp_f32_e64 v94, v94 clamp
    v_exp_f32_e64 v95, v95 clamp
    v_cvt_pk_bf16_f32 v112, v80, v81
    v_cvt_pk_bf16_f32 v113, v82, v83
    v_cvt_pk_bf16_f32 v114, v84, v85
    v_cvt_pk_bf16_f32 v115, v86, v87
    v_cvt_pk_bf16_f32 v116, v88, v89
    v_cvt_pk_bf16_f32 v117, v90, v91
    v_cvt_pk_bf16_f32 v118, v92, v93
    v_cvt_pk_bf16_f32 v119, v94, v95
    s_waitcnt lgkmcnt(1)
    v_mfma_f32_32x32x16_bf16 v[176:191], v[40:43], v[112:115], v[176:191]
    s_waitcnt lgkmcnt(0)
    v_mfma_f32_32x32x16_bf16 v[176:191], v[44:47], v[116:119], v[176:191]
    v_mfma_f32_32x32x16_bf16 v[80:95], v[148:151], v[16:19], 0
    ds_read_b128 v[40:43], v21 offset:5200
    ds_read_b128 v[44:47], v22 offset:5200
    s_nop 9
    v_sub_f32 v80, v80, v12
    v_sub_f32 v81, v81, v12
    v_sub_f32 v82, v82, v12
    v_sub_f32 v83, v83, v12
    v_sub_f32 v84, v84, v12
    v_sub_f32 v85, v85, v12
    v_sub_f32 v86, v86, v12
    v_sub_f32 v87, v87, v12
    v_sub_f32 v88, v88, v12
    v_sub_f32 v89, v89, v12
    v_sub_f32 v90, v90, v12
    v_sub_f32 v91, v91, v12
    v_sub_f32 v92, v92, v12
    v_sub_f32 v93, v93, v12
    v_sub_f32 v94, v94, v12
    v_sub_f32 v95, v95, v12
    v_exp_f32_e64 v80, v80 clamp
    v_exp_f32_e64 v81, v81 clamp
    v_exp_f32_e64 v82, v82 clamp
    v_exp_f32_e64 v83, v83 clamp
    v_exp_f32_e64 v84, v84 clamp
    v_exp_f32_e64 v85, v85 clamp
    v_exp_f32_e64 v86, v86 clamp
    v_exp_f32_e64 v87, v87 clamp
    v_exp_f32_e64 v88, v88 clamp
    v_exp_f32_e64 v89, v89 clamp
    v_exp_f32_e64 v90, v90 clamp
    v_exp_f32_e64 v91, v91 clamp
    v_exp_f32_e64 v92, v92 clamp
    v_exp_f32_e64 v93, v93 clamp
    v_exp_f32_e64 v94, v94 clamp
    v_exp_f32_e64 v95, v95 clamp
    v_cvt_pk_bf16_f32 v112, v80, v81
    v_cvt_pk_bf16_f32 v113, v82, v83
    v_cvt_pk_bf16_f32 v114, v84, v85
    v_cvt_pk_bf16_f32 v115, v86, v87
    v_cvt_pk_bf16_f32 v116, v88, v89
    v_cvt_pk_bf16_f32 v117, v90, v91
    v_cvt_pk_bf16_f32 v118, v92, v93
    v_cvt_pk_bf16_f32 v119, v94, v95
    s_waitcnt lgkmcnt(1)
    v_mfma_f32_32x32x16_bf16 v[176:191], v[40:43], v[112:115], v[176:191]
    s_waitcnt lgkmcnt(0)
    v_mfma_f32_32x32x16_bf16 v[176:191], v[44:47], v[116:119], v[176:191]
    v_mfma_f32_32x32x16_bf16 v[80:95], v[152:155], v[16:19], 0
    ds_read_b128 v[40:43], v21 offset:6240
    ds_read_b128 v[44:47], v22 offset:6240
    s_nop 9
    v_sub_f32 v80, v80, v12
    v_sub_f32 v81, v81, v12
    v_sub_f32 v82, v82, v12
    v_sub_f32 v83, v83, v12
    v_sub_f32 v84, v84, v12
    v_sub_f32 v85, v85, v12
    v_sub_f32 v86, v86, v12
    v_sub_f32 v87, v87, v12
    v_sub_f32 v88, v88, v12
    v_sub_f32 v89, v89, v12
    v_sub_f32 v90, v90, v12
    v_sub_f32 v91, v91, v12
    v_sub_f32 v92, v92, v12
    v_sub_f32 v93, v93, v12
    v_sub_f32 v94, v94, v12
    v_sub_f32 v95, v95, v12
    v_exp_f32_e64 v80, v80 clamp
    v_exp_f32_e64 v81, v81 clamp
    v_exp_f32_e64 v82, v82 clamp
    v_exp_f32_e64 v83, v83 clamp
    v_exp_f32_e64 v84, v84 clamp
    v_exp_f32_e64 v85, v85 clamp
    v_exp_f32_e64 v86, v86 clamp
    v_exp_f32_e64 v87, v87 clamp
    v_exp_f32_e64 v88, v88 clamp
    v_exp_f32_e64 v89, v89 clamp
    v_exp_f32_e64 v90, v90 clamp
    v_exp_f32_e64 v91, v91 clamp
    v_exp_f32_e64 v92, v92 clamp
    v_exp_f32_e64 v93, v93 clamp
    v_exp_f32_e64 v94, v94 clamp
    v_exp_f32_e64 v95, v95 clamp
    v_cvt_pk_bf16_f32 v112, v80, v81
    v_cvt_pk_bf16_f32 v113, v82, v83
    v_cvt_pk_bf16_f32 v114, v84, v85
    v_cvt_pk_bf16_f32 v115, v86, v87
    v_cvt_pk_bf16_f32 v116, v88, v89
    v_cvt_pk_bf16_f32 v117, v90, v91
    v_cvt_pk_bf16_f32 v118, v92, v93
    v_cvt_pk_bf16_f32 v119, v94, v95
    s_waitcnt lgkmcnt(1)
    v_mfma_f32_32x32x16_bf16 v[176:191], v[40:43], v[112:115], v[176:191]
    s_waitcnt lgkmcnt(0)
    v_mfma_f32_32x32x16_bf16 v[176:191], v[44:47], v[116:119], v[176:191]
    v_mfma_f32_32x32x16_bf16 v[80:95], v[156:159], v[16:19], 0
    ds_read_b128 v[40:43], v21 offset:7280
    ds_read_b128 v[44:47], v22 offset:7280
    s_nop 9
    v_sub_f32 v80, v80, v12
    v_sub_f32 v81, v81, v12
    v_sub_f32 v82, v82, v12
    v_sub_f32 v83, v83, v12
    v_sub_f32 v84, v84, v12
    v_sub_f32 v85, v85, v12
    v_sub_f32 v86, v86, v12
    v_sub_f32 v87, v87, v12
    v_sub_f32 v88, v88, v12
    v_sub_f32 v89, v89, v12
    v_sub_f32 v90, v90, v12
    v_sub_f32 v91, v91, v12
    v_sub_f32 v92, v92, v12
    v_sub_f32 v93, v93, v12
    v_sub_f32 v94, v94, v12
    v_sub_f32 v95, v95, v12
    v_exp_f32_e64 v80, v80 clamp
    v_exp_f32_e64 v81, v81 clamp
    v_exp_f32_e64 v82, v82 clamp
    v_exp_f32_e64 v83, v83 clamp
    v_exp_f32_e64 v84, v84 clamp
    v_exp_f32_e64 v85, v85 clamp
    v_exp_f32_e64 v86, v86 clamp
    v_exp_f32_e64 v87, v87 clamp
    v_exp_f32_e64 v88, v88 clamp
    v_exp_f32_e64 v89, v89 clamp
    v_exp_f32_e64 v90, v90 clamp
    v_exp_f32_e64 v91, v91 clamp
    v_exp_f32_e64 v92, v92 clamp
    v_exp_f32_e64 v93, v93 clamp
    v_exp_f32_e64 v94, v94 clamp
    v_exp_f32_e64 v95, v95 clamp
    v_cvt_pk_bf16_f32 v112, v80, v81
    v_cvt_pk_bf16_f32 v113, v82, v83
    v_cvt_pk_bf16_f32 v114, v84, v85
    v_cvt_pk_bf16_f32 v115, v86, v87
    v_cvt_pk_bf16_f32 v116, v88, v89
    v_cvt_pk_bf16_f32 v117, v90, v91
    v_cvt_pk_bf16_f32 v118, v92, v93
    v_cvt_pk_bf16_f32 v119, v94, v95
    s_waitcnt lgkmcnt(1)
    v_mfma_f32_32x32x16_bf16 v[176:191], v[40:43], v[112:115], v[176:191]
    s_waitcnt lgkmcnt(0)
    v_mfma_f32_32x32x16_bf16 v[176:191], v[44:47], v[116:119], v[176:191]
    v_mfma_f32_32x32x16_bf16 v[80:95], v[160:163], v[16:19], v[64:79]
    ds_read_b128 v[40:43], v21 offset:8320
    ds_read_b128 v[44:47], v22 offset:8320
    s_nop 9
    v_sub_f32 v80, v80, v12
    v_sub_f32 v81, v81, v12
    v_sub_f32 v82, v82, v12
    v_sub_f32 v83, v83, v12
    v_sub_f32 v84, v84, v12
    v_sub_f32 v85, v85, v12
    v_sub_f32 v86, v86, v12
    v_sub_f32 v87, v87, v12
    v_sub_f32 v88, v88, v12
    v_sub_f32 v89, v89, v12
    v_sub_f32 v90, v90, v12
    v_sub_f32 v91, v91, v12
    v_sub_f32 v92, v92, v12
    v_sub_f32 v93, v93, v12
    v_sub_f32 v94, v94, v12
    v_sub_f32 v95, v95, v12
    v_exp_f32_e64 v80, v80 clamp
    v_exp_f32_e64 v81, v81 clamp
    v_exp_f32_e64 v82, v82 clamp
    v_exp_f32_e64 v83, v83 clamp
    v_exp_f32_e64 v84, v84 clamp
    v_exp_f32_e64 v85, v85 clamp
    v_exp_f32_e64 v86, v86 clamp
    v_exp_f32_e64 v87, v87 clamp
    v_exp_f32_e64 v88, v88 clamp
    v_exp_f32_e64 v89, v89 clamp
    v_exp_f32_e64 v90, v90 clamp
    v_exp_f32_e64 v91, v91 clamp
    v_exp_f32_e64 v92, v92 clamp
    v_exp_f32_e64 v93, v93 clamp
    v_exp_f32_e64 v94, v94 clamp
    v_exp_f32_e64 v95, v95 clamp
    v_cvt_pk_bf16_f32 v112, v80, v81
    v_cvt_pk_bf16_f32 v113, v82, v83
    v_cvt_pk_bf16_f32 v114, v84, v85
    v_cvt_pk_bf16_f32 v115, v86, v87
    v_cvt_pk_bf16_f32 v116, v88, v89
    v_cvt_pk_bf16_f32 v117, v90, v91
    v_cvt_pk_bf16_f32 v118, v92, v93
    v_cvt_pk_bf16_f32 v119, v94, v95
    s_waitcnt lgkmcnt(1)
    v_mfma_f32_32x32x16_bf16 v[176:191], v[40:43], v[112:115], v[176:191]
    s_waitcnt lgkmcnt(0)
    v_mfma_f32_32x32x16_bf16 v[176:191], v[44:47], v[116:119], v[176:191]
    s_nop 11
    v_rcp_f32 v14, v184
    s_nop 1
    s_branch attn_fin
.section .rodata,"a"
.p2align 6
.amdhsa_kernel interleave_layers__sliding_block__glu_gated_glu__prompt_kernel
  .amdhsa_next_free_vgpr 256
  .amdhsa_next_free_sgpr 100
  .amdhsa_accum_offset 256
  .amdhsa_group_segment_fixed_size 0
  .amdhsa_kernarg_size 80
  .amdhsa_user_sgpr_count 2
  .amdhsa_user_sgpr_kernarg_segment_ptr 1
  .amdhsa_system_sgpr_workgroup_id_x 1
.end_amdhsa_kernel
```
